```python
import torch

def _softmax(x, axis=-1):
    return torch.softmax(x, dim=axis)
def _gelu(x):
    return torch.nn.functional.gelu(x, approximate="tanh")
def _silu(x):
    return torch.nn.functional.silu(x)
def _sigmoid(x):
    return torch.sigmoid(x)
def _layernorm(x, axis=-1, eps=1e-5):
    m = x.mean(dim=axis, keepdim=True)
    v = x.var(dim=axis, keepdim=True, unbiased=False)
    return (x - m) / torch.sqrt(v + eps)
def _scatter_add(tgt, idx, src, axis=0):
    return tgt.clone().index_add_(axis, idx, src)
def _segment_sum(src, seg, n):
    out = torch.zeros((n,) + src.shape[1:], dtype=src.dtype)
    return out.index_add_(0, seg, src)
def _pad(x, pw):
    flat = tuple(v for pair in reversed(pw) for v in pair)
    return torch.nn.functional.pad(x, flat)

kernel_name = 'recurrent_scan__sliding_local_dilated__swiglu_ffn__prompt'

def setup_inputs():

    _w = (lambda a: (lambda t: t.to(torch.bfloat16) if t.is_floating_point() else t)(torch.as_tensor(a)))
    def _A_setup():
        B, S, D = 1, 2048, 1024
        return {
            "x": _w((lambda *s: torch.randn(*s, dtype=torch.bfloat16) * 0.05)(B, S, D)),
            "wqkv": _w((lambda *s: torch.randn(*s, dtype=torch.bfloat16) * 0.05)(D, 3 * D)),
            "wo": _w((lambda *s: torch.randn(*s, dtype=torch.bfloat16) * 0.05)(D, D)),
        }
    _A_in = _A_setup()

    def _B_setup():
        B, S, D, F = 1, 2048, 1024, 3584
        return {
            "x": _w((lambda *s: torch.randn(*s, dtype=torch.bfloat16) * 0.05)(B, S, D)),
            "w_gate": _w((lambda *s: torch.randn(*s, dtype=torch.bfloat16) * 0.05)(D, F)),
            "w_up": _w((lambda *s: torch.randn(*s, dtype=torch.bfloat16) * 0.05)(D, F)),
            "w_down": _w((lambda *s: torch.randn(*s, dtype=torch.bfloat16) * 0.05)(F, D)),
        }
    _B_in = _B_setup()

    return {
        "A_x": _A_in["x"],
        "A_wqkv": _A_in["wqkv"],
        "A_wo": _A_in["wo"],
        "B_x": _B_in["x"],
        "B_w_gate": _B_in["w_gate"],
        "B_w_up": _B_in["w_up"],
        "B_w_down": _B_in["w_down"],
    }

def reference(A_x, A_wqkv, A_wo, B_x, B_w_gate, B_w_up, B_w_down):
    def _A_ref(x, wqkv, wo):
        B, S, D = x.shape
        H = 32; Dh = D // H
        W, dil = 8, 2
        qkv = (lambda x, *d: x.permute(*d))((x @ wqkv).reshape(B, S, 3, H, Dh), 2, 0, 3, 1, 4)
        q, k, v = qkv[0], qkv[1], qkv[2]
        scale = Dh ** -0.5
        pos = torch.arange(S)
        off = torch.arange(W) * dil
        idx = pos[:, None] - off[None, :]
        mask = idx >= 0
        idx_c = torch.where(mask, idx, 0).reshape(-1)
        kg = k[:, :, idx_c, :].reshape(B, H, S, W, Dh)
        vg = v[:, :, idx_c, :].reshape(B, H, S, W, Dh)
        logits = torch.einsum("bhsd,bhswd->bhsw", q, kg) * scale
        logits = torch.where(mask[None, None, :, :], logits, -1e9)
        attn = _softmax(logits, axis=-1)
        o = torch.einsum("bhsw,bhswd->bhsd", attn, vg)
        return (lambda x, *d: x.permute(*d))(o, 0, 2, 1, 3).reshape(B, S, D) @ wo

    def _B_ref(x, w_gate, w_up, w_down):
        g = _silu(x @ w_gate)
        u = x @ w_up
        return (g * u) @ w_down

    x = A_x
    xn = _layernorm(x, axis=-1)
    s = _A_ref(xn, A_wqkv, A_wo)
    g = _silu(_B_ref(xn, B_w_gate, B_w_up, B_w_down))
    return x + s * g
```

```asm
; @launch grid=(256,1,1) block=(256,1,1) lds=163840
.amdgcn_target "amdgcn-amd-amdhsa--gfx950"
.text
.p2align 12
.globl recurrent_scan__sliding_local_dilated__swiglu_ffn__prompt_kernel
.p2align 8
.type recurrent_scan__sliding_local_dilated__swiglu_ffn__prompt_kernel,@function
recurrent_scan__sliding_local_dilated__swiglu_ffn__prompt_kernel:
    s_cmp_ge_u32 s2, 256
    s_cbranch_scc1 recurrent_scan__sliding_local_dilated__swiglu_ffn__prompt_kernel_done

    s_load_dwordx2 s[92:93], s[0:1], 0
    s_load_dwordx2 s[8:9], s[0:1], 72
    s_load_dwordx2 s[70:71], s[0:1], 8
    s_load_dwordx2 s[56:57], s[0:1], 16
    s_load_dwordx4 s[64:67], s[0:1], 32
    s_load_dwordx2 s[60:61], s[0:1], 48
    s_load_dwordx2 s[52:53], s[0:1], 56
    s_getpc_b64 s[12:13]
recurrent_scan__sliding_local_dilated__swiglu_ffn__prompt_kernel_pc0:
    s_mov_b32 s14, code_end - recurrent_scan__sliding_local_dilated__swiglu_ffn__prompt_kernel_pc0
    s_mov_b32 s15, 0x20000
    v_lshrrev_b32 v2, 4, v0
    v_lshlrev_b32 v2, 7, v2
    s_lshr_b32 s7, s2, 3
    s_lshl_b32 s7, s7, 11
    v_lshrrev_b32 v15, 6, v0
    v_and_b32 v1, 63, v0
    buffer_load_dword a210, v2, s[12:15], s7 offen
    v_readfirstlane_b32 s3, v15
    s_and_b32 s77, s2, 7
    s_lshl_b32 s77, s77, 2
    s_lshr_b32 s77, 0x37261504, s77
    s_and_b32 s77, s77, 7
    s_lshl_b32 s5, s77, 2
    s_bfe_u32 s4, s2, 0x20003
    s_add_u32 s5, s5, s4
    s_lshr_b32 s4, s2, 5
    s_lshl_b32 s79, s4, 5
    s_add_u32 s79, s79, s5
    s_lshl_b32 s78, s79, 2
    s_add_u32 s78, s78, s3
    v_and_b32 v24, 7, v1
    v_lshrrev_b32 v25, 3, v1
    v_lshlrev_b32 v36, 11, v24
    v_lshl_add_u32 v36, v15, 9, v36
    v_lshl_add_u32 v36, v25, 4, v36
    s_lshl_b32 s7, s79, 14
    s_mov_b32 s94, 0x400000
    s_mov_b32 s95, 0x20000
    s_mov_b32 s10, 12582912
    s_mov_b32 s11, 0x20000
    s_mov_b32 s82, 3145728
    s_mov_b32 s83, 0x20000
    v_mov_b32 v23, 0
    s_mov_b32 s90, 524288
    s_lshl_b32 s91, s78, 7
    s_add_u32 s91, s91, 262144
    s_waitcnt lgkmcnt(0)

    buffer_load_dwordx4 v[40:43], v36, s[92:95], s7 offen offset:0
    buffer_load_dwordx4 v[44:47], v36, s[92:95], s7 offen offset:128
    buffer_load_dwordx4 v[48:51], v36, s[92:95], s7 offen offset:256
    buffer_load_dwordx4 v[52:55], v36, s[92:95], s7 offen offset:384
    s_add_u32 s80, s8, 41943040
    s_addc_u32 s81, s9, 0
    s_mov_b64 s[54:55], s[92:93]
    buffer_load_dword v22, v23, s[80:83], s90 offen
    buffer_load_dword a210, v23, s[80:83], s91 offen sc0 sc1
    s_lshr_b32 s7, s2, 3
    v_min_u32 v26, 6, v24
    v_lshlrev_b32 v26, 7, v26
    v_min_u32 v28, 5, v24
    v_lshrrev_b32 v27, 1, v28
    v_lshlrev_b32 v27, 11, v27
    v_and_b32 v28, 1, v28
    v_lshl_add_u32 v27, v28, 7, v27
    s_cmp_eq_u32 s3, 0
    s_cselect_b64 vcc, -1, 0
    s_movk_i32 s88, 7168
    s_cselect_b32 s88, 6144, s88
    s_movk_i32 s89, 896
    s_cselect_b32 s89, 256, s89
    s_cselect_b64 s[84:85], s[70:71], s[64:65]
    v_cndmask_b32 v8, v26, v27, vcc
    s_cmp_eq_u32 s3, 2
    s_cselect_b64 s[84:85], s[66:67], s[84:85]
    s_mul_i32 s89, s89, s77
    s_lshl_b32 s86, s88, 10
    s_mov_b32 s87, 0x20000
    v_mul_lo_u32 v26, v25, s88
    v_add_u32 v26, v26, v8
    s_lshl_b32 s91, s7, 3
    s_mul_i32 s91, s91, s88
    s_add_u32 s91, s91, s89
    s_cmp_eq_u32 s3, 3
    s_cselect_b32 s86, 0, s86
    s_lshl_b32 s97, s4, 2
    s_add_u32 s97, s97, s3
    s_lshl_b32 s97, s97, 3
    s_add_u32 s97, s97, s77
    s_lshl_b32 s97, s97, 7
    s_add_u32 s97, s97, 393216
    buffer_load_dword a210, v23, s[80:83], s97 offen sc0 sc1
    v_mov_b32 v28, v26
    buffer_load_dword a210, v28, s[84:87], s91 offen
    s_mov_b32 s62, 7340032
    s_mov_b32 s63, 0x20000
    v_lshrrev_b32 v26, 2, v25
    s_lshl_b32 s92, s3, 3
    v_add_u32 v26, s92, v26
    s_mov_b32 s92, 196608
    v_mul_lo_u32 v37, v26, s92
    v_and_b32 v26, 3, v25
    s_and_b32 s92, s79, 1
    v_lshl_add_u32 v26, v26, 1, s92
    s_bfe_u32 s93, s79, 0x10001
    s_sub_u32 s94, 3, s93
    v_cmp_le_u32 vcc, s94, v26
    v_lshl_add_u32 v37, v24, 4, v37
    s_mul_i32 s93, s93, 1152
    v_addc_co_u32 v26, vcc, 0, v26, vcc
    v_lshl_add_u32 v37, v26, 7, v37
    s_lshr_b32 s92, s79, 2
    s_mul_i32 s92, s92, 3072
    s_add_u32 s92, s92, s93
    v_add_u32 v37, s92, v37
    s_mov_b32 s92, 0
    s_mov_b32 s93, 393216
    s_mov_b32 s94, 786432
    s_mov_b32 s95, 1179648
    v_lshlrev_b32 v38, 4, v24
    v_add_u32 v38, 163584, v38
    s_lshl_b32 s96, s3, 2
    v_add_u32 v39, s96, v38
    s_mov_b64 exec, 0
    s_cmp_eq_u32 s3, 0
    s_cbranch_scc1 recurrent_scan__sliding_local_dilated__swiglu_ffn__prompt_kernel_w0
    s_cmp_eq_u32 s3, 1
    s_cbranch_scc1 recurrent_scan__sliding_local_dilated__swiglu_ffn__prompt_kernel_w1
    s_cmp_eq_u32 s3, 2
    s_cbranch_scc1 recurrent_scan__sliding_local_dilated__swiglu_ffn__prompt_kernel_w2
    s_branch recurrent_scan__sliding_local_dilated__swiglu_ffn__prompt_kernel_w3
recurrent_scan__sliding_local_dilated__swiglu_ffn__prompt_kernel_wret0:
    s_mov_b64 exec, -1
    s_waitcnt vmcnt(7)
    v_lshlrev_b32 v56, 16, v40
    v_and_b32 v57, 0xffff0000, v40
    v_lshlrev_b32 v58, 16, v41
    v_and_b32 v59, 0xffff0000, v41
    v_lshlrev_b32 v60, 16, v42
    v_and_b32 v61, 0xffff0000, v42
    v_lshlrev_b32 v62, 16, v43
    v_and_b32 v63, 0xffff0000, v43
    v_pk_add_f32 v[88:89], v[56:57], v[60:61]
    v_pk_add_f32 v[90:91], v[58:59], v[62:63]
    s_waitcnt vmcnt(6)
    v_lshlrev_b32 v64, 16, v44
    v_and_b32 v65, 0xffff0000, v44
    v_lshlrev_b32 v66, 16, v45
    v_and_b32 v67, 0xffff0000, v45
    v_lshlrev_b32 v68, 16, v46
    v_and_b32 v69, 0xffff0000, v46
    v_lshlrev_b32 v70, 16, v47
    v_and_b32 v71, 0xffff0000, v47
    v_pk_add_f32 v[88:89], v[88:89], v[64:65]
    v_pk_add_f32 v[90:91], v[90:91], v[66:67]
    v_pk_add_f32 v[88:89], v[88:89], v[68:69]
    v_pk_add_f32 v[90:91], v[90:91], v[70:71]
    s_waitcnt vmcnt(5)
    v_lshlrev_b32 v72, 16, v48
    v_and_b32 v73, 0xffff0000, v48
    v_lshlrev_b32 v74, 16, v49
    v_and_b32 v75, 0xffff0000, v49
    v_lshlrev_b32 v76, 16, v50
    v_and_b32 v77, 0xffff0000, v50
    v_lshlrev_b32 v78, 16, v51
    v_and_b32 v79, 0xffff0000, v51
    v_pk_add_f32 v[88:89], v[88:89], v[72:73]
    v_pk_add_f32 v[90:91], v[90:91], v[74:75]
    v_pk_add_f32 v[88:89], v[88:89], v[76:77]
    v_pk_add_f32 v[90:91], v[90:91], v[78:79]
    s_waitcnt vmcnt(4)
    v_lshlrev_b32 v80, 16, v52
    v_and_b32 v81, 0xffff0000, v52
    v_lshlrev_b32 v82, 16, v53
    v_and_b32 v83, 0xffff0000, v53
    v_lshlrev_b32 v84, 16, v54
    v_and_b32 v85, 0xffff0000, v54
    v_lshlrev_b32 v86, 16, v55
    v_and_b32 v87, 0xffff0000, v55
    v_pk_add_f32 v[88:89], v[88:89], v[80:81]
    v_pk_add_f32 v[90:91], v[90:91], v[82:83]
    v_pk_add_f32 v[88:89], v[88:89], v[84:85]
    v_pk_add_f32 v[90:91], v[90:91], v[86:87]
    v_pk_add_f32 v[88:89], v[88:89], v[90:91]
    v_add_f32 v88, v88, v89
    s_nop 1
    v_add_f32_dpp v88, v88, v88 row_ror:8 row_mask:0xf bank_mask:0xf
    v_mov_b32 v89, v88
    s_nop 1
    v_permlane16_swap_b32 v88, v89
    v_add_f32 v88, v88, v89
    v_mov_b32 v89, v88
    s_nop 1
    v_permlane32_swap_b32 v88, v89
    v_add_f32 v88, v88, v89
    v_mul_f32 v92, 0x3b800000, v88
    v_mov_b32 v93, v92
    v_pk_add_f32 v[96:97], v[56:57], v[92:93] neg_lo:[0,1] neg_hi:[0,1]
    v_pk_mul_f32 v[90:91], v[96:97], v[96:97]
    v_pk_add_f32 v[98:99], v[58:59], v[92:93] neg_lo:[0,1] neg_hi:[0,1]
    v_pk_mul_f32 v[94:95], v[98:99], v[98:99]
    v_pk_add_f32 v[96:97], v[60:61], v[92:93] neg_lo:[0,1] neg_hi:[0,1]
    v_pk_fma_f32 v[90:91], v[96:97], v[96:97], v[90:91]
    v_pk_add_f32 v[98:99], v[62:63], v[92:93] neg_lo:[0,1] neg_hi:[0,1]
    v_pk_fma_f32 v[94:95], v[98:99], v[98:99], v[94:95]
    v_pk_add_f32 v[96:97], v[64:65], v[92:93] neg_lo:[0,1] neg_hi:[0,1]
    v_pk_fma_f32 v[90:91], v[96:97], v[96:97], v[90:91]
    v_pk_add_f32 v[98:99], v[66:67], v[92:93] neg_lo:[0,1] neg_hi:[0,1]
    v_pk_fma_f32 v[94:95], v[98:99], v[98:99], v[94:95]
    v_pk_add_f32 v[96:97], v[68:69], v[92:93] neg_lo:[0,1] neg_hi:[0,1]
    v_pk_fma_f32 v[90:91], v[96:97], v[96:97], v[90:91]
    v_pk_add_f32 v[98:99], v[70:71], v[92:93] neg_lo:[0,1] neg_hi:[0,1]
    v_pk_fma_f32 v[94:95], v[98:99], v[98:99], v[94:95]
    v_pk_add_f32 v[96:97], v[72:73], v[92:93] neg_lo:[0,1] neg_hi:[0,1]
    v_pk_fma_f32 v[90:91], v[96:97], v[96:97], v[90:91]
    v_pk_add_f32 v[98:99], v[74:75], v[92:93] neg_lo:[0,1] neg_hi:[0,1]
    v_pk_fma_f32 v[94:95], v[98:99], v[98:99], v[94:95]
    v_pk_add_f32 v[96:97], v[76:77], v[92:93] neg_lo:[0,1] neg_hi:[0,1]
    v_pk_fma_f32 v[90:91], v[96:97], v[96:97], v[90:91]
    v_pk_add_f32 v[98:99], v[78:79], v[92:93] neg_lo:[0,1] neg_hi:[0,1]
    v_pk_fma_f32 v[94:95], v[98:99], v[98:99], v[94:95]
    v_pk_add_f32 v[96:97], v[80:81], v[92:93] neg_lo:[0,1] neg_hi:[0,1]
    v_pk_fma_f32 v[90:91], v[96:97], v[96:97], v[90:91]
    v_pk_add_f32 v[98:99], v[82:83], v[92:93] neg_lo:[0,1] neg_hi:[0,1]
    v_pk_fma_f32 v[94:95], v[98:99], v[98:99], v[94:95]
    v_pk_add_f32 v[96:97], v[84:85], v[92:93] neg_lo:[0,1] neg_hi:[0,1]
    v_pk_fma_f32 v[90:91], v[96:97], v[96:97], v[90:91]
    v_pk_add_f32 v[98:99], v[86:87], v[92:93] neg_lo:[0,1] neg_hi:[0,1]
    v_pk_fma_f32 v[94:95], v[98:99], v[98:99], v[94:95]
    v_pk_add_f32 v[90:91], v[90:91], v[94:95]
    v_add_f32 v90, v90, v91
    s_nop 1
    v_add_f32_dpp v90, v90, v90 row_ror:8 row_mask:0xf bank_mask:0xf
    v_mov_b32 v91, v90
    s_nop 1
    v_permlane16_swap_b32 v90, v91
    v_add_f32 v90, v90, v91
    v_mov_b32 v91, v90
    s_nop 1
    v_permlane32_swap_b32 v90, v91
    v_add_f32 v90, v90, v91
    ds_write_b32 v39, v92
    ds_write_b32 v39, v90 offset:128
    s_waitcnt lgkmcnt(0)
    s_barrier
    ds_read_b128 v[92:95], v38
    ds_read_b128 v[96:99], v38 offset:128
    s_waitcnt lgkmcnt(1)
    v_add_f32 v88, v92, v93
    v_add_f32 v89, v94, v95
    v_add_f32 v88, v88, v89
    v_mul_f32 v88, 0x3e800000, v88
    v_sub_f32 v92, v92, v88
    v_sub_f32 v93, v93, v88
    v_sub_f32 v94, v94, v88
    v_sub_f32 v95, v95, v88
    v_mul_f32 v89, v92, v92
    v_fmac_f32 v89, v93, v93
    v_fmac_f32 v89, v94, v94
    v_fmac_f32 v89, v95, v95
    v_cvt_pk_bf16_f32 v92, v88, v88
    v_lshlrev_b32 v92, 16, v92
    v_mov_b32 v93, v92
    s_waitcnt lgkmcnt(0)
    v_add_f32 v96, v96, v97
    v_add_f32 v98, v98, v99
    v_add_f32 v96, v96, v98
    v_mul_f32 v96, 0x3a800000, v96
    v_fmac_f32 v96, 0x3e800000, v89
    v_cvt_pk_bf16_f32 v96, v96, v96
    v_lshlrev_b32 v96, 16, v96
    v_add_f32 v96, 0x3727c5ac, v96
    v_cvt_pk_bf16_f32 v96, v96, v96
    v_lshlrev_b32 v96, 16, v96
    v_sqrt_f32 v96, v96
    v_pk_add_f32 v[56:57], v[56:57], v[92:93] neg_lo:[0,1] neg_hi:[0,1]
    v_cvt_pk_bf16_f32 v96, v96, v96
    v_lshlrev_b32 v96, 16, v96
    v_rcp_f32 v96, v96
    v_pk_add_f32 v[58:59], v[58:59], v[92:93] neg_lo:[0,1] neg_hi:[0,1]
    v_mov_b32 v97, v96
    v_cvt_pk_bf16_f32 v104, v56, v57
    v_lshlrev_b32 v56, 16, v104
    v_and_b32 v57, 0xffff0000, v104
    v_pk_mul_f32 v[56:57], v[56:57], v[96:97]
    v_cvt_pk_bf16_f32 v104, v56, v57
    v_cvt_pk_bf16_f32 v105, v58, v59
    v_lshlrev_b32 v58, 16, v105
    v_and_b32 v59, 0xffff0000, v105
    v_pk_mul_f32 v[58:59], v[58:59], v[96:97]
    v_cvt_pk_bf16_f32 v105, v58, v59
    v_pk_add_f32 v[60:61], v[60:61], v[92:93] neg_lo:[0,1] neg_hi:[0,1]
    v_cvt_pk_bf16_f32 v106, v60, v61
    v_lshlrev_b32 v60, 16, v106
    v_and_b32 v61, 0xffff0000, v106
    v_pk_mul_f32 v[60:61], v[60:61], v[96:97]
    v_cvt_pk_bf16_f32 v106, v60, v61
    v_pk_add_f32 v[62:63], v[62:63], v[92:93] neg_lo:[0,1] neg_hi:[0,1]
    v_cvt_pk_bf16_f32 v107, v62, v63
    v_lshlrev_b32 v62, 16, v107
    v_and_b32 v63, 0xffff0000, v107
    v_pk_mul_f32 v[62:63], v[62:63], v[96:97]
    v_cvt_pk_bf16_f32 v107, v62, v63
    buffer_store_dwordx4 v[104:107], v37, s[8:11], s92 offen sc0 sc1
    v_pk_add_f32 v[64:65], v[64:65], v[92:93] neg_lo:[0,1] neg_hi:[0,1]
    v_cvt_pk_bf16_f32 v108, v64, v65
    v_lshlrev_b32 v64, 16, v108
    v_and_b32 v65, 0xffff0000, v108
    v_pk_mul_f32 v[64:65], v[64:65], v[96:97]
    v_cvt_pk_bf16_f32 v108, v64, v65
    v_pk_add_f32 v[66:67], v[66:67], v[92:93] neg_lo:[0,1] neg_hi:[0,1]
    v_cvt_pk_bf16_f32 v109, v66, v67
    v_lshlrev_b32 v66, 16, v109
    v_and_b32 v67, 0xffff0000, v109
    v_pk_mul_f32 v[66:67], v[66:67], v[96:97]
    v_cvt_pk_bf16_f32 v109, v66, v67
    v_pk_add_f32 v[68:69], v[68:69], v[92:93] neg_lo:[0,1] neg_hi:[0,1]
    v_cvt_pk_bf16_f32 v110, v68, v69
    v_lshlrev_b32 v68, 16, v110
    v_and_b32 v69, 0xffff0000, v110
    v_pk_mul_f32 v[68:69], v[68:69], v[96:97]
    v_cvt_pk_bf16_f32 v110, v68, v69
    v_pk_add_f32 v[70:71], v[70:71], v[92:93] neg_lo:[0,1] neg_hi:[0,1]
    v_cvt_pk_bf16_f32 v111, v70, v71
    v_lshlrev_b32 v70, 16, v111
    v_and_b32 v71, 0xffff0000, v111
    v_pk_mul_f32 v[70:71], v[70:71], v[96:97]
    v_cvt_pk_bf16_f32 v111, v70, v71
    buffer_store_dwordx4 v[108:111], v37, s[8:11], s93 offen sc0 sc1
    v_pk_add_f32 v[72:73], v[72:73], v[92:93] neg_lo:[0,1] neg_hi:[0,1]
    v_cvt_pk_bf16_f32 v112, v72, v73
    v_lshlrev_b32 v72, 16, v112
    v_and_b32 v73, 0xffff0000, v112
    v_pk_mul_f32 v[72:73], v[72:73], v[96:97]
    v_cvt_pk_bf16_f32 v112, v72, v73
    v_pk_add_f32 v[74:75], v[74:75], v[92:93] neg_lo:[0,1] neg_hi:[0,1]
    v_cvt_pk_bf16_f32 v113, v74, v75
    v_lshlrev_b32 v74, 16, v113
    v_and_b32 v75, 0xffff0000, v113
    v_pk_mul_f32 v[74:75], v[74:75], v[96:97]
    v_cvt_pk_bf16_f32 v113, v74, v75
    v_pk_add_f32 v[76:77], v[76:77], v[92:93] neg_lo:[0,1] neg_hi:[0,1]
    v_cvt_pk_bf16_f32 v114, v76, v77
    v_lshlrev_b32 v76, 16, v114
    v_and_b32 v77, 0xffff0000, v114
    v_pk_mul_f32 v[76:77], v[76:77], v[96:97]
    v_cvt_pk_bf16_f32 v114, v76, v77
    v_pk_add_f32 v[78:79], v[78:79], v[92:93] neg_lo:[0,1] neg_hi:[0,1]
    v_cvt_pk_bf16_f32 v115, v78, v79
    v_lshlrev_b32 v78, 16, v115
    v_and_b32 v79, 0xffff0000, v115
    v_pk_mul_f32 v[78:79], v[78:79], v[96:97]
    v_cvt_pk_bf16_f32 v115, v78, v79
    buffer_store_dwordx4 v[112:115], v37, s[8:11], s94 offen sc0 sc1
    v_pk_add_f32 v[80:81], v[80:81], v[92:93] neg_lo:[0,1] neg_hi:[0,1]
    v_cvt_pk_bf16_f32 v116, v80, v81
    v_lshlrev_b32 v80, 16, v116
    v_and_b32 v81, 0xffff0000, v116
    v_pk_mul_f32 v[80:81], v[80:81], v[96:97]
    v_cvt_pk_bf16_f32 v116, v80, v81
    v_pk_add_f32 v[82:83], v[82:83], v[92:93] neg_lo:[0,1] neg_hi:[0,1]
    v_cvt_pk_bf16_f32 v117, v82, v83
    v_lshlrev_b32 v82, 16, v117
    v_and_b32 v83, 0xffff0000, v117
    v_pk_mul_f32 v[82:83], v[82:83], v[96:97]
    v_cvt_pk_bf16_f32 v117, v82, v83
    v_pk_add_f32 v[84:85], v[84:85], v[92:93] neg_lo:[0,1] neg_hi:[0,1]
    v_cvt_pk_bf16_f32 v118, v84, v85
    v_lshlrev_b32 v84, 16, v118
    v_and_b32 v85, 0xffff0000, v118
    v_pk_mul_f32 v[84:85], v[84:85], v[96:97]
    v_cvt_pk_bf16_f32 v118, v84, v85
    v_pk_add_f32 v[86:87], v[86:87], v[92:93] neg_lo:[0,1] neg_hi:[0,1]
    v_cvt_pk_bf16_f32 v119, v86, v87
    v_lshlrev_b32 v86, 16, v119
    v_and_b32 v87, 0xffff0000, v119
    v_pk_mul_f32 v[86:87], v[86:87], v[96:97]
    v_cvt_pk_bf16_f32 v119, v86, v87
    buffer_store_dwordx4 v[116:119], v37, s[8:11], s95 offen sc0 sc1
    s_lshr_b32 s91, s4, 1
    s_lshl_b32 s91, s91, 2
    s_and_b32 s72, s5, 3
    s_add_u32 s91, s91, s72
    s_lshl_b32 s91, s91, 2
    v_bfe_u32 v26, v1, 3, 2
    v_mul_lo_u32 v26, v26, s88
    v_add_u32 v8, v8, v26
    s_and_b32 s68, s4, 1
    s_lshl_b32 s68, 1, s68
    s_add_u32 s91, s91, 256
    s_mul_i32 s91, s91, s88
    s_add_u32 s89, s89, s91
    s_lshl_b32 s88, s88, 6
    v_and_b32 v31, 15, v1
    v_lshlrev_b32 v31, 7, v31
    s_lshr_b32 s91, s2, 1
    s_and_b32 s73, s2, 1
    s_sub_u32 s73, s73, 1
    s_and_b32 s73, s73, 3
    s_mul_i32 s91, s91, 5760
    s_mov_b32 s72, s62
    v_min_u32 v26, 44, v1
    v_lshlrev_b32 v26, 7, v26
    s_cmp_eq_u32 s3, 3
    s_cselect_b64 vcc, -1, 0
    s_cselect_b32 s89, s91, s89
    s_cselect_b32 s86, s72, s86
    s_cselect_b32 s88, 737280, s88
    s_cselect_b64 s[84:85], s[60:61], s[84:85]
    v_cndmask_b32 v8, v8, v26, vcc
    s_mov_b32 s69, s86
    s_mov_b32 s0, s89
    s_cselect_b32 s1, 2, -1
    s_cselect_b32 s68, s73, s68
    v_lshlrev_b32 v15, 7, v1
    s_lshl_b32 s6, s4, 4
    s_lshl_b32 s72, s3, 2
    s_add_u32 s6, s6, s72
    s_mul_i32 s46, s3, 5120
    v_lshrrev_b32 v16, 4, v1
    v_bfe_u32 v17, v1, 2, 2
    v_lshl_add_u32 v20, v16, 3, v17
    v_and_b32 v18, 1, v16
    v_lshlrev_b32 v21, 1, v18
    v_and_b32 v19, 3, v1
    v_xor_b32 v21, v21, v19
    v_lshlrev_b32 v21, 4, v21
    v_mul_u32_u24 v20, 6144, v20
    v_add_u32 v20, v20, v21
    v_lshlrev_b32 v9, 8, v16
    v_lshl_add_u32 v9, v17, 6, v9
    v_lshl_add_u32 v9, v19, 3, v9
    v_lshl_add_u32 v9, v18, 5, v9
    v_xor_b32 v10, 32, v9
    v_lshrrev_b32 v11, 2, v1
    v_mul_u32_u24 v11, 224, v11
    v_lshl_add_u32 v11, v19, 3, v11
    v_mov_b32 v12, v9
    v_mov_b32 v13, v10
    v_mov_b32 v14, v11
    s_mul_i32 s73, s6, 1536
    v_lshl_add_u32 v7, v1, 4, s73
    v_cmp_le_u32 vcc, 16, v1
    v_add_u32 v30, 1152, v7
    v_add_u32 v28, 1280, v7
    v_cndmask_b32 v30, v30, v28, vcc
    v_cmp_le_u32 vcc, 24, v1
    v_add_u32 v28, 128, v7
    s_lshl_b32 s72, s5, 6
    v_cndmask_b32 v7, v7, v28, vcc
    s_and_b32 s73, s5, 1
    s_mul_i32 s74, s5, 7
    s_add_u32 s75, s74, s73
    s_xor_b32 s76, s73, 1
    s_mul_i32 s76, s76, 6
    s_add_u32 s76, s76, s74
    s_lshl_b32 s73, s73, 1
    s_mul_i32 s74, s5, 224
    s_mov_b32 s42, 0
    s_add_u32 s48, s8, 12582912
    s_addc_u32 s49, s9, 0
    s_mov_b32 s50, 28311552
    s_mov_b32 s51, 0x20000
    s_add_u32 s47, s46, 163840
    s_mov_b32 s43, 0
    s_cmp_eq_u32 s3, 1
    s_cbranch_scc1 recurrent_scan__sliding_local_dilated__swiglu_ffn__prompt_kernel_setup1
    s_cmp_eq_u32 s3, 2
    s_cbranch_scc1 recurrent_scan__sliding_local_dilated__swiglu_ffn__prompt_kernel_setup2
    s_cmp_eq_u32 s3, 3
    s_cbranch_scc1 recurrent_scan__sliding_local_dilated__swiglu_ffn__prompt_kernel_setup3
recurrent_scan__sliding_local_dilated__swiglu_ffn__prompt_kernel_setup0:
    s_add_u32 s32, s72, 0
    v_mov_b32 v2, v20
    s_mov_b64 s[12:13], s[70:71]
    s_mov_b32 s14, 6291456
    s_mov_b32 s15, 0x20000
    s_mov_b32 s37, 196608
    s_add_u32 s33, s72, 24576
    v_mov_b32 v3, v20
    s_mov_b64 s[16:17], s[70:71]
    s_mov_b32 s18, 6291456
    s_mov_b32 s19, 0x20000
    s_mov_b32 s38, 196608
    s_add_u32 s34, s72, 2048
    v_mov_b32 v4, v20
    s_mov_b64 s[20:21], s[70:71]
    s_mov_b32 s22, 6291456
    s_mov_b32 s23, 0x20000
    s_mov_b32 s39, 196608
    s_add_u32 s35, s72, 26624
    v_mov_b32 v5, v20
    s_mov_b64 s[24:25], s[70:71]
    s_mov_b32 s26, 6291456
    s_mov_b32 s27, 0x20000
    s_mov_b32 s40, 196608
    s_add_u32 s36, s72, 4096
    v_mov_b32 v6, v20
    s_mov_b64 s[28:29], s[70:71]
    s_mov_b32 s30, 6291456
    s_mov_b32 s31, 0x20000
    s_mov_b32 s41, 196608
    s_branch recurrent_scan__sliding_local_dilated__swiglu_ffn__prompt_kernel_setup_done
recurrent_scan__sliding_local_dilated__swiglu_ffn__prompt_kernel_setup1:
    s_add_u32 s32, s72, 28672
    v_mov_b32 v2, v20
    s_mov_b64 s[12:13], s[70:71]
    s_mov_b32 s14, 6291456
    s_mov_b32 s15, 0x20000
    s_mov_b32 s37, 196608
    s_mov_b32 s33, s74
    v_add_u32 v26, 0, v1
    v_mul_u32_u24 v27, 4682, v26
    v_lshrrev_b32 v27, 16, v27
    v_mul_u32_u24 v28, 14, v27
    v_sub_u32 v26, v26, v28
    v_add_u32 v26, s73, v26
    v_subrev_u32 v28, 14, v26
    v_min_u32 v26, v26, v28
    v_bfe_u32 v28, v27, 2, 2
    v_lshlrev_b32 v28, 3, v28
    v_lshrrev_b32 v21, 4, v27
    v_lshl_add_u32 v28, v21, 2, v28
    v_and_b32 v27, 3, v27
    v_add_u32 v28, v28, v27
    v_mul_u32_u24 v28, 7168, v28
    v_lshl_add_u32 v3, v26, 4, v28
    s_mov_b64 s[16:17], s[64:65]
    s_mov_b32 s18, 7340032
    s_mov_b32 s19, 0x20000
    s_mov_b32 s38, 229376
    s_mov_b32 s34, s74
    v_add_u32 v26, 64, v1
    v_mul_u32_u24 v27, 4682, v26
    v_lshrrev_b32 v27, 16, v27
    v_mul_u32_u24 v28, 14, v27
    v_sub_u32 v26, v26, v28
    v_add_u32 v26, s73, v26
    v_subrev_u32 v28, 14, v26
    v_min_u32 v26, v26, v28
    v_bfe_u32 v28, v27, 2, 2
    v_lshlrev_b32 v28, 3, v28
    v_lshrrev_b32 v21, 4, v27
    v_lshl_add_u32 v28, v21, 2, v28
    v_and_b32 v27, 3, v27
    v_add_u32 v28, v28, v27
    v_mul_u32_u24 v28, 7168, v28
    v_lshl_add_u32 v4, v26, 4, v28
    s_mov_b64 s[20:21], s[64:65]
    s_mov_b32 s22, 7340032
    s_mov_b32 s23, 0x20000
    s_mov_b32 s39, 229376
    s_mov_b32 s35, s74
    v_add_u32 v26, 128, v1
    v_mul_u32_u24 v27, 4682, v26
recurrent_scan__sliding_local_dilated__swiglu_ffn__prompt_kernel_w0:
    s_cbranch_execz recurrent_scan__sliding_local_dilated__swiglu_ffn__prompt_kernel_w4
    v_lshrrev_b32 v27, 16, v27
    v_mul_u32_u24 v28, 14, v27
    v_sub_u32 v26, v26, v28
    v_add_u32 v26, s73, v26
    v_subrev_u32 v28, 14, v26
    v_min_u32 v26, v26, v28
    v_bfe_u32 v28, v27, 2, 2
    v_lshlrev_b32 v28, 3, v28
    v_lshrrev_b32 v21, 4, v27
    v_lshl_add_u32 v28, v21, 2, v28
    v_and_b32 v27, 3, v27
    v_add_u32 v28, v28, v27
    v_mul_u32_u24 v28, 7168, v28
    v_lshl_add_u32 v5, v26, 4, v28
    s_mov_b64 s[24:25], s[64:65]
    s_mov_b32 s26, 7340032
    s_mov_b32 s27, 0x20000
    s_mov_b32 s40, 229376
    s_mov_b32 s36, s74
    v_add_u32 v26, 192, v1
    v_mul_u32_u24 v27, 4682, v26
    v_lshrrev_b32 v27, 16, v27
    v_mul_u32_u24 v28, 14, v27
    v_sub_u32 v26, v26, v28
    v_add_u32 v26, s73, v26
    v_subrev_u32 v28, 14, v26
    v_min_u32 v26, v26, v28
    v_bfe_u32 v28, v27, 2, 2
    v_lshlrev_b32 v28, 3, v28
    v_lshrrev_b32 v21, 4, v27
    v_lshl_add_u32 v28, v21, 2, v28
    v_and_b32 v27, 3, v27
    v_add_u32 v28, v28, v27
    v_mul_u32_u24 v28, 7168, v28
    v_lshl_add_u32 v6, v26, 4, v28
    s_mov_b64 s[28:29], s[64:65]
    s_mov_b32 s30, 7340032
    s_mov_b32 s31, 0x20000
    s_mov_b32 s41, 229376
    s_branch recurrent_scan__sliding_local_dilated__swiglu_ffn__prompt_kernel_setup_done
recurrent_scan__sliding_local_dilated__swiglu_ffn__prompt_kernel_setup2:
    s_mov_b32 s32, s74
    v_add_u32 v26, 256, v1
    v_mul_u32_u24 v27, 4682, v26
    v_lshrrev_b32 v27, 16, v27
    v_mul_u32_u24 v28, 14, v27
    v_sub_u32 v26, v26, v28
    v_add_u32 v26, s73, v26
    v_subrev_u32 v28, 14, v26
    v_min_u32 v26, v26, v28
    v_bfe_u32 v28, v27, 2, 2
    v_lshlrev_b32 v28, 3, v28
    v_lshrrev_b32 v21, 4, v27
    v_lshl_add_u32 v28, v21, 2, v28
    v_and_b32 v27, 3, v27
    v_add_u32 v28, v28, v27
    v_mul_u32_u24 v28, 7168, v28
    v_lshl_add_u32 v2, v26, 4, v28
    s_mov_b64 s[12:13], s[64:65]
    s_mov_b32 s14, 7340032
    s_mov_b32 s15, 0x20000
    s_mov_b32 s37, 229376
    s_mov_b32 s33, s74
    v_add_u32 v26, 320, v1
    v_mul_u32_u24 v27, 4682, v26
    v_lshrrev_b32 v27, 16, v27
    v_mul_u32_u24 v28, 14, v27
    v_sub_u32 v26, v26, v28
    v_add_u32 v26, s73, v26
    v_subrev_u32 v28, 14, v26
    v_min_u32 v26, v26, v28
    v_bfe_u32 v28, v27, 2, 2
    v_lshlrev_b32 v28, 3, v28
    v_lshrrev_b32 v21, 4, v27
    v_lshl_add_u32 v28, v21, 2, v28
    v_and_b32 v27, 3, v27
    v_add_u32 v28, v28, v27
    v_mul_u32_u24 v28, 7168, v28
    v_lshl_add_u32 v3, v26, 4, v28
    s_mov_b64 s[16:17], s[64:65]
    s_mov_b32 s18, 7340032
    s_mov_b32 s19, 0x20000
    s_mov_b32 s38, 229376
    s_mov_b32 s34, s74
    v_add_u32 v26, 384, v1
    v_mul_u32_u24 v27, 4682, v26
    v_lshrrev_b32 v27, 16, v27
    v_mul_u32_u24 v28, 14, v27
    v_sub_u32 v26, v26, v28
    v_add_u32 v26, s73, v26
    v_subrev_u32 v28, 14, v26
    v_min_u32 v26, v26, v28
    v_bfe_u32 v28, v27, 2, 2
    v_lshlrev_b32 v28, 3, v28
    v_lshrrev_b32 v21, 4, v27
    v_lshl_add_u32 v28, v21, 2, v28
    v_and_b32 v27, 3, v27
    v_add_u32 v28, v28, v27
    v_mul_u32_u24 v28, 7168, v28
    v_lshl_add_u32 v4, v26, 4, v28
    s_mov_b64 s[20:21], s[64:65]
    s_mov_b32 s22, 7340032
    s_mov_b32 s23, 0x20000
    s_mov_b32 s39, 229376
    s_mov_b32 s35, s74
    v_add_u32 v26, 0, v1
    v_mul_u32_u24 v27, 4682, v26
    v_lshrrev_b32 v27, 16, v27
    v_mul_u32_u24 v28, 14, v27
    v_sub_u32 v26, v26, v28
    v_add_u32 v26, s73, v26
    v_subrev_u32 v28, 14, v26
    v_min_u32 v26, v26, v28
    v_bfe_u32 v28, v27, 2, 2
    v_lshlrev_b32 v28, 3, v28
    v_lshrrev_b32 v21, 4, v27
    v_lshl_add_u32 v28, v21, 2, v28
    v_and_b32 v27, 3, v27
    v_add_u32 v28, v28, v27
    v_mul_u32_u24 v28, 7168, v28
    v_lshl_add_u32 v5, v26, 4, v28
    s_mov_b64 s[24:25], s[66:67]
    s_mov_b32 s26, 7340032
    s_mov_b32 s27, 0x20000
    s_mov_b32 s40, 229376
    s_mov_b32 s36, s74
    v_add_u32 v26, 64, v1
    v_mul_u32_u24 v27, 4682, v26
    v_lshrrev_b32 v27, 16, v27
    v_mul_u32_u24 v28, 14, v27
    v_sub_u32 v26, v26, v28
    v_add_u32 v26, s73, v26
    v_subrev_u32 v28, 14, v26
    v_min_u32 v26, v26, v28
    v_bfe_u32 v28, v27, 2, 2
    v_lshlrev_b32 v28, 3, v28
    v_lshrrev_b32 v21, 4, v27
    v_lshl_add_u32 v28, v21, 2, v28
    v_and_b32 v27, 3, v27
    v_add_u32 v28, v28, v27
    v_mul_u32_u24 v28, 7168, v28
    v_lshl_add_u32 v6, v26, 4, v28
    s_mov_b64 s[28:29], s[66:67]
    s_mov_b32 s30, 7340032
    s_mov_b32 s31, 0x20000
    s_mov_b32 s41, 229376
    s_branch recurrent_scan__sliding_local_dilated__swiglu_ffn__prompt_kernel_setup_done
recurrent_scan__sliding_local_dilated__swiglu_ffn__prompt_kernel_setup3:
    s_mov_b32 s32, s74
    v_add_u32 v26, 128, v1
    v_mul_u32_u24 v27, 4682, v26
    v_lshrrev_b32 v27, 16, v27
    v_mul_u32_u24 v28, 14, v27
    v_sub_u32 v26, v26, v28
    v_add_u32 v26, s73, v26
    v_subrev_u32 v28, 14, v26
    v_min_u32 v26, v26, v28
    v_bfe_u32 v28, v27, 2, 2
    v_lshlrev_b32 v28, 3, v28
    v_lshrrev_b32 v21, 4, v27
    v_lshl_add_u32 v28, v21, 2, v28
    v_and_b32 v27, 3, v27
    v_add_u32 v28, v28, v27
    v_mul_u32_u24 v28, 7168, v28
    v_lshl_add_u32 v2, v26, 4, v28
    s_mov_b64 s[12:13], s[66:67]
    s_mov_b32 s14, 7340032
    s_mov_b32 s15, 0x20000
    s_mov_b32 s37, 229376
    s_mov_b32 s33, s74
    v_add_u32 v26, 192, v1
    v_mul_u32_u24 v27, 4682, v26
    v_lshrrev_b32 v27, 16, v27
    v_mul_u32_u24 v28, 14, v27
    v_sub_u32 v26, v26, v28
    v_add_u32 v26, s73, v26
    v_subrev_u32 v28, 14, v26
    v_min_u32 v26, v26, v28
    v_bfe_u32 v28, v27, 2, 2
    v_lshlrev_b32 v28, 3, v28
    v_lshrrev_b32 v21, 4, v27
    v_lshl_add_u32 v28, v21, 2, v28
    v_and_b32 v27, 3, v27
    v_add_u32 v28, v28, v27
    v_mul_u32_u24 v28, 7168, v28
    v_lshl_add_u32 v3, v26, 4, v28
    s_mov_b64 s[16:17], s[66:67]
    s_mov_b32 s18, 7340032
    s_mov_b32 s19, 0x20000
    s_mov_b32 s38, 229376
    s_mov_b32 s34, s74
    v_add_u32 v26, 256, v1
    v_mul_u32_u24 v27, 4682, v26
    v_lshrrev_b32 v27, 16, v27
    v_mul_u32_u24 v28, 14, v27
    v_sub_u32 v26, v26, v28
    v_add_u32 v26, s73, v26
    v_subrev_u32 v28, 14, v26
    v_min_u32 v26, v26, v28
    v_bfe_u32 v28, v27, 2, 2
    v_lshlrev_b32 v28, 3, v28
    v_lshrrev_b32 v21, 4, v27
    v_lshl_add_u32 v28, v21, 2, v28
    v_and_b32 v27, 3, v27
    v_add_u32 v28, v28, v27
    v_mul_u32_u24 v28, 7168, v28
    v_lshl_add_u32 v4, v26, 4, v28
    s_mov_b64 s[20:21], s[66:67]
    s_mov_b32 s22, 7340032
    s_mov_b32 s23, 0x20000
    s_mov_b32 s39, 229376
    s_mov_b32 s35, s74
    v_add_u32 v26, 320, v1
    v_mul_u32_u24 v27, 4682, v26
    v_lshrrev_b32 v27, 16, v27
    v_mul_u32_u24 v28, 14, v27
    v_sub_u32 v26, v26, v28
    v_add_u32 v26, s73, v26
    v_subrev_u32 v28, 14, v26
    v_min_u32 v26, v26, v28
    v_bfe_u32 v28, v27, 2, 2
    v_lshlrev_b32 v28, 3, v28
    v_lshrrev_b32 v21, 4, v27
    v_lshl_add_u32 v28, v21, 2, v28
    v_and_b32 v27, 3, v27
    v_add_u32 v28, v28, v27
    v_mul_u32_u24 v28, 7168, v28
    v_lshl_add_u32 v5, v26, 4, v28
    s_mov_b64 s[24:25], s[66:67]
    s_mov_b32 s26, 7340032
    s_mov_b32 s27, 0x20000
    s_mov_b32 s40, 229376
    s_mov_b32 s36, s74
    v_add_u32 v26, 384, v1
    v_mul_u32_u24 v27, 4682, v26
    v_lshrrev_b32 v27, 16, v27
    v_mul_u32_u24 v28, 14, v27
    v_sub_u32 v26, v26, v28
    v_add_u32 v26, s73, v26
    v_subrev_u32 v28, 14, v26
    v_min_u32 v26, v26, v28
    v_bfe_u32 v28, v27, 2, 2
    v_lshlrev_b32 v28, 3, v28
    v_lshrrev_b32 v21, 4, v27
    v_lshl_add_u32 v28, v21, 2, v28
    v_and_b32 v27, 3, v27
    v_add_u32 v28, v28, v27
    v_mul_u32_u24 v28, 7168, v28
    v_lshl_add_u32 v6, v26, 4, v28
    s_mov_b64 s[28:29], s[66:67]
    s_mov_b32 s30, 7340032
    s_mov_b32 s31, 0x20000
    s_mov_b32 s41, 229376
recurrent_scan__sliding_local_dilated__swiglu_ffn__prompt_kernel_setup_done:
    s_add_u32 m0, s46, 0
    s_nop 0
    buffer_load_dwordx4 v2, s[12:15], s32 offen lds
    s_add_u32 s32, s32, s37
    s_add_u32 m0, s46, 1024
    s_nop 0
    buffer_load_dwordx4 v3, s[16:19], s33 offen lds
    s_add_u32 s33, s33, s38
    s_add_u32 m0, s46, 2048
    s_nop 0
    buffer_load_dwordx4 v4, s[20:23], s34 offen lds
    s_add_u32 s34, s34, s39
    s_add_u32 m0, s46, 3072
    s_nop 0
    buffer_load_dwordx4 v5, s[24:27], s35 offen lds
    s_add_u32 s35, s35, s40
    s_add_u32 m0, s46, 4096
    s_nop 0
    buffer_load_dwordx4 v6, s[28:31], s36 offen lds
    s_add_u32 s36, s36, s41
    s_waitcnt vmcnt(12)
    v_add_u32 v22, 0x9e3779b9, v22
    s_lshr_b32 s92, s79, 3
    s_lshl_b32 s92, s92, 10
    s_and_b32 s93, s79, 7
    s_lshl_b32 s93, s93, 2
    s_add_u32 s92, s92, s93
    s_add_u32 s92, s92, 393216
    s_cmp_eq_u32 s3, 0
    s_cselect_b32 s92, s92, 3145728
    v_lshlrev_b32 v27, 7, v24
    v_lshlrev_b32 v26, 2, v24
    s_waitcnt vmcnt(5)
    s_barrier
    buffer_store_dword v22, v27, s[80:83], s92 offen sc0 sc1
    s_add_u32 m0, s46, 20480
    s_nop 0
    buffer_load_dwordx4 v2, s[12:15], s32 offen lds
    s_add_u32 s32, s32, s37
    s_add_u32 m0, s46, 21504
    s_nop 0
    buffer_load_dwordx4 v3, s[16:19], s33 offen lds
    s_add_u32 s33, s33, s38
    s_add_u32 m0, s46, 22528
    s_nop 0
    buffer_load_dwordx4 v4, s[20:23], s34 offen lds
    s_add_u32 s34, s34, s39
    s_add_u32 m0, s46, 23552
    s_nop 0
    buffer_load_dwordx4 v5, s[24:27], s35 offen lds
    s_add_u32 s35, s35, s40
    s_add_u32 m0, s46, 24576
    s_nop 0
    buffer_load_dwordx4 v6, s[28:31], s36 offen lds
    s_add_u32 s36, s36, s41
    s_add_u32 m0, s46, 40960
    s_nop 0
    buffer_load_dwordx4 v2, s[12:15], s32 offen lds
    s_add_u32 s32, s32, s37
    s_add_u32 m0, s46, 41984
    s_nop 0
    buffer_load_dwordx4 v3, s[16:19], s33 offen lds
    s_add_u32 s33, s33, s38
    s_add_u32 m0, s46, 43008
    s_nop 0
    buffer_load_dwordx4 v4, s[20:23], s34 offen lds
    s_add_u32 s34, s34, s39
    s_add_u32 m0, s46, 44032
    s_nop 0
    buffer_load_dwordx4 v5, s[24:27], s35 offen lds
    s_add_u32 s35, s35, s40
    s_add_u32 m0, s46, 45056
    s_nop 0
    buffer_load_dwordx4 v6, s[28:31], s36 offen lds
    s_add_u32 s36, s36, s41
    s_mov_b32 s45, 524288
recurrent_scan__sliding_local_dilated__swiglu_ffn__prompt_kernel_poll:
    buffer_load_dword v28, v26, s[80:83], s97 offen sc0 sc1
    s_waitcnt vmcnt(0)
    v_cmp_eq_u32 vcc, v28, v22
    s_cmp_eq_u64 vcc, exec
    s_cbranch_scc1 recurrent_scan__sliding_local_dilated__swiglu_ffn__prompt_kernel_poll_done
    s_sub_u32 s45, s45, 1
    s_cmp_lg_u32 s45, 0
    s_cbranch_scc1 recurrent_scan__sliding_local_dilated__swiglu_ffn__prompt_kernel_poll
recurrent_scan__sliding_local_dilated__swiglu_ffn__prompt_kernel_poll_done:
    buffer_load_dwordx4 a[96:99], v7, s[8:11], s42 offen offset:0 sc1
    buffer_load_dwordx4 a[100:103], v30, s[8:11], s42 offen offset:0 sc1
    buffer_load_dwordx4 a[104:107], v7, s[8:11], s42 offen offset:3072 sc1
    buffer_load_dwordx4 a[108:111], v30, s[8:11], s42 offen offset:3072 sc1
    s_add_u32 s42, s42, 196608
    buffer_load_dwordx4 a[112:115], v7, s[8:11], s42 offen offset:0 sc1
    buffer_load_dwordx4 a[116:119], v30, s[8:11], s42 offen offset:0 sc1
    buffer_load_dwordx4 a[120:123], v7, s[8:11], s42 offen offset:3072 sc1
    buffer_load_dwordx4 a[124:127], v30, s[8:11], s42 offen offset:3072 sc1
    s_add_u32 s42, s42, 196608
    s_barrier
    ds_read_b64_tr_b16 a[160:161], v12 offset:0
    ds_read_b64_tr_b16 a[162:163], v12 offset:1024
    ds_read_b64_tr_b16 a[164:165], v12 offset:20480
    ds_read_b64_tr_b16 a[166:167], v12 offset:21504
    ds_read_b64_tr_b16 a[168:169], v13 offset:0
    ds_read_b64_tr_b16 a[170:171], v13 offset:1024
    ds_read_b64_tr_b16 a[172:173], v13 offset:20480
    ds_read_b64_tr_b16 a[174:175], v13 offset:21504
    s_mov_b32 s58, 0x200000
    s_mov_b32 s59, 0x20000
    s_lshl_b32 s91, s78, 13
    v_lshlrev_b32 v27, 4, v24
    v_lshl_add_u32 v21, v25, 10, v27
    v_lshl_add_u32 v0, v25, 8, v27
    s_add_u32 s64, s8, 46137344
    s_addc_u32 s65, s9, 0
    s_mov_b32 s66, 2359296
    s_mov_b32 s67, 0x20000
    s_lshl_b32 s95, s78, 11
    s_add_u32 s93, s95, 524288
    v_lshlrev_b32 v26, 2, v1
    s_lshl_b32 s94, s78, 8
    s_lshl_b32 s92, s2, 2
    s_add_u32 s92, s92, 589824
    s_cmp_eq_u32 s3, 0
    s_cselect_b32 s92, s92, 3145728
    v_lshlrev_b32 v27, 10, v24
    s_waitcnt vmcnt(0) lgkmcnt(4)
    v_mfma_f32_16x16x32_bf16 a[0:3], a[160:163], a[96:99], 0
    ds_read_b64_tr_b16 a[176:177], v12 offset:2048
    v_mfma_f32_16x16x32_bf16 a[0:3], a[164:167], a[112:115], a[0:3]
    ds_read_b64_tr_b16 a[178:179], v12 offset:3072
    s_add_u32 m0, s46, 61440
    v_mfma_f32_16x16x32_bf16 a[4:7], a[164:167], a[116:119], 0
    buffer_load_dwordx4 v2, s[12:15], s32 offen lds
    v_mfma_f32_16x16x32_bf16 a[4:7], a[160:163], a[100:103], a[4:7]
    s_add_u32 s32, s32, s37
    v_mfma_f32_16x16x32_bf16 a[8:11], a[160:163], a[104:107], 0
    ds_read_b64_tr_b16 a[180:181], v12 offset:22528
    v_mfma_f32_16x16x32_bf16 a[8:11], a[164:167], a[120:123], a[8:11]
    ds_read_b64_tr_b16 a[182:183], v12 offset:23552
    s_add_u32 m0, s46, 62464
    v_mfma_f32_16x16x32_bf16 a[12:15], a[164:167], a[124:127], 0
    buffer_load_dwordx4 v3, s[16:19], s33 offen lds
    v_mfma_f32_16x16x32_bf16 a[12:15], a[160:163], a[108:111], a[12:15]
    s_add_u32 s33, s33, s38
    s_waitcnt lgkmcnt(4)
    v_mfma_f32_16x16x32_bf16 a[28:31], a[168:171], a[108:111], 0
    ds_read_b64_tr_b16 a[184:185], v13 offset:2048
    v_mfma_f32_16x16x32_bf16 a[28:31], a[172:175], a[124:127], a[28:31]
    ds_read_b64_tr_b16 a[186:187], v13 offset:3072
    s_add_u32 m0, s46, 63488
    v_mfma_f32_16x16x32_bf16 a[24:27], a[172:175], a[120:123], 0
    buffer_load_dwordx4 v4, s[20:23], s34 offen lds
    v_mfma_f32_16x16x32_bf16 a[24:27], a[168:171], a[104:107], a[24:27]
    s_add_u32 s34, s34, s39
    v_mfma_f32_16x16x32_bf16 a[20:23], a[168:171], a[100:103], 0
    ds_read_b64_tr_b16 a[188:189], v13 offset:22528
    v_mfma_f32_16x16x32_bf16 a[20:23], a[172:175], a[116:119], a[20:23]
    ds_read_b64_tr_b16 a[190:191], v13 offset:23552
    v_mfma_f32_16x16x32_bf16 a[16:19], a[172:175], a[112:115], 0
    v_mfma_f32_16x16x32_bf16 a[16:19], a[168:171], a[96:99], a[16:19]
    s_waitcnt lgkmcnt(4)
    v_mfma_f32_16x16x32_bf16 a[32:35], a[176:179], a[96:99], 0
    ds_read_b64_tr_b16 a[160:161], v12 offset:4096
    v_mfma_f32_16x16x32_bf16 a[32:35], a[180:183], a[112:115], a[32:35]
    ds_read_b64_tr_b16 a[162:163], v12 offset:5120
    s_add_u32 m0, s46, 64512
    v_mfma_f32_16x16x32_bf16 a[36:39], a[180:183], a[116:119], 0
    buffer_load_dwordx4 v5, s[24:27], s35 offen lds
    v_mfma_f32_16x16x32_bf16 a[36:39], a[176:179], a[100:103], a[36:39]
    s_add_u32 s35, s35, s40
    v_mfma_f32_16x16x32_bf16 a[40:43], a[176:179], a[104:107], 0
    ds_read_b64_tr_b16 a[164:165], v12 offset:24576
    v_mfma_f32_16x16x32_bf16 a[40:43], a[180:183], a[120:123], a[40:43]
    ds_read_b64_tr_b16 a[166:167], v12 offset:25600
    s_add_u32 m0, s46, 65536
    v_mfma_f32_16x16x32_bf16 a[44:47], a[180:183], a[124:127], 0
    buffer_load_dwordx4 v6, s[28:31], s36 offen lds
    v_mfma_f32_16x16x32_bf16 a[44:47], a[176:179], a[108:111], a[44:47]
    s_add_u32 s36, s36, s41
    s_waitcnt lgkmcnt(4)
    v_mfma_f32_16x16x32_bf16 a[60:63], a[184:187], a[108:111], 0
    ds_read_b64_tr_b16 a[168:169], v13 offset:4096
    s_add_u32 s43, s43, 40960
    v_mfma_f32_16x16x32_bf16 a[60:63], a[188:191], a[124:127], a[60:63]
    ds_read_b64_tr_b16 a[170:171], v13 offset:5120
    v_mfma_f32_16x16x32_bf16 a[56:59], a[188:191], a[120:123], 0
    v_mfma_f32_16x16x32_bf16 a[56:59], a[184:187], a[104:107], a[56:59]
    s_cmp_ge_u32 s43, 163840
    s_cselect_b32 s43, 0, s43
    v_mfma_f32_16x16x32_bf16 a[52:55], a[184:187], a[100:103], 0
    ds_read_b64_tr_b16 a[172:173], v13 offset:24576
    v_mfma_f32_16x16x32_bf16 a[52:55], a[188:191], a[116:119], a[52:55]
    ds_read_b64_tr_b16 a[174:175], v13 offset:25600
    v_mfma_f32_16x16x32_bf16 a[48:51], a[188:191], a[112:115], 0
    buffer_load_dwordx4 a[128:131], v7, s[8:11], s42 offen offset:0 sc1
    v_mfma_f32_16x16x32_bf16 a[48:51], a[184:187], a[96:99], a[48:51]
    s_waitcnt lgkmcnt(4)
    v_mfma_f32_16x16x32_bf16 a[64:67], a[96:99], a[160:163], 0
    ds_read_b64_tr_b16 a[176:177], v14 offset:6144
    v_mfma_f32_16x16x32_bf16 a[64:67], a[112:115], a[164:167], a[64:67]
    ds_read_b64_tr_b16 a[178:179], v14 offset:9728
    v_mfma_f32_16x16x32_bf16 a[68:71], a[116:119], a[164:167], 0
    buffer_load_dwordx4 a[132:135], v30, s[8:11], s42 offen offset:0 sc1
    v_mfma_f32_16x16x32_bf16 a[68:71], a[100:103], a[160:163], a[68:71]
    v_mfma_f32_16x16x32_bf16 a[72:75], a[104:107], a[160:163], 0
    ds_read_b64_tr_b16 a[180:181], v14 offset:26624
    v_mfma_f32_16x16x32_bf16 a[72:75], a[120:123], a[164:167], a[72:75]
    ds_read_b64_tr_b16 a[182:183], v14 offset:30208
    v_mfma_f32_16x16x32_bf16 a[76:79], a[124:127], a[164:167], 0
    buffer_load_dwordx4 a[136:139], v7, s[8:11], s42 offen offset:3072 sc1
    v_mfma_f32_16x16x32_bf16 a[76:79], a[108:111], a[160:163], a[76:79]
    s_waitcnt lgkmcnt(4)
    v_mfma_f32_16x16x32_bf16 a[92:95], a[108:111], a[168:171], 0
    ds_read_b64_tr_b16 a[184:185], v14 offset:6176
    v_mfma_f32_16x16x32_bf16 a[92:95], a[124:127], a[172:175], a[92:95]
    ds_read_b64_tr_b16 a[186:187], v14 offset:9760
    v_mfma_f32_16x16x32_bf16 a[88:91], a[120:123], a[172:175], 0
    v_mfma_f32_16x16x32_bf16 a[88:91], a[104:107], a[168:171], a[88:91]
    v_mfma_f32_16x16x32_bf16 a[84:87], a[100:103], a[168:171], 0
    ds_read_b64_tr_b16 a[188:189], v14 offset:26656
    v_mfma_f32_16x16x32_bf16 a[84:87], a[116:119], a[172:175], a[84:87]
    ds_read_b64_tr_b16 a[190:191], v14 offset:30240
    v_mfma_f32_16x16x32_bf16 a[80:83], a[112:115], a[172:175], 0
    buffer_load_dwordx4 a[140:143], v30, s[8:11], s42 offen offset:3072 sc1
    v_mfma_f32_16x16x32_bf16 a[80:83], a[96:99], a[168:171], a[80:83]
    s_add_u32 s42, s42, 196608
    s_waitcnt lgkmcnt(4)
    v_mfma_f32_16x16x32_bf16 v[32:35], a[176:179], a[96:99], 0
    ds_read_b64_tr_b16 a[160:161], v14 offset:6208
    v_mfma_f32_16x16x32_bf16 v[32:35], a[180:183], a[112:115], v[32:35]
    ds_read_b64_tr_b16 a[162:163], v14 offset:9792
    v_mfma_f32_16x16x32_bf16 v[36:39], a[180:183], a[116:119], 0
    buffer_load_dwordx4 a[144:147], v7, s[8:11], s42 offen offset:0 sc1
    v_mfma_f32_16x16x32_bf16 v[36:39], a[176:179], a[100:103], v[36:39]
    v_mfma_f32_16x16x32_bf16 v[40:43], a[176:179], a[104:107], 0
    ds_read_b64_tr_b16 a[164:165], v14 offset:26688
    v_mfma_f32_16x16x32_bf16 v[40:43], a[180:183], a[120:123], v[40:43]
    ds_read_b64_tr_b16 a[166:167], v14 offset:30272
    v_mfma_f32_16x16x32_bf16 v[44:47], a[180:183], a[124:127], 0
    v_mfma_f32_16x16x32_bf16 v[44:47], a[176:179], a[108:111], v[44:47]
    s_waitcnt lgkmcnt(4)
    v_mfma_f32_16x16x32_bf16 v[60:63], a[184:187], a[108:111], 0
    ds_read_b64_tr_b16 a[168:169], v14 offset:6240
    v_mfma_f32_16x16x32_bf16 v[60:63], a[188:191], a[124:127], v[60:63]
    ds_read_b64_tr_b16 a[170:171], v14 offset:9824
    v_mfma_f32_16x16x32_bf16 v[56:59], a[188:191], a[120:123], 0
    buffer_load_dwordx4 a[148:151], v30, s[8:11], s42 offen offset:0 sc1
    v_mfma_f32_16x16x32_bf16 v[56:59], a[184:187], a[104:107], v[56:59]
    v_mfma_f32_16x16x32_bf16 v[52:55], a[184:187], a[100:103], 0
    ds_read_b64_tr_b16 a[172:173], v14 offset:26720
    v_mfma_f32_16x16x32_bf16 v[52:55], a[188:191], a[116:119], v[52:55]
    ds_read_b64_tr_b16 a[174:175], v14 offset:30304
    v_mfma_f32_16x16x32_bf16 v[48:51], a[188:191], a[112:115], 0
    buffer_load_dwordx4 a[152:155], v7, s[8:11], s42 offen offset:3072 sc1
    v_mfma_f32_16x16x32_bf16 v[48:51], a[184:187], a[96:99], v[48:51]
    s_waitcnt lgkmcnt(4)
    v_mfma_f32_16x16x32_bf16 v[64:67], a[160:163], a[96:99], 0
    ds_read_b64_tr_b16 a[176:177], v14 offset:6272
    v_mfma_f32_16x16x32_bf16 v[64:67], a[164:167], a[112:115], v[64:67]
    ds_read_b64_tr_b16 a[178:179], v14 offset:9856
    v_mfma_f32_16x16x32_bf16 v[68:71], a[164:167], a[116:119], 0
    buffer_load_dwordx4 a[156:159], v30, s[8:11], s42 offen offset:3072 sc1
    v_mfma_f32_16x16x32_bf16 v[68:71], a[160:163], a[100:103], v[68:71]
    s_add_u32 s42, s42, 196608
    v_mfma_f32_16x16x32_bf16 v[72:75], a[160:163], a[104:107], 0
    ds_read_b64_tr_b16 a[180:181], v14 offset:26752
    v_mfma_f32_16x16x32_bf16 v[72:75], a[164:167], a[120:123], v[72:75]
    ds_read_b64_tr_b16 a[182:183], v14 offset:30336
    v_mfma_f32_16x16x32_bf16 v[76:79], a[164:167], a[124:127], 0
    v_mfma_f32_16x16x32_bf16 v[76:79], a[160:163], a[108:111], v[76:79]
    s_waitcnt lgkmcnt(4)
    v_mfma_f32_16x16x32_bf16 v[92:95], a[168:171], a[108:111], 0
    ds_read_b64_tr_b16 a[184:185], v14 offset:6304
    v_mfma_f32_16x16x32_bf16 v[92:95], a[172:175], a[124:127], v[92:95]
    ds_read_b64_tr_b16 a[186:187], v14 offset:9888
    s_add_u32 m0, s46, 81920
    v_mfma_f32_16x16x32_bf16 v[88:91], a[172:175], a[120:123], 0
    buffer_load_dwordx4 v2, s[12:15], s32 offen lds
    v_mfma_f32_16x16x32_bf16 v[88:91], a[168:171], a[104:107], v[88:91]
    s_add_u32 s32, s32, s37
    v_mfma_f32_16x16x32_bf16 v[84:87], a[168:171], a[100:103], 0
    ds_read_b64_tr_b16 a[188:189], v14 offset:26784
    v_mfma_f32_16x16x32_bf16 v[84:87], a[172:175], a[116:119], v[84:87]
    ds_read_b64_tr_b16 a[190:191], v14 offset:30368
    v_mfma_f32_16x16x32_bf16 v[80:83], a[172:175], a[112:115], 0
    v_mfma_f32_16x16x32_bf16 v[80:83], a[168:171], a[96:99], v[80:83]
    s_waitcnt lgkmcnt(4)
    v_mfma_f32_16x16x32_bf16 v[96:99], a[176:179], a[96:99], 0
    ds_read_b64_tr_b16 a[160:161], v14 offset:6336
    v_mfma_f32_16x16x32_bf16 v[96:99], a[180:183], a[112:115], v[96:99]
    ds_read_b64_tr_b16 a[162:163], v14 offset:9920
    s_add_u32 m0, s46, 82944
    v_mfma_f32_16x16x32_bf16 v[100:103], a[180:183], a[116:119], 0
    buffer_load_dwordx4 v3, s[16:19], s33 offen lds
    v_mfma_f32_16x16x32_bf16 v[100:103], a[176:179], a[100:103], v[100:103]
    s_add_u32 s33, s33, s38
    v_mfma_f32_16x16x32_bf16 v[104:107], a[176:179], a[104:107], 0
    ds_read_b64_tr_b16 a[164:165], v14 offset:26816
    v_mfma_f32_16x16x32_bf16 v[104:107], a[180:183], a[120:123], v[104:107]
    ds_read_b64_tr_b16 a[166:167], v14 offset:30400
    v_mfma_f32_16x16x32_bf16 v[108:111], a[180:183], a[124:127], 0
    v_mfma_f32_16x16x32_bf16 v[108:111], a[176:179], a[108:111], v[108:111]
    s_waitcnt lgkmcnt(4)
    v_mfma_f32_16x16x32_bf16 v[124:127], a[184:187], a[108:111], 0
    ds_read_b64_tr_b16 a[168:169], v14 offset:13312
    v_mfma_f32_16x16x32_bf16 v[124:127], a[188:191], a[124:127], v[124:127]
    ds_read_b64_tr_b16 a[170:171], v14 offset:16896
    s_add_u32 m0, s46, 83968
    v_mfma_f32_16x16x32_bf16 v[120:123], a[188:191], a[120:123], 0
    buffer_load_dwordx4 v4, s[20:23], s34 offen lds
    v_mfma_f32_16x16x32_bf16 v[120:123], a[184:187], a[104:107], v[120:123]
    s_add_u32 s34, s34, s39
    v_mfma_f32_16x16x32_bf16 v[116:119], a[184:187], a[100:103], 0
    ds_read_b64_tr_b16 a[172:173], v14 offset:33792
    v_mfma_f32_16x16x32_bf16 v[116:119], a[188:191], a[116:119], v[116:119]
    ds_read_b64_tr_b16 a[174:175], v14 offset:37376
    v_mfma_f32_16x16x32_bf16 v[112:115], a[188:191], a[112:115], 0
    v_mfma_f32_16x16x32_bf16 v[112:115], a[184:187], a[96:99], v[112:115]
    s_waitcnt lgkmcnt(4)
    v_mfma_f32_16x16x32_bf16 v[128:131], a[160:163], a[96:99], 0
    ds_read_b64_tr_b16 a[176:177], v14 offset:13344
    v_mfma_f32_16x16x32_bf16 v[128:131], a[164:167], a[112:115], v[128:131]
    ds_read_b64_tr_b16 a[178:179], v14 offset:16928
    s_add_u32 m0, s46, 84992
    v_mfma_f32_16x16x32_bf16 v[132:135], a[164:167], a[116:119], 0
    buffer_load_dwordx4 v5, s[24:27], s35 offen lds
    v_mfma_f32_16x16x32_bf16 v[132:135], a[160:163], a[100:103], v[132:135]
    s_add_u32 s35, s35, s40
    v_mfma_f32_16x16x32_bf16 v[136:139], a[160:163], a[104:107], 0
    ds_read_b64_tr_b16 a[180:181], v14 offset:33824
    v_mfma_f32_16x16x32_bf16 v[136:139], a[164:167], a[120:123], v[136:139]
    ds_read_b64_tr_b16 a[182:183], v14 offset:37408
    v_mfma_f32_16x16x32_bf16 v[140:143], a[164:167], a[124:127], 0
    v_mfma_f32_16x16x32_bf16 v[140:143], a[160:163], a[108:111], v[140:143]
    s_waitcnt lgkmcnt(4)
    v_mfma_f32_16x16x32_bf16 v[156:159], a[168:171], a[108:111], 0
    ds_read_b64_tr_b16 a[184:185], v14 offset:13376
    v_mfma_f32_16x16x32_bf16 v[156:159], a[172:175], a[124:127], v[156:159]
    ds_read_b64_tr_b16 a[186:187], v14 offset:16960
    s_add_u32 m0, s46, 86016
    v_mfma_f32_16x16x32_bf16 v[152:155], a[172:175], a[120:123], 0
    buffer_load_dwordx4 v6, s[28:31], s36 offen lds
    v_mfma_f32_16x16x32_bf16 v[152:155], a[168:171], a[104:107], v[152:155]
    s_add_u32 s36, s36, s41
    v_mfma_f32_16x16x32_bf16 v[148:151], a[168:171], a[100:103], 0
    ds_read_b64_tr_b16 a[188:189], v14 offset:33856
    v_mfma_f32_16x16x32_bf16 v[148:151], a[172:175], a[116:119], v[148:151]
    ds_read_b64_tr_b16 a[190:191], v14 offset:37440
    v_mfma_f32_16x16x32_bf16 v[144:147], a[172:175], a[112:115], 0
    v_mfma_f32_16x16x32_bf16 v[144:147], a[168:171], a[96:99], v[144:147]
    s_waitcnt lgkmcnt(4)
    v_mfma_f32_16x16x32_bf16 v[160:163], a[176:179], a[96:99], 0
    ds_read_b64_tr_b16 a[160:161], v14 offset:13408
    v_mfma_f32_16x16x32_bf16 v[160:163], a[180:183], a[112:115], v[160:163]
    ds_read_b64_tr_b16 a[162:163], v14 offset:16992
    s_add_u32 m0, s46, 102400
    v_mfma_f32_16x16x32_bf16 v[164:167], a[180:183], a[116:119], 0
    buffer_load_dwordx4 v2, s[12:15], s32 offen lds
    v_mfma_f32_16x16x32_bf16 v[164:167], a[176:179], a[100:103], v[164:167]
    s_add_u32 s32, s32, s37
    v_mfma_f32_16x16x32_bf16 v[168:171], a[176:179], a[104:107], 0
    ds_read_b64_tr_b16 a[164:165], v14 offset:33888
    v_mfma_f32_16x16x32_bf16 v[168:171], a[180:183], a[120:123], v[168:171]
    ds_read_b64_tr_b16 a[166:167], v14 offset:37472
    v_mfma_f32_16x16x32_bf16 v[172:175], a[180:183], a[124:127], 0
    v_mfma_f32_16x16x32_bf16 v[172:175], a[176:179], a[108:111], v[172:175]
    s_waitcnt lgkmcnt(4)
    v_mfma_f32_16x16x32_bf16 v[188:191], a[184:187], a[108:111], 0
    ds_read_b64_tr_b16 a[168:169], v14 offset:13440
    v_mfma_f32_16x16x32_bf16 v[188:191], a[188:191], a[124:127], v[188:191]
    ds_read_b64_tr_b16 a[170:171], v14 offset:17024
    s_add_u32 m0, s46, 103424
    v_mfma_f32_16x16x32_bf16 v[184:187], a[188:191], a[120:123], 0
    buffer_load_dwordx4 v3, s[16:19], s33 offen lds
    v_mfma_f32_16x16x32_bf16 v[184:187], a[184:187], a[104:107], v[184:187]
    s_add_u32 s33, s33, s38
    v_mfma_f32_16x16x32_bf16 v[180:183], a[184:187], a[100:103], 0
    ds_read_b64_tr_b16 a[172:173], v14 offset:33920
    v_mfma_f32_16x16x32_bf16 v[180:183], a[188:191], a[116:119], v[180:183]
    ds_read_b64_tr_b16 a[174:175], v14 offset:37504
    v_mfma_f32_16x16x32_bf16 v[176:179], a[188:191], a[112:115], 0
recurrent_scan__sliding_local_dilated__swiglu_ffn__prompt_kernel_w1:
    s_cbranch_execz recurrent_scan__sliding_local_dilated__swiglu_ffn__prompt_kernel_w5
    v_mfma_f32_16x16x32_bf16 v[176:179], a[184:187], a[96:99], v[176:179]
    s_waitcnt lgkmcnt(4)
    v_mfma_f32_16x16x32_bf16 v[192:195], a[160:163], a[96:99], 0
    ds_read_b64_tr_b16 a[176:177], v14 offset:13472
    v_mfma_f32_16x16x32_bf16 v[192:195], a[164:167], a[112:115], v[192:195]
    ds_read_b64_tr_b16 a[178:179], v14 offset:17056
    s_add_u32 m0, s46, 104448
    v_mfma_f32_16x16x32_bf16 v[196:199], a[164:167], a[116:119], 0
    buffer_load_dwordx4 v4, s[20:23], s34 offen lds
    v_mfma_f32_16x16x32_bf16 v[196:199], a[160:163], a[100:103], v[196:199]
    s_add_u32 s34, s34, s39
    v_mfma_f32_16x16x32_bf16 v[200:203], a[160:163], a[104:107], 0
    ds_read_b64_tr_b16 a[180:181], v14 offset:33952
    v_mfma_f32_16x16x32_bf16 v[200:203], a[164:167], a[120:123], v[200:203]
    ds_read_b64_tr_b16 a[182:183], v14 offset:37536
    v_mfma_f32_16x16x32_bf16 v[204:207], a[164:167], a[124:127], 0
    v_mfma_f32_16x16x32_bf16 v[204:207], a[160:163], a[108:111], v[204:207]
    s_waitcnt lgkmcnt(4)
    v_mfma_f32_16x16x32_bf16 v[220:223], a[168:171], a[108:111], 0
    ds_read_b64_tr_b16 a[184:185], v14 offset:13504
    v_mfma_f32_16x16x32_bf16 v[220:223], a[172:175], a[124:127], v[220:223]
    ds_read_b64_tr_b16 a[186:187], v14 offset:17088
    s_add_u32 m0, s46, 105472
    v_mfma_f32_16x16x32_bf16 v[216:219], a[172:175], a[120:123], 0
    buffer_load_dwordx4 v5, s[24:27], s35 offen lds
    v_mfma_f32_16x16x32_bf16 v[216:219], a[168:171], a[104:107], v[216:219]
    s_add_u32 s35, s35, s40
    v_mfma_f32_16x16x32_bf16 v[212:215], a[168:171], a[100:103], 0
    ds_read_b64_tr_b16 a[188:189], v14 offset:33984
    v_mfma_f32_16x16x32_bf16 v[212:215], a[172:175], a[116:119], v[212:215]
    ds_read_b64_tr_b16 a[190:191], v14 offset:37568
    v_mfma_f32_16x16x32_bf16 v[208:211], a[172:175], a[112:115], 0
    v_add_u32 v12, s43, v9
    v_add_u32 v13, s43, v10
    v_mfma_f32_16x16x32_bf16 v[208:211], a[168:171], a[96:99], v[208:211]
    v_add_u32 v14, s43, v11
    s_waitcnt lgkmcnt(4)
    v_mfma_f32_16x16x32_bf16 v[224:227], a[176:179], a[96:99], 0
    s_waitcnt vmcnt(17)
    s_barrier
    ds_read_b64_tr_b16 a[160:161], v12 offset:0
    v_mfma_f32_16x16x32_bf16 v[224:227], a[180:183], a[112:115], v[224:227]
    ds_read_b64_tr_b16 a[162:163], v12 offset:1024
    s_add_u32 m0, s46, 106496
    v_mfma_f32_16x16x32_bf16 v[228:231], a[180:183], a[116:119], 0
    buffer_load_dwordx4 v6, s[28:31], s36 offen lds
    v_mfma_f32_16x16x32_bf16 v[228:231], a[176:179], a[100:103], v[228:231]
    s_add_u32 s36, s36, s41
    v_mfma_f32_16x16x32_bf16 v[232:235], a[176:179], a[104:107], 0
    ds_read_b64_tr_b16 a[164:165], v12 offset:20480
    v_mfma_f32_16x16x32_bf16 v[232:235], a[180:183], a[120:123], v[232:235]
    ds_read_b64_tr_b16 a[166:167], v12 offset:21504
    v_mfma_f32_16x16x32_bf16 v[236:239], a[180:183], a[124:127], 0
    v_mfma_f32_16x16x32_bf16 v[236:239], a[176:179], a[108:111], v[236:239]
    s_waitcnt lgkmcnt(4)
    v_mfma_f32_16x16x32_bf16 v[252:255], a[184:187], a[108:111], 0
    ds_read_b64_tr_b16 a[168:169], v13 offset:0
    v_mfma_f32_16x16x32_bf16 v[252:255], a[188:191], a[124:127], v[252:255]
    ds_read_b64_tr_b16 a[170:171], v13 offset:1024
    v_mfma_f32_16x16x32_bf16 v[248:251], a[188:191], a[120:123], 0
    s_bitcmp1_b32 s68, 0
    s_cselect_b32 s86, s69, 0
    v_mfma_f32_16x16x32_bf16 v[248:251], a[184:187], a[104:107], v[248:251]
    buffer_load_dwordx4 a[200:203], v21, s[60:63], s91 offen offset:384
    buffer_load_dwordx4 a[204:207], v21, s[56:59], s91 offen offset:384
    buffer_load_dword a210, v8, s[84:87], s89 offen
    s_add_u32 s89, s89, s88
    v_mfma_f32_16x16x32_bf16 v[244:247], a[184:187], a[100:103], 0
    ds_read_b64_tr_b16 a[172:173], v13 offset:20480
    v_mfma_f32_16x16x32_bf16 v[244:247], a[188:191], a[116:119], v[244:247]
    ds_read_b64_tr_b16 a[174:175], v13 offset:21504
    v_mfma_f32_16x16x32_bf16 v[240:243], a[188:191], a[112:115], 0
    v_mfma_f32_16x16x32_bf16 v[240:243], a[184:187], a[96:99], v[240:243]
    s_waitcnt vmcnt(13) lgkmcnt(4)
    v_mfma_f32_16x16x32_bf16 a[0:3], a[160:163], a[128:131], a[0:3]
    ds_read_b64_tr_b16 a[176:177], v12 offset:2048
    v_mfma_f32_16x16x32_bf16 a[0:3], a[164:167], a[144:147], a[0:3]
    ds_read_b64_tr_b16 a[178:179], v12 offset:3072
    v_mfma_f32_16x16x32_bf16 a[4:7], a[164:167], a[148:151], a[4:7]
    v_mfma_f32_16x16x32_bf16 a[4:7], a[160:163], a[132:135], a[4:7]
    v_mfma_f32_16x16x32_bf16 a[8:11], a[160:163], a[136:139], a[8:11]
    ds_read_b64_tr_b16 a[180:181], v12 offset:22528
    v_mfma_f32_16x16x32_bf16 a[8:11], a[164:167], a[152:155], a[8:11]
    ds_read_b64_tr_b16 a[182:183], v12 offset:23552
    v_mfma_f32_16x16x32_bf16 a[12:15], a[164:167], a[156:159], a[12:15]
    buffer_load_dwordx4 a[96:99], v7, s[8:11], s42 offen offset:0 sc1
    v_mfma_f32_16x16x32_bf16 a[12:15], a[160:163], a[140:143], a[12:15]
    s_waitcnt lgkmcnt(4)
    v_mfma_f32_16x16x32_bf16 a[28:31], a[168:171], a[140:143], a[28:31]
    ds_read_b64_tr_b16 a[184:185], v13 offset:2048
    v_mfma_f32_16x16x32_bf16 a[28:31], a[172:175], a[156:159], a[28:31]
    ds_read_b64_tr_b16 a[186:187], v13 offset:3072
    v_mfma_f32_16x16x32_bf16 a[24:27], a[172:175], a[152:155], a[24:27]
    v_mfma_f32_16x16x32_bf16 a[24:27], a[168:171], a[136:139], a[24:27]
    v_mfma_f32_16x16x32_bf16 a[20:23], a[168:171], a[132:135], a[20:23]
    ds_read_b64_tr_b16 a[188:189], v13 offset:22528
    v_mfma_f32_16x16x32_bf16 a[20:23], a[172:175], a[148:151], a[20:23]
    ds_read_b64_tr_b16 a[190:191], v13 offset:23552
    v_mfma_f32_16x16x32_bf16 a[16:19], a[172:175], a[144:147], a[16:19]
    buffer_load_dwordx4 a[100:103], v30, s[8:11], s42 offen offset:0 sc1
    v_mfma_f32_16x16x32_bf16 a[16:19], a[168:171], a[128:131], a[16:19]
    s_waitcnt lgkmcnt(4)
    v_mfma_f32_16x16x32_bf16 a[32:35], a[176:179], a[128:131], a[32:35]
    ds_read_b64_tr_b16 a[160:161], v12 offset:4096
    v_mfma_f32_16x16x32_bf16 a[32:35], a[180:183], a[144:147], a[32:35]
    ds_read_b64_tr_b16 a[162:163], v12 offset:5120
    v_mfma_f32_16x16x32_bf16 a[36:39], a[180:183], a[148:151], a[36:39]
    v_mfma_f32_16x16x32_bf16 a[36:39], a[176:179], a[132:135], a[36:39]
    v_mfma_f32_16x16x32_bf16 a[40:43], a[176:179], a[136:139], a[40:43]
    ds_read_b64_tr_b16 a[164:165], v12 offset:24576
    v_mfma_f32_16x16x32_bf16 a[40:43], a[180:183], a[152:155], a[40:43]
    ds_read_b64_tr_b16 a[166:167], v12 offset:25600
    v_mfma_f32_16x16x32_bf16 a[44:47], a[180:183], a[156:159], a[44:47]
    buffer_load_dwordx4 a[104:107], v7, s[8:11], s42 offen offset:3072 sc1
    v_mfma_f32_16x16x32_bf16 a[44:47], a[176:179], a[140:143], a[44:47]
    s_waitcnt lgkmcnt(4)
    v_mfma_f32_16x16x32_bf16 a[60:63], a[184:187], a[140:143], a[60:63]
    ds_read_b64_tr_b16 a[168:169], v13 offset:4096
    s_add_u32 s43, s43, 40960
    v_mfma_f32_16x16x32_bf16 a[60:63], a[188:191], a[156:159], a[60:63]
    ds_read_b64_tr_b16 a[170:171], v13 offset:5120
    v_mfma_f32_16x16x32_bf16 a[56:59], a[188:191], a[152:155], a[56:59]
    v_mfma_f32_16x16x32_bf16 a[56:59], a[184:187], a[136:139], a[56:59]
    s_cmp_ge_u32 s43, 163840
    s_cselect_b32 s43, 0, s43
    v_mfma_f32_16x16x32_bf16 a[52:55], a[184:187], a[132:135], a[52:55]
    ds_read_b64_tr_b16 a[172:173], v13 offset:24576
    v_mfma_f32_16x16x32_bf16 a[52:55], a[188:191], a[148:151], a[52:55]
    ds_read_b64_tr_b16 a[174:175], v13 offset:25600
    v_mfma_f32_16x16x32_bf16 a[48:51], a[188:191], a[144:147], a[48:51]
    buffer_load_dwordx4 a[108:111], v30, s[8:11], s42 offen offset:3072 sc1
    v_mfma_f32_16x16x32_bf16 a[48:51], a[184:187], a[128:131], a[48:51]
    s_add_u32 s42, s42, 196608
    s_waitcnt lgkmcnt(4)
    v_mfma_f32_16x16x32_bf16 a[64:67], a[128:131], a[160:163], a[64:67]
    ds_read_b64_tr_b16 a[176:177], v14 offset:6144
    v_mfma_f32_16x16x32_bf16 a[64:67], a[144:147], a[164:167], a[64:67]
    ds_read_b64_tr_b16 a[178:179], v14 offset:9728
    v_mfma_f32_16x16x32_bf16 a[68:71], a[148:151], a[164:167], a[68:71]
    v_mfma_f32_16x16x32_bf16 a[68:71], a[132:135], a[160:163], a[68:71]
    s_add_u32 s44, s46, 122880
    v_mfma_f32_16x16x32_bf16 a[72:75], a[136:139], a[160:163], a[72:75]
    ds_read_b64_tr_b16 a[180:181], v14 offset:26624
    v_mfma_f32_16x16x32_bf16 a[72:75], a[152:155], a[164:167], a[72:75]
    ds_read_b64_tr_b16 a[182:183], v14 offset:30208
    v_mfma_f32_16x16x32_bf16 a[76:79], a[156:159], a[164:167], a[76:79]
    buffer_load_dwordx4 a[112:115], v7, s[8:11], s42 offen offset:0 sc1
    v_mfma_f32_16x16x32_bf16 a[76:79], a[140:143], a[160:163], a[76:79]
    s_waitcnt lgkmcnt(4)
    v_mfma_f32_16x16x32_bf16 a[92:95], a[140:143], a[168:171], a[92:95]
    ds_read_b64_tr_b16 a[184:185], v14 offset:6176
    v_mfma_f32_16x16x32_bf16 a[92:95], a[156:159], a[172:175], a[92:95]
    ds_read_b64_tr_b16 a[186:187], v14 offset:9760
    v_mfma_f32_16x16x32_bf16 a[88:91], a[152:155], a[172:175], a[88:91]
    v_mfma_f32_16x16x32_bf16 a[88:91], a[136:139], a[168:171], a[88:91]
    buffer_store_dword v23, v26, s[80:83], s94 offen sc0 sc1
    v_mfma_f32_16x16x32_bf16 a[84:87], a[132:135], a[168:171], a[84:87]
    ds_read_b64_tr_b16 a[188:189], v14 offset:26656
    v_mfma_f32_16x16x32_bf16 a[84:87], a[148:151], a[172:175], a[84:87]
    ds_read_b64_tr_b16 a[190:191], v14 offset:30240
    v_mfma_f32_16x16x32_bf16 a[80:83], a[144:147], a[172:175], a[80:83]
    buffer_load_dwordx4 a[116:119], v30, s[8:11], s42 offen offset:0 sc1
    v_mfma_f32_16x16x32_bf16 a[80:83], a[128:131], a[168:171], a[80:83]
    s_waitcnt lgkmcnt(4)
    v_mfma_f32_16x16x32_bf16 v[32:35], a[176:179], a[128:131], v[32:35]
    ds_read_b64_tr_b16 a[160:161], v14 offset:6208
    v_mfma_f32_16x16x32_bf16 v[32:35], a[180:183], a[144:147], v[32:35]
    ds_read_b64_tr_b16 a[162:163], v14 offset:9792
    v_mfma_f32_16x16x32_bf16 v[36:39], a[180:183], a[148:151], v[36:39]
    v_mfma_f32_16x16x32_bf16 v[36:39], a[176:179], a[132:135], v[36:39]
    v_mfma_f32_16x16x32_bf16 v[40:43], a[176:179], a[136:139], v[40:43]
    ds_read_b64_tr_b16 a[164:165], v14 offset:26688
    v_mfma_f32_16x16x32_bf16 v[40:43], a[180:183], a[152:155], v[40:43]
    ds_read_b64_tr_b16 a[166:167], v14 offset:30272
    v_mfma_f32_16x16x32_bf16 v[44:47], a[180:183], a[156:159], v[44:47]
    buffer_load_dwordx4 a[120:123], v7, s[8:11], s42 offen offset:3072 sc1
    v_mfma_f32_16x16x32_bf16 v[44:47], a[176:179], a[140:143], v[44:47]
    s_waitcnt lgkmcnt(4)
    v_mfma_f32_16x16x32_bf16 v[60:63], a[184:187], a[140:143], v[60:63]
    ds_read_b64_tr_b16 a[168:169], v14 offset:6240
    v_mfma_f32_16x16x32_bf16 v[60:63], a[188:191], a[156:159], v[60:63]
    ds_read_b64_tr_b16 a[170:171], v14 offset:9824
    v_mfma_f32_16x16x32_bf16 v[56:59], a[188:191], a[152:155], v[56:59]
    v_mfma_f32_16x16x32_bf16 v[56:59], a[184:187], a[136:139], v[56:59]
    v_mfma_f32_16x16x32_bf16 v[52:55], a[184:187], a[132:135], v[52:55]
    ds_read_b64_tr_b16 a[172:173], v14 offset:26720
    v_mfma_f32_16x16x32_bf16 v[52:55], a[188:191], a[148:151], v[52:55]
    ds_read_b64_tr_b16 a[174:175], v14 offset:30304
    v_mfma_f32_16x16x32_bf16 v[48:51], a[188:191], a[144:147], v[48:51]
    buffer_load_dwordx4 a[124:127], v30, s[8:11], s42 offen offset:3072 sc1
    v_mfma_f32_16x16x32_bf16 v[48:51], a[184:187], a[128:131], v[48:51]
    s_add_u32 s42, s42, 196608
    s_waitcnt lgkmcnt(4)
    v_mfma_f32_16x16x32_bf16 v[64:67], a[160:163], a[128:131], v[64:67]
    ds_read_b64_tr_b16 a[176:177], v14 offset:6272
    v_mfma_f32_16x16x32_bf16 v[64:67], a[164:167], a[144:147], v[64:67]
    ds_read_b64_tr_b16 a[178:179], v14 offset:9856
    v_mfma_f32_16x16x32_bf16 v[68:71], a[164:167], a[148:151], v[68:71]
    v_mfma_f32_16x16x32_bf16 v[68:71], a[160:163], a[132:135], v[68:71]
    v_mfma_f32_16x16x32_bf16 v[72:75], a[160:163], a[136:139], v[72:75]
    ds_read_b64_tr_b16 a[180:181], v14 offset:26752
    v_mfma_f32_16x16x32_bf16 v[72:75], a[164:167], a[152:155], v[72:75]
    ds_read_b64_tr_b16 a[182:183], v14 offset:30336
    v_mfma_f32_16x16x32_bf16 v[76:79], a[164:167], a[156:159], v[76:79]
    v_mfma_f32_16x16x32_bf16 v[76:79], a[160:163], a[140:143], v[76:79]
    s_waitcnt lgkmcnt(4)
    v_mfma_f32_16x16x32_bf16 v[92:95], a[168:171], a[140:143], v[92:95]
    ds_read_b64_tr_b16 a[184:185], v14 offset:6304
    v_mfma_f32_16x16x32_bf16 v[92:95], a[172:175], a[156:159], v[92:95]
    ds_read_b64_tr_b16 a[186:187], v14 offset:9888
    s_add_u32 m0, s46, 122880
    v_mfma_f32_16x16x32_bf16 v[88:91], a[172:175], a[152:155], v[88:91]
    buffer_load_dwordx4 v2, s[12:15], s32 offen lds
    v_mfma_f32_16x16x32_bf16 v[88:91], a[168:171], a[136:139], v[88:91]
    s_add_u32 s32, s32, s37
    v_mfma_f32_16x16x32_bf16 v[84:87], a[168:171], a[132:135], v[84:87]
    ds_read_b64_tr_b16 a[188:189], v14 offset:26784
    v_mfma_f32_16x16x32_bf16 v[84:87], a[172:175], a[148:151], v[84:87]
    ds_read_b64_tr_b16 a[190:191], v14 offset:30368
    v_mfma_f32_16x16x32_bf16 v[80:83], a[172:175], a[144:147], v[80:83]
    v_mfma_f32_16x16x32_bf16 v[80:83], a[168:171], a[128:131], v[80:83]
    s_waitcnt lgkmcnt(4)
    v_mfma_f32_16x16x32_bf16 v[96:99], a[176:179], a[128:131], v[96:99]
    ds_read_b64_tr_b16 a[160:161], v14 offset:6336
    v_mfma_f32_16x16x32_bf16 v[96:99], a[180:183], a[144:147], v[96:99]
    ds_read_b64_tr_b16 a[162:163], v14 offset:9920
    s_add_u32 m0, s46, 123904
    v_mfma_f32_16x16x32_bf16 v[100:103], a[180:183], a[148:151], v[100:103]
    buffer_load_dwordx4 v3, s[16:19], s33 offen lds
    v_mfma_f32_16x16x32_bf16 v[100:103], a[176:179], a[132:135], v[100:103]
    s_add_u32 s33, s33, s38
    v_mfma_f32_16x16x32_bf16 v[104:107], a[176:179], a[136:139], v[104:107]
    ds_read_b64_tr_b16 a[164:165], v14 offset:26816
    v_mfma_f32_16x16x32_bf16 v[104:107], a[180:183], a[152:155], v[104:107]
    ds_read_b64_tr_b16 a[166:167], v14 offset:30400
    v_mfma_f32_16x16x32_bf16 v[108:111], a[180:183], a[156:159], v[108:111]
    v_mfma_f32_16x16x32_bf16 v[108:111], a[176:179], a[140:143], v[108:111]
    s_waitcnt lgkmcnt(4)
    v_mfma_f32_16x16x32_bf16 v[124:127], a[184:187], a[140:143], v[124:127]
    ds_read_b64_tr_b16 a[168:169], v14 offset:13312
    v_mfma_f32_16x16x32_bf16 v[124:127], a[188:191], a[156:159], v[124:127]
    ds_read_b64_tr_b16 a[170:171], v14 offset:16896
    s_add_u32 m0, s46, 124928
    v_mfma_f32_16x16x32_bf16 v[120:123], a[188:191], a[152:155], v[120:123]
    buffer_load_dwordx4 v4, s[20:23], s34 offen lds
    v_mfma_f32_16x16x32_bf16 v[120:123], a[184:187], a[136:139], v[120:123]
    s_add_u32 s34, s34, s39
    v_mfma_f32_16x16x32_bf16 v[116:119], a[184:187], a[132:135], v[116:119]
    ds_read_b64_tr_b16 a[172:173], v14 offset:33792
    v_mfma_f32_16x16x32_bf16 v[116:119], a[188:191], a[148:151], v[116:119]
    ds_read_b64_tr_b16 a[174:175], v14 offset:37376
    v_mfma_f32_16x16x32_bf16 v[112:115], a[188:191], a[144:147], v[112:115]
    v_mfma_f32_16x16x32_bf16 v[112:115], a[184:187], a[128:131], v[112:115]
    s_waitcnt lgkmcnt(4)
    v_mfma_f32_16x16x32_bf16 v[128:131], a[160:163], a[128:131], v[128:131]
    ds_read_b64_tr_b16 a[176:177], v14 offset:13344
    v_mfma_f32_16x16x32_bf16 v[128:131], a[164:167], a[144:147], v[128:131]
    ds_read_b64_tr_b16 a[178:179], v14 offset:16928
    s_add_u32 m0, s46, 125952
    v_mfma_f32_16x16x32_bf16 v[132:135], a[164:167], a[148:151], v[132:135]
    buffer_load_dwordx4 v5, s[24:27], s35 offen lds
    v_mfma_f32_16x16x32_bf16 v[132:135], a[160:163], a[132:135], v[132:135]
    s_add_u32 s35, s35, s40
    v_mfma_f32_16x16x32_bf16 v[136:139], a[160:163], a[136:139], v[136:139]
    ds_read_b64_tr_b16 a[180:181], v14 offset:33824
    v_mfma_f32_16x16x32_bf16 v[136:139], a[164:167], a[152:155], v[136:139]
    ds_read_b64_tr_b16 a[182:183], v14 offset:37408
    v_mfma_f32_16x16x32_bf16 v[140:143], a[164:167], a[156:159], v[140:143]
    v_mfma_f32_16x16x32_bf16 v[140:143], a[160:163], a[140:143], v[140:143]
    s_waitcnt lgkmcnt(4)
    v_mfma_f32_16x16x32_bf16 v[156:159], a[168:171], a[140:143], v[156:159]
    ds_read_b64_tr_b16 a[184:185], v14 offset:13376
    v_mfma_f32_16x16x32_bf16 v[156:159], a[172:175], a[156:159], v[156:159]
    ds_read_b64_tr_b16 a[186:187], v14 offset:16960
    s_add_u32 m0, s46, 126976
    v_mfma_f32_16x16x32_bf16 v[152:155], a[172:175], a[152:155], v[152:155]
    buffer_load_dwordx4 v6, s[28:31], s36 offen lds
    v_mfma_f32_16x16x32_bf16 v[152:155], a[168:171], a[136:139], v[152:155]
    s_add_u32 s36, s36, s41
    v_mfma_f32_16x16x32_bf16 v[148:151], a[168:171], a[132:135], v[148:151]
    ds_read_b64_tr_b16 a[188:189], v14 offset:33856
    v_mfma_f32_16x16x32_bf16 v[148:151], a[172:175], a[148:151], v[148:151]
    ds_read_b64_tr_b16 a[190:191], v14 offset:37440
    v_mfma_f32_16x16x32_bf16 v[144:147], a[172:175], a[144:147], v[144:147]
    v_mfma_f32_16x16x32_bf16 v[144:147], a[168:171], a[128:131], v[144:147]
    s_waitcnt lgkmcnt(4)
    v_mfma_f32_16x16x32_bf16 v[160:163], a[176:179], a[128:131], v[160:163]
    ds_read_b64_tr_b16 a[160:161], v14 offset:13408
    v_mfma_f32_16x16x32_bf16 v[160:163], a[180:183], a[144:147], v[160:163]
    ds_read_b64_tr_b16 a[162:163], v14 offset:16992
    s_add_u32 m0, s46, 143360
    v_mfma_f32_16x16x32_bf16 v[164:167], a[180:183], a[148:151], v[164:167]
    buffer_load_dwordx4 v2, s[12:15], s32 offen lds
    v_mfma_f32_16x16x32_bf16 v[164:167], a[176:179], a[132:135], v[164:167]
    s_add_u32 s32, s32, s37
    v_mfma_f32_16x16x32_bf16 v[168:171], a[176:179], a[136:139], v[168:171]
    ds_read_b64_tr_b16 a[164:165], v14 offset:33888
    v_mfma_f32_16x16x32_bf16 v[168:171], a[180:183], a[152:155], v[168:171]
    ds_read_b64_tr_b16 a[166:167], v14 offset:37472
    v_mfma_f32_16x16x32_bf16 v[172:175], a[180:183], a[156:159], v[172:175]
    v_mfma_f32_16x16x32_bf16 v[172:175], a[176:179], a[140:143], v[172:175]
    s_waitcnt lgkmcnt(4)
    v_mfma_f32_16x16x32_bf16 v[188:191], a[184:187], a[140:143], v[188:191]
    ds_read_b64_tr_b16 a[168:169], v14 offset:13440
    v_mfma_f32_16x16x32_bf16 v[188:191], a[188:191], a[156:159], v[188:191]
    ds_read_b64_tr_b16 a[170:171], v14 offset:17024
    s_add_u32 m0, s46, 144384
    v_mfma_f32_16x16x32_bf16 v[184:187], a[188:191], a[152:155], v[184:187]
    buffer_load_dwordx4 v3, s[16:19], s33 offen lds
    v_mfma_f32_16x16x32_bf16 v[184:187], a[184:187], a[136:139], v[184:187]
    s_add_u32 s33, s33, s38
    v_mfma_f32_16x16x32_bf16 v[180:183], a[184:187], a[132:135], v[180:183]
    ds_read_b64_tr_b16 a[172:173], v14 offset:33920
    v_mfma_f32_16x16x32_bf16 v[180:183], a[188:191], a[148:151], v[180:183]
    ds_read_b64_tr_b16 a[174:175], v14 offset:37504
    v_mfma_f32_16x16x32_bf16 v[176:179], a[188:191], a[144:147], v[176:179]
    v_mfma_f32_16x16x32_bf16 v[176:179], a[184:187], a[128:131], v[176:179]
    s_waitcnt lgkmcnt(4)
    v_mfma_f32_16x16x32_bf16 v[192:195], a[160:163], a[128:131], v[192:195]
    ds_read_b64_tr_b16 a[176:177], v14 offset:13472
    v_mfma_f32_16x16x32_bf16 v[192:195], a[164:167], a[144:147], v[192:195]
    ds_read_b64_tr_b16 a[178:179], v14 offset:17056
    s_add_u32 m0, s46, 145408
    v_mfma_f32_16x16x32_bf16 v[196:199], a[164:167], a[148:151], v[196:199]
    buffer_load_dwordx4 v4, s[20:23], s34 offen lds
    v_mfma_f32_16x16x32_bf16 v[196:199], a[160:163], a[132:135], v[196:199]
    s_add_u32 s34, s34, s39
    s_waitcnt vmcnt(18)
    buffer_store_dwordx4 a[200:203], v0, s[64:67], s93 offen sc0 sc1
    s_mov_b32 s66, 524288
    v_mfma_f32_16x16x32_bf16 v[200:203], a[160:163], a[136:139], v[200:203]
    ds_read_b64_tr_b16 a[180:181], v14 offset:33952
    v_mfma_f32_16x16x32_bf16 v[200:203], a[164:167], a[152:155], v[200:203]
    ds_read_b64_tr_b16 a[182:183], v14 offset:37536
    v_mfma_f32_16x16x32_bf16 v[204:207], a[164:167], a[156:159], v[204:207]
    v_mfma_f32_16x16x32_bf16 v[204:207], a[160:163], a[140:143], v[204:207]
    s_waitcnt lgkmcnt(4)
    v_mfma_f32_16x16x32_bf16 v[220:223], a[168:171], a[140:143], v[220:223]
    ds_read_b64_tr_b16 a[184:185], v14 offset:13504
    v_mfma_f32_16x16x32_bf16 v[220:223], a[172:175], a[156:159], v[220:223]
    ds_read_b64_tr_b16 a[186:187], v14 offset:17088
    s_add_u32 m0, s46, 146432
    v_mfma_f32_16x16x32_bf16 v[216:219], a[172:175], a[152:155], v[216:219]
    buffer_load_dwordx4 v5, s[24:27], s35 offen lds
    v_mfma_f32_16x16x32_bf16 v[216:219], a[168:171], a[136:139], v[216:219]
    s_add_u32 s35, s35, s40
    v_mfma_f32_16x16x32_bf16 v[212:215], a[168:171], a[132:135], v[212:215]
    ds_read_b64_tr_b16 a[188:189], v14 offset:33984
    v_mfma_f32_16x16x32_bf16 v[212:215], a[172:175], a[148:151], v[212:215]
    ds_read_b64_tr_b16 a[190:191], v14 offset:37568
    v_mfma_f32_16x16x32_bf16 v[208:211], a[172:175], a[144:147], v[208:211]
    v_add_u32 v12, s43, v9
    v_add_u32 v13, s43, v10
    v_mfma_f32_16x16x32_bf16 v[208:211], a[168:171], a[128:131], v[208:211]
    buffer_store_dwordx4 a[204:207], v0, s[64:67], s95 offen sc0 sc1
    v_add_u32 v14, s43, v11
    s_waitcnt lgkmcnt(4)
    v_mfma_f32_16x16x32_bf16 v[224:227], a[176:179], a[128:131], v[224:227]
    s_waitcnt vmcnt(23)
    s_barrier
    ds_read_b64_tr_b16 a[160:161], v12 offset:0
    v_mfma_f32_16x16x32_bf16 v[224:227], a[180:183], a[144:147], v[224:227]
    ds_read_b64_tr_b16 a[162:163], v12 offset:1024
    s_add_u32 m0, s46, 147456
    v_mfma_f32_16x16x32_bf16 v[228:231], a[180:183], a[148:151], v[228:231]
    buffer_load_dwordx4 v6, s[28:31], s36 offen lds
    v_mfma_f32_16x16x32_bf16 v[228:231], a[176:179], a[132:135], v[228:231]
    s_add_u32 s36, s36, s41
    v_mfma_f32_16x16x32_bf16 v[232:235], a[176:179], a[136:139], v[232:235]
    ds_read_b64_tr_b16 a[164:165], v12 offset:20480
    v_mfma_f32_16x16x32_bf16 v[232:235], a[180:183], a[152:155], v[232:235]
    ds_read_b64_tr_b16 a[166:167], v12 offset:21504
    v_mfma_f32_16x16x32_bf16 v[236:239], a[180:183], a[156:159], v[236:239]
    v_mfma_f32_16x16x32_bf16 v[236:239], a[176:179], a[140:143], v[236:239]
    s_waitcnt lgkmcnt(4)
    v_mfma_f32_16x16x32_bf16 v[252:255], a[184:187], a[140:143], v[252:255]
    ds_read_b64_tr_b16 a[168:169], v13 offset:0
    v_mfma_f32_16x16x32_bf16 v[252:255], a[188:191], a[156:159], v[252:255]
    ds_read_b64_tr_b16 a[170:171], v13 offset:1024
    v_mfma_f32_16x16x32_bf16 v[248:251], a[188:191], a[152:155], v[248:251]
    s_bitcmp1_b32 s68, 1
    s_cselect_b32 s86, s69, 0
    v_mfma_f32_16x16x32_bf16 v[248:251], a[184:187], a[136:139], v[248:251]
    buffer_load_dword a210, v8, s[84:87], s89 offen
    s_add_u32 s89, s89, s88
    v_mfma_f32_16x16x32_bf16 v[244:247], a[184:187], a[132:135], v[244:247]
    ds_read_b64_tr_b16 a[172:173], v13 offset:20480
    v_mfma_f32_16x16x32_bf16 v[244:247], a[188:191], a[148:151], v[244:247]
    ds_read_b64_tr_b16 a[174:175], v13 offset:21504
    v_mfma_f32_16x16x32_bf16 v[240:243], a[188:191], a[144:147], v[240:243]
    v_mfma_f32_16x16x32_bf16 v[240:243], a[184:187], a[128:131], v[240:243]
    s_mov_b32 s45, 6
.p2align 6
recurrent_scan__sliding_local_dilated__swiglu_ffn__prompt_kernel_loop:
    s_waitcnt vmcnt(12) lgkmcnt(4)
    v_mfma_f32_16x16x32_bf16 a[0:3], a[160:163], a[96:99], a[0:3]
    ds_read_b64_tr_b16 a[176:177], v12 offset:2048
    v_mfma_f32_16x16x32_bf16 a[0:3], a[164:167], a[112:115], a[0:3]
    ds_read_b64_tr_b16 a[178:179], v12 offset:3072
    v_mfma_f32_16x16x32_bf16 a[4:7], a[164:167], a[116:119], a[4:7]
    v_mfma_f32_16x16x32_bf16 a[4:7], a[160:163], a[100:103], a[4:7]
    v_mfma_f32_16x16x32_bf16 a[8:11], a[160:163], a[104:107], a[8:11]
    ds_read_b64_tr_b16 a[180:181], v12 offset:22528
    v_mfma_f32_16x16x32_bf16 a[8:11], a[164:167], a[120:123], a[8:11]
    ds_read_b64_tr_b16 a[182:183], v12 offset:23552
    v_mfma_f32_16x16x32_bf16 a[12:15], a[164:167], a[124:127], a[12:15]
    buffer_load_dwordx4 a[128:131], v7, s[8:11], s42 offen offset:0 sc1
    v_mfma_f32_16x16x32_bf16 a[12:15], a[160:163], a[108:111], a[12:15]
    s_waitcnt lgkmcnt(4)
    v_mfma_f32_16x16x32_bf16 a[28:31], a[168:171], a[108:111], a[28:31]
    ds_read_b64_tr_b16 a[184:185], v13 offset:2048
    v_mfma_f32_16x16x32_bf16 a[28:31], a[172:175], a[124:127], a[28:31]
    ds_read_b64_tr_b16 a[186:187], v13 offset:3072
    v_mfma_f32_16x16x32_bf16 a[24:27], a[172:175], a[120:123], a[24:27]
    v_mfma_f32_16x16x32_bf16 a[24:27], a[168:171], a[104:107], a[24:27]
    v_mfma_f32_16x16x32_bf16 a[20:23], a[168:171], a[100:103], a[20:23]
    ds_read_b64_tr_b16 a[188:189], v13 offset:22528
    v_mfma_f32_16x16x32_bf16 a[20:23], a[172:175], a[116:119], a[20:23]
    ds_read_b64_tr_b16 a[190:191], v13 offset:23552
    v_mfma_f32_16x16x32_bf16 a[16:19], a[172:175], a[112:115], a[16:19]
    buffer_load_dwordx4 a[132:135], v30, s[8:11], s42 offen offset:0 sc1
    v_mfma_f32_16x16x32_bf16 a[16:19], a[168:171], a[96:99], a[16:19]
    s_waitcnt lgkmcnt(4)
    v_mfma_f32_16x16x32_bf16 a[32:35], a[176:179], a[96:99], a[32:35]
    ds_read_b64_tr_b16 a[160:161], v12 offset:4096
    v_mfma_f32_16x16x32_bf16 a[32:35], a[180:183], a[112:115], a[32:35]
    ds_read_b64_tr_b16 a[162:163], v12 offset:5120
    v_mfma_f32_16x16x32_bf16 a[36:39], a[180:183], a[116:119], a[36:39]
    v_mfma_f32_16x16x32_bf16 a[36:39], a[176:179], a[100:103], a[36:39]
    v_mfma_f32_16x16x32_bf16 a[40:43], a[176:179], a[104:107], a[40:43]
    ds_read_b64_tr_b16 a[164:165], v12 offset:24576
    v_mfma_f32_16x16x32_bf16 a[40:43], a[180:183], a[120:123], a[40:43]
    ds_read_b64_tr_b16 a[166:167], v12 offset:25600
    v_mfma_f32_16x16x32_bf16 a[44:47], a[180:183], a[124:127], a[44:47]
    buffer_load_dwordx4 a[136:139], v7, s[8:11], s42 offen offset:3072 sc1
    v_mfma_f32_16x16x32_bf16 a[44:47], a[176:179], a[108:111], a[44:47]
    s_waitcnt lgkmcnt(4)
    v_mfma_f32_16x16x32_bf16 a[60:63], a[184:187], a[108:111], a[60:63]
    ds_read_b64_tr_b16 a[168:169], v13 offset:4096
    s_add_u32 s43, s43, 40960
    v_mfma_f32_16x16x32_bf16 a[60:63], a[188:191], a[124:127], a[60:63]
    ds_read_b64_tr_b16 a[170:171], v13 offset:5120
    v_mfma_f32_16x16x32_bf16 a[56:59], a[188:191], a[120:123], a[56:59]
    v_mfma_f32_16x16x32_bf16 a[56:59], a[184:187], a[104:107], a[56:59]
    s_cmp_ge_u32 s43, 163840
    s_cselect_b32 s43, 0, s43
    v_mfma_f32_16x16x32_bf16 a[52:55], a[184:187], a[100:103], a[52:55]
    ds_read_b64_tr_b16 a[172:173], v13 offset:24576
    v_mfma_f32_16x16x32_bf16 a[52:55], a[188:191], a[116:119], a[52:55]
    ds_read_b64_tr_b16 a[174:175], v13 offset:25600
    v_mfma_f32_16x16x32_bf16 a[48:51], a[188:191], a[112:115], a[48:51]
    buffer_load_dwordx4 a[140:143], v30, s[8:11], s42 offen offset:3072 sc1
    v_mfma_f32_16x16x32_bf16 a[48:51], a[184:187], a[96:99], a[48:51]
    s_add_u32 s42, s42, 196608
    s_waitcnt lgkmcnt(4)
    v_mfma_f32_16x16x32_bf16 a[64:67], a[96:99], a[160:163], a[64:67]
    ds_read_b64_tr_b16 a[176:177], v14 offset:6144
    s_add_u32 s44, s44, 40960
    v_mfma_f32_16x16x32_bf16 a[64:67], a[112:115], a[164:167], a[64:67]
    ds_read_b64_tr_b16 a[178:179], v14 offset:9728
    v_mfma_f32_16x16x32_bf16 a[68:71], a[116:119], a[164:167], a[68:71]
    v_mfma_f32_16x16x32_bf16 a[68:71], a[100:103], a[160:163], a[68:71]
    s_cmp_ge_u32 s44, s47
    s_cselect_b32 s44, s46, s44
    v_mfma_f32_16x16x32_bf16 a[72:75], a[104:107], a[160:163], a[72:75]
    ds_read_b64_tr_b16 a[180:181], v14 offset:26624
    v_mfma_f32_16x16x32_bf16 a[72:75], a[120:123], a[164:167], a[72:75]
    ds_read_b64_tr_b16 a[182:183], v14 offset:30208
    v_mfma_f32_16x16x32_bf16 a[76:79], a[124:127], a[164:167], a[76:79]
    buffer_load_dwordx4 a[144:147], v7, s[8:11], s42 offen offset:0 sc1
    v_mfma_f32_16x16x32_bf16 a[76:79], a[108:111], a[160:163], a[76:79]
    s_waitcnt lgkmcnt(4)
    v_mfma_f32_16x16x32_bf16 a[92:95], a[108:111], a[168:171], a[92:95]
    ds_read_b64_tr_b16 a[184:185], v14 offset:6176
    v_mfma_f32_16x16x32_bf16 a[92:95], a[124:127], a[172:175], a[92:95]
    ds_read_b64_tr_b16 a[186:187], v14 offset:9760
    v_mfma_f32_16x16x32_bf16 a[88:91], a[120:123], a[172:175], a[88:91]
    s_cmp_eq_u32 s45, s1
    s_cselect_b64 s[84:85], s[56:57], s[84:85]
    v_mfma_f32_16x16x32_bf16 a[88:91], a[104:107], a[168:171], a[88:91]
    s_cmp_eq_u32 s45, s1
    s_cselect_b32 s69, 0x200000, s69
    s_cselect_b32 s89, s0, s89
    v_mfma_f32_16x16x32_bf16 a[84:87], a[100:103], a[168:171], a[84:87]
    ds_read_b64_tr_b16 a[188:189], v14 offset:26656
    v_mfma_f32_16x16x32_bf16 a[84:87], a[116:119], a[172:175], a[84:87]
    ds_read_b64_tr_b16 a[190:191], v14 offset:30240
    v_mfma_f32_16x16x32_bf16 a[80:83], a[112:115], a[172:175], a[80:83]
    buffer_load_dwordx4 a[148:151], v30, s[8:11], s42 offen offset:0 sc1
    v_mfma_f32_16x16x32_bf16 a[80:83], a[96:99], a[168:171], a[80:83]
    s_waitcnt lgkmcnt(4)
    v_mfma_f32_16x16x32_bf16 v[32:35], a[176:179], a[96:99], v[32:35]
    ds_read_b64_tr_b16 a[160:161], v14 offset:6208
    v_mfma_f32_16x16x32_bf16 v[32:35], a[180:183], a[112:115], v[32:35]
    ds_read_b64_tr_b16 a[162:163], v14 offset:9792
    v_mfma_f32_16x16x32_bf16 v[36:39], a[180:183], a[116:119], v[36:39]
    v_mfma_f32_16x16x32_bf16 v[36:39], a[176:179], a[100:103], v[36:39]
    v_mfma_f32_16x16x32_bf16 v[40:43], a[176:179], a[104:107], v[40:43]
    ds_read_b64_tr_b16 a[164:165], v14 offset:26688
    v_mfma_f32_16x16x32_bf16 v[40:43], a[180:183], a[120:123], v[40:43]
    ds_read_b64_tr_b16 a[166:167], v14 offset:30272
    v_mfma_f32_16x16x32_bf16 v[44:47], a[180:183], a[124:127], v[44:47]
    buffer_load_dwordx4 a[152:155], v7, s[8:11], s42 offen offset:3072 sc1
    v_mfma_f32_16x16x32_bf16 v[44:47], a[176:179], a[108:111], v[44:47]
    s_waitcnt lgkmcnt(4)
    v_mfma_f32_16x16x32_bf16 v[60:63], a[184:187], a[108:111], v[60:63]
    ds_read_b64_tr_b16 a[168:169], v14 offset:6240
    v_mfma_f32_16x16x32_bf16 v[60:63], a[188:191], a[124:127], v[60:63]
    ds_read_b64_tr_b16 a[170:171], v14 offset:9824
    v_mfma_f32_16x16x32_bf16 v[56:59], a[188:191], a[120:123], v[56:59]
    v_mfma_f32_16x16x32_bf16 v[56:59], a[184:187], a[104:107], v[56:59]
    v_mfma_f32_16x16x32_bf16 v[52:55], a[184:187], a[100:103], v[52:55]
    ds_read_b64_tr_b16 a[172:173], v14 offset:26720
    v_mfma_f32_16x16x32_bf16 v[52:55], a[188:191], a[116:119], v[52:55]
    ds_read_b64_tr_b16 a[174:175], v14 offset:30304
    v_mfma_f32_16x16x32_bf16 v[48:51], a[188:191], a[112:115], v[48:51]
    buffer_load_dwordx4 a[156:159], v30, s[8:11], s42 offen offset:3072 sc1
    v_mfma_f32_16x16x32_bf16 v[48:51], a[184:187], a[96:99], v[48:51]
    s_add_u32 s42, s42, 196608
    s_waitcnt lgkmcnt(4)
    v_mfma_f32_16x16x32_bf16 v[64:67], a[160:163], a[96:99], v[64:67]
    ds_read_b64_tr_b16 a[176:177], v14 offset:6272
    v_mfma_f32_16x16x32_bf16 v[64:67], a[164:167], a[112:115], v[64:67]
    ds_read_b64_tr_b16 a[178:179], v14 offset:9856
    v_mfma_f32_16x16x32_bf16 v[68:71], a[164:167], a[116:119], v[68:71]
    v_mfma_f32_16x16x32_bf16 v[68:71], a[160:163], a[100:103], v[68:71]
    v_mfma_f32_16x16x32_bf16 v[72:75], a[160:163], a[104:107], v[72:75]
    ds_read_b64_tr_b16 a[180:181], v14 offset:26752
    v_mfma_f32_16x16x32_bf16 v[72:75], a[164:167], a[120:123], v[72:75]
    ds_read_b64_tr_b16 a[182:183], v14 offset:30336
    v_mfma_f32_16x16x32_bf16 v[76:79], a[164:167], a[124:127], v[76:79]
    v_mfma_f32_16x16x32_bf16 v[76:79], a[160:163], a[108:111], v[76:79]
    s_waitcnt lgkmcnt(4)
    v_mfma_f32_16x16x32_bf16 v[92:95], a[168:171], a[108:111], v[92:95]
    ds_read_b64_tr_b16 a[184:185], v14 offset:6304
    v_mfma_f32_16x16x32_bf16 v[92:95], a[172:175], a[124:127], v[92:95]
    ds_read_b64_tr_b16 a[186:187], v14 offset:9888
    s_add_u32 m0, s44, 0
    v_mfma_f32_16x16x32_bf16 v[88:91], a[172:175], a[120:123], v[88:91]
    buffer_load_dwordx4 v2, s[12:15], s32 offen lds
    v_mfma_f32_16x16x32_bf16 v[88:91], a[168:171], a[104:107], v[88:91]
    s_add_u32 s32, s32, s37
    v_mfma_f32_16x16x32_bf16 v[84:87], a[168:171], a[100:103], v[84:87]
    ds_read_b64_tr_b16 a[188:189], v14 offset:26784
    v_mfma_f32_16x16x32_bf16 v[84:87], a[172:175], a[116:119], v[84:87]
    ds_read_b64_tr_b16 a[190:191], v14 offset:30368
    v_mfma_f32_16x16x32_bf16 v[80:83], a[172:175], a[112:115], v[80:83]
    v_mfma_f32_16x16x32_bf16 v[80:83], a[168:171], a[96:99], v[80:83]
recurrent_scan__sliding_local_dilated__swiglu_ffn__prompt_kernel_w2:
    s_cbranch_execz recurrent_scan__sliding_local_dilated__swiglu_ffn__prompt_kernel_w6
    s_waitcnt lgkmcnt(4)
    v_mfma_f32_16x16x32_bf16 v[96:99], a[176:179], a[96:99], v[96:99]
    ds_read_b64_tr_b16 a[160:161], v14 offset:6336
    v_mfma_f32_16x16x32_bf16 v[96:99], a[180:183], a[112:115], v[96:99]
    ds_read_b64_tr_b16 a[162:163], v14 offset:9920
    s_add_u32 m0, s44, 1024
    v_mfma_f32_16x16x32_bf16 v[100:103], a[180:183], a[116:119], v[100:103]
    buffer_load_dwordx4 v3, s[16:19], s33 offen lds
    v_mfma_f32_16x16x32_bf16 v[100:103], a[176:179], a[100:103], v[100:103]
    s_add_u32 s33, s33, s38
    v_mfma_f32_16x16x32_bf16 v[104:107], a[176:179], a[104:107], v[104:107]
    ds_read_b64_tr_b16 a[164:165], v14 offset:26816
    v_mfma_f32_16x16x32_bf16 v[104:107], a[180:183], a[120:123], v[104:107]
    ds_read_b64_tr_b16 a[166:167], v14 offset:30400
    v_mfma_f32_16x16x32_bf16 v[108:111], a[180:183], a[124:127], v[108:111]
    v_mfma_f32_16x16x32_bf16 v[108:111], a[176:179], a[108:111], v[108:111]
    s_waitcnt lgkmcnt(4)
    v_mfma_f32_16x16x32_bf16 v[124:127], a[184:187], a[108:111], v[124:127]
    ds_read_b64_tr_b16 a[168:169], v14 offset:13312
    v_mfma_f32_16x16x32_bf16 v[124:127], a[188:191], a[124:127], v[124:127]
    ds_read_b64_tr_b16 a[170:171], v14 offset:16896
    s_add_u32 m0, s44, 2048
    v_mfma_f32_16x16x32_bf16 v[120:123], a[188:191], a[120:123], v[120:123]
    buffer_load_dwordx4 v4, s[20:23], s34 offen lds
    v_mfma_f32_16x16x32_bf16 v[120:123], a[184:187], a[104:107], v[120:123]
    s_add_u32 s34, s34, s39
    v_mfma_f32_16x16x32_bf16 v[116:119], a[184:187], a[100:103], v[116:119]
    ds_read_b64_tr_b16 a[172:173], v14 offset:33792
    v_mfma_f32_16x16x32_bf16 v[116:119], a[188:191], a[116:119], v[116:119]
    ds_read_b64_tr_b16 a[174:175], v14 offset:37376
    v_mfma_f32_16x16x32_bf16 v[112:115], a[188:191], a[112:115], v[112:115]
    v_mfma_f32_16x16x32_bf16 v[112:115], a[184:187], a[96:99], v[112:115]
    s_waitcnt lgkmcnt(4)
    v_mfma_f32_16x16x32_bf16 v[128:131], a[160:163], a[96:99], v[128:131]
    ds_read_b64_tr_b16 a[176:177], v14 offset:13344
    v_mfma_f32_16x16x32_bf16 v[128:131], a[164:167], a[112:115], v[128:131]
    ds_read_b64_tr_b16 a[178:179], v14 offset:16928
    s_add_u32 m0, s44, 3072
    v_mfma_f32_16x16x32_bf16 v[132:135], a[164:167], a[116:119], v[132:135]
    buffer_load_dwordx4 v5, s[24:27], s35 offen lds
    v_mfma_f32_16x16x32_bf16 v[132:135], a[160:163], a[100:103], v[132:135]
    s_add_u32 s35, s35, s40
    v_mfma_f32_16x16x32_bf16 v[136:139], a[160:163], a[104:107], v[136:139]
    ds_read_b64_tr_b16 a[180:181], v14 offset:33824
    v_mfma_f32_16x16x32_bf16 v[136:139], a[164:167], a[120:123], v[136:139]
    ds_read_b64_tr_b16 a[182:183], v14 offset:37408
    v_mfma_f32_16x16x32_bf16 v[140:143], a[164:167], a[124:127], v[140:143]
    v_mfma_f32_16x16x32_bf16 v[140:143], a[160:163], a[108:111], v[140:143]
    s_waitcnt lgkmcnt(4)
    v_mfma_f32_16x16x32_bf16 v[156:159], a[168:171], a[108:111], v[156:159]
    ds_read_b64_tr_b16 a[184:185], v14 offset:13376
    v_mfma_f32_16x16x32_bf16 v[156:159], a[172:175], a[124:127], v[156:159]
    ds_read_b64_tr_b16 a[186:187], v14 offset:16960
    s_add_u32 m0, s44, 4096
    v_mfma_f32_16x16x32_bf16 v[152:155], a[172:175], a[120:123], v[152:155]
    buffer_load_dwordx4 v6, s[28:31], s36 offen lds
    v_mfma_f32_16x16x32_bf16 v[152:155], a[168:171], a[104:107], v[152:155]
    s_add_u32 s36, s36, s41
    v_mfma_f32_16x16x32_bf16 v[148:151], a[168:171], a[100:103], v[148:151]
    ds_read_b64_tr_b16 a[188:189], v14 offset:33856
    v_mfma_f32_16x16x32_bf16 v[148:151], a[172:175], a[116:119], v[148:151]
    ds_read_b64_tr_b16 a[190:191], v14 offset:37440
    v_mfma_f32_16x16x32_bf16 v[144:147], a[172:175], a[112:115], v[144:147]
    v_mfma_f32_16x16x32_bf16 v[144:147], a[168:171], a[96:99], v[144:147]
    s_waitcnt lgkmcnt(4)
    v_mfma_f32_16x16x32_bf16 v[160:163], a[176:179], a[96:99], v[160:163]
    ds_read_b64_tr_b16 a[160:161], v14 offset:13408
    v_mfma_f32_16x16x32_bf16 v[160:163], a[180:183], a[112:115], v[160:163]
    ds_read_b64_tr_b16 a[162:163], v14 offset:16992
    s_add_u32 m0, s44, 20480
    v_mfma_f32_16x16x32_bf16 v[164:167], a[180:183], a[116:119], v[164:167]
    buffer_load_dwordx4 v2, s[12:15], s32 offen lds
    v_mfma_f32_16x16x32_bf16 v[164:167], a[176:179], a[100:103], v[164:167]
    s_add_u32 s32, s32, s37
    v_mfma_f32_16x16x32_bf16 v[168:171], a[176:179], a[104:107], v[168:171]
    ds_read_b64_tr_b16 a[164:165], v14 offset:33888
    v_mfma_f32_16x16x32_bf16 v[168:171], a[180:183], a[120:123], v[168:171]
    ds_read_b64_tr_b16 a[166:167], v14 offset:37472
    v_mfma_f32_16x16x32_bf16 v[172:175], a[180:183], a[124:127], v[172:175]
    v_mfma_f32_16x16x32_bf16 v[172:175], a[176:179], a[108:111], v[172:175]
    s_waitcnt lgkmcnt(4)
    v_mfma_f32_16x16x32_bf16 v[188:191], a[184:187], a[108:111], v[188:191]
    ds_read_b64_tr_b16 a[168:169], v14 offset:13440
    v_mfma_f32_16x16x32_bf16 v[188:191], a[188:191], a[124:127], v[188:191]
    ds_read_b64_tr_b16 a[170:171], v14 offset:17024
    s_add_u32 m0, s44, 21504
    v_mfma_f32_16x16x32_bf16 v[184:187], a[188:191], a[120:123], v[184:187]
    buffer_load_dwordx4 v3, s[16:19], s33 offen lds
    v_mfma_f32_16x16x32_bf16 v[184:187], a[184:187], a[104:107], v[184:187]
    s_add_u32 s33, s33, s38
    v_mfma_f32_16x16x32_bf16 v[180:183], a[184:187], a[100:103], v[180:183]
    ds_read_b64_tr_b16 a[172:173], v14 offset:33920
    v_mfma_f32_16x16x32_bf16 v[180:183], a[188:191], a[116:119], v[180:183]
    ds_read_b64_tr_b16 a[174:175], v14 offset:37504
    v_mfma_f32_16x16x32_bf16 v[176:179], a[188:191], a[112:115], v[176:179]
    v_mfma_f32_16x16x32_bf16 v[176:179], a[184:187], a[96:99], v[176:179]
    s_waitcnt lgkmcnt(4)
    v_mfma_f32_16x16x32_bf16 v[192:195], a[160:163], a[96:99], v[192:195]
    ds_read_b64_tr_b16 a[176:177], v14 offset:13472
    v_mfma_f32_16x16x32_bf16 v[192:195], a[164:167], a[112:115], v[192:195]
    ds_read_b64_tr_b16 a[178:179], v14 offset:17056
    s_add_u32 m0, s44, 22528
    v_mfma_f32_16x16x32_bf16 v[196:199], a[164:167], a[116:119], v[196:199]
    buffer_load_dwordx4 v4, s[20:23], s34 offen lds
    v_mfma_f32_16x16x32_bf16 v[196:199], a[160:163], a[100:103], v[196:199]
    s_add_u32 s34, s34, s39
    v_mfma_f32_16x16x32_bf16 v[200:203], a[160:163], a[104:107], v[200:203]
    ds_read_b64_tr_b16 a[180:181], v14 offset:33952
    v_mfma_f32_16x16x32_bf16 v[200:203], a[164:167], a[120:123], v[200:203]
    ds_read_b64_tr_b16 a[182:183], v14 offset:37536
    v_mfma_f32_16x16x32_bf16 v[204:207], a[164:167], a[124:127], v[204:207]
    v_mfma_f32_16x16x32_bf16 v[204:207], a[160:163], a[108:111], v[204:207]
    s_waitcnt lgkmcnt(4)
    v_mfma_f32_16x16x32_bf16 v[220:223], a[168:171], a[108:111], v[220:223]
    ds_read_b64_tr_b16 a[184:185], v14 offset:13504
    v_mfma_f32_16x16x32_bf16 v[220:223], a[172:175], a[124:127], v[220:223]
    ds_read_b64_tr_b16 a[186:187], v14 offset:17088
    s_add_u32 m0, s44, 23552
    v_mfma_f32_16x16x32_bf16 v[216:219], a[172:175], a[120:123], v[216:219]
    buffer_load_dwordx4 v5, s[24:27], s35 offen lds
    v_mfma_f32_16x16x32_bf16 v[216:219], a[168:171], a[104:107], v[216:219]
    s_add_u32 s35, s35, s40
    v_mfma_f32_16x16x32_bf16 v[212:215], a[168:171], a[100:103], v[212:215]
    ds_read_b64_tr_b16 a[188:189], v14 offset:33984
    v_mfma_f32_16x16x32_bf16 v[212:215], a[172:175], a[116:119], v[212:215]
    ds_read_b64_tr_b16 a[190:191], v14 offset:37568
    v_mfma_f32_16x16x32_bf16 v[208:211], a[172:175], a[112:115], v[208:211]
    v_add_u32 v12, s43, v9
    v_add_u32 v13, s43, v10
    v_mfma_f32_16x16x32_bf16 v[208:211], a[168:171], a[96:99], v[208:211]
    v_add_u32 v14, s43, v11
    s_waitcnt lgkmcnt(4)
    v_mfma_f32_16x16x32_bf16 v[224:227], a[176:179], a[96:99], v[224:227]
    s_waitcnt vmcnt(18)
    s_barrier
    ds_read_b64_tr_b16 a[160:161], v12 offset:0
    v_mfma_f32_16x16x32_bf16 v[224:227], a[180:183], a[112:115], v[224:227]
    ds_read_b64_tr_b16 a[162:163], v12 offset:1024
    s_add_u32 m0, s44, 24576
    v_mfma_f32_16x16x32_bf16 v[228:231], a[180:183], a[116:119], v[228:231]
    buffer_load_dwordx4 v6, s[28:31], s36 offen lds
    v_mfma_f32_16x16x32_bf16 v[228:231], a[176:179], a[100:103], v[228:231]
    s_add_u32 s36, s36, s41
    v_mfma_f32_16x16x32_bf16 v[232:235], a[176:179], a[104:107], v[232:235]
    ds_read_b64_tr_b16 a[164:165], v12 offset:20480
    v_mfma_f32_16x16x32_bf16 v[232:235], a[180:183], a[120:123], v[232:235]
    ds_read_b64_tr_b16 a[166:167], v12 offset:21504
    v_mfma_f32_16x16x32_bf16 v[236:239], a[180:183], a[124:127], v[236:239]
    v_mfma_f32_16x16x32_bf16 v[236:239], a[176:179], a[108:111], v[236:239]
    s_waitcnt lgkmcnt(4)
    v_mfma_f32_16x16x32_bf16 v[252:255], a[184:187], a[108:111], v[252:255]
    ds_read_b64_tr_b16 a[168:169], v13 offset:0
    v_mfma_f32_16x16x32_bf16 v[252:255], a[188:191], a[124:127], v[252:255]
    ds_read_b64_tr_b16 a[170:171], v13 offset:1024
    v_mfma_f32_16x16x32_bf16 v[248:251], a[188:191], a[120:123], v[248:251]
    s_bitcmp1_b32 s68, 0
    s_cselect_b32 s86, s69, 0
    v_mfma_f32_16x16x32_bf16 v[248:251], a[184:187], a[104:107], v[248:251]
    buffer_load_dword a210, v8, s[84:87], s89 offen
    s_add_u32 s89, s89, s88
    v_mfma_f32_16x16x32_bf16 v[244:247], a[184:187], a[100:103], v[244:247]
    ds_read_b64_tr_b16 a[172:173], v13 offset:20480
    v_mfma_f32_16x16x32_bf16 v[244:247], a[188:191], a[116:119], v[244:247]
    ds_read_b64_tr_b16 a[174:175], v13 offset:21504
    v_mfma_f32_16x16x32_bf16 v[240:243], a[188:191], a[112:115], v[240:243]
    v_mfma_f32_16x16x32_bf16 v[240:243], a[184:187], a[96:99], v[240:243]
    s_waitcnt vmcnt(11) lgkmcnt(4)
    v_mfma_f32_16x16x32_bf16 a[0:3], a[160:163], a[128:131], a[0:3]
    ds_read_b64_tr_b16 a[176:177], v12 offset:2048
    v_mfma_f32_16x16x32_bf16 a[0:3], a[164:167], a[144:147], a[0:3]
    ds_read_b64_tr_b16 a[178:179], v12 offset:3072
    v_mfma_f32_16x16x32_bf16 a[4:7], a[164:167], a[148:151], a[4:7]
    v_mfma_f32_16x16x32_bf16 a[4:7], a[160:163], a[132:135], a[4:7]
    v_mfma_f32_16x16x32_bf16 a[8:11], a[160:163], a[136:139], a[8:11]
    ds_read_b64_tr_b16 a[180:181], v12 offset:22528
    v_mfma_f32_16x16x32_bf16 a[8:11], a[164:167], a[152:155], a[8:11]
    ds_read_b64_tr_b16 a[182:183], v12 offset:23552
    v_mfma_f32_16x16x32_bf16 a[12:15], a[164:167], a[156:159], a[12:15]
    buffer_load_dwordx4 a[96:99], v7, s[8:11], s42 offen offset:0 sc1
    v_mfma_f32_16x16x32_bf16 a[12:15], a[160:163], a[140:143], a[12:15]
    s_waitcnt lgkmcnt(4)
    v_mfma_f32_16x16x32_bf16 a[28:31], a[168:171], a[140:143], a[28:31]
    ds_read_b64_tr_b16 a[184:185], v13 offset:2048
    v_mfma_f32_16x16x32_bf16 a[28:31], a[172:175], a[156:159], a[28:31]
    ds_read_b64_tr_b16 a[186:187], v13 offset:3072
    v_mfma_f32_16x16x32_bf16 a[24:27], a[172:175], a[152:155], a[24:27]
    v_mfma_f32_16x16x32_bf16 a[24:27], a[168:171], a[136:139], a[24:27]
    v_mfma_f32_16x16x32_bf16 a[20:23], a[168:171], a[132:135], a[20:23]
    ds_read_b64_tr_b16 a[188:189], v13 offset:22528
    v_mfma_f32_16x16x32_bf16 a[20:23], a[172:175], a[148:151], a[20:23]
    ds_read_b64_tr_b16 a[190:191], v13 offset:23552
    v_mfma_f32_16x16x32_bf16 a[16:19], a[172:175], a[144:147], a[16:19]
    buffer_load_dwordx4 a[100:103], v30, s[8:11], s42 offen offset:0 sc1
    v_mfma_f32_16x16x32_bf16 a[16:19], a[168:171], a[128:131], a[16:19]
    s_waitcnt lgkmcnt(4)
    v_mfma_f32_16x16x32_bf16 a[32:35], a[176:179], a[128:131], a[32:35]
    ds_read_b64_tr_b16 a[160:161], v12 offset:4096
    v_mfma_f32_16x16x32_bf16 a[32:35], a[180:183], a[144:147], a[32:35]
    ds_read_b64_tr_b16 a[162:163], v12 offset:5120
    v_mfma_f32_16x16x32_bf16 a[36:39], a[180:183], a[148:151], a[36:39]
    v_mfma_f32_16x16x32_bf16 a[36:39], a[176:179], a[132:135], a[36:39]
    v_mfma_f32_16x16x32_bf16 a[40:43], a[176:179], a[136:139], a[40:43]
    ds_read_b64_tr_b16 a[164:165], v12 offset:24576
    v_mfma_f32_16x16x32_bf16 a[40:43], a[180:183], a[152:155], a[40:43]
    ds_read_b64_tr_b16 a[166:167], v12 offset:25600
    v_mfma_f32_16x16x32_bf16 a[44:47], a[180:183], a[156:159], a[44:47]
    buffer_load_dwordx4 a[104:107], v7, s[8:11], s42 offen offset:3072 sc1
    v_mfma_f32_16x16x32_bf16 a[44:47], a[176:179], a[140:143], a[44:47]
    s_waitcnt lgkmcnt(4)
    v_mfma_f32_16x16x32_bf16 a[60:63], a[184:187], a[140:143], a[60:63]
    ds_read_b64_tr_b16 a[168:169], v13 offset:4096
    s_add_u32 s43, s43, 40960
    v_mfma_f32_16x16x32_bf16 a[60:63], a[188:191], a[156:159], a[60:63]
    ds_read_b64_tr_b16 a[170:171], v13 offset:5120
    v_mfma_f32_16x16x32_bf16 a[56:59], a[188:191], a[152:155], a[56:59]
    v_mfma_f32_16x16x32_bf16 a[56:59], a[184:187], a[136:139], a[56:59]
    s_cmp_ge_u32 s43, 163840
    s_cselect_b32 s43, 0, s43
    v_mfma_f32_16x16x32_bf16 a[52:55], a[184:187], a[132:135], a[52:55]
    ds_read_b64_tr_b16 a[172:173], v13 offset:24576
    v_mfma_f32_16x16x32_bf16 a[52:55], a[188:191], a[148:151], a[52:55]
    ds_read_b64_tr_b16 a[174:175], v13 offset:25600
    v_mfma_f32_16x16x32_bf16 a[48:51], a[188:191], a[144:147], a[48:51]
    buffer_load_dwordx4 a[108:111], v30, s[8:11], s42 offen offset:3072 sc1
    v_mfma_f32_16x16x32_bf16 a[48:51], a[184:187], a[128:131], a[48:51]
    s_add_u32 s42, s42, 196608
    s_waitcnt lgkmcnt(4)
    v_mfma_f32_16x16x32_bf16 a[64:67], a[128:131], a[160:163], a[64:67]
    ds_read_b64_tr_b16 a[176:177], v14 offset:6144
    s_add_u32 s44, s44, 40960
    v_mfma_f32_16x16x32_bf16 a[64:67], a[144:147], a[164:167], a[64:67]
    ds_read_b64_tr_b16 a[178:179], v14 offset:9728
    v_mfma_f32_16x16x32_bf16 a[68:71], a[148:151], a[164:167], a[68:71]
    v_mfma_f32_16x16x32_bf16 a[68:71], a[132:135], a[160:163], a[68:71]
    s_cmp_ge_u32 s44, s47
    s_cselect_b32 s44, s46, s44
    v_mfma_f32_16x16x32_bf16 a[72:75], a[136:139], a[160:163], a[72:75]
    ds_read_b64_tr_b16 a[180:181], v14 offset:26624
    v_mfma_f32_16x16x32_bf16 a[72:75], a[152:155], a[164:167], a[72:75]
    ds_read_b64_tr_b16 a[182:183], v14 offset:30208
    v_mfma_f32_16x16x32_bf16 a[76:79], a[156:159], a[164:167], a[76:79]
    buffer_load_dwordx4 a[112:115], v7, s[8:11], s42 offen offset:0 sc1
    v_mfma_f32_16x16x32_bf16 a[76:79], a[140:143], a[160:163], a[76:79]
    s_waitcnt lgkmcnt(4)
    v_mfma_f32_16x16x32_bf16 a[92:95], a[140:143], a[168:171], a[92:95]
    ds_read_b64_tr_b16 a[184:185], v14 offset:6176
    v_mfma_f32_16x16x32_bf16 a[92:95], a[156:159], a[172:175], a[92:95]
    ds_read_b64_tr_b16 a[186:187], v14 offset:9760
    v_mfma_f32_16x16x32_bf16 a[88:91], a[152:155], a[172:175], a[88:91]
    v_mfma_f32_16x16x32_bf16 a[88:91], a[136:139], a[168:171], a[88:91]
    v_mfma_f32_16x16x32_bf16 a[84:87], a[132:135], a[168:171], a[84:87]
    ds_read_b64_tr_b16 a[188:189], v14 offset:26656
    v_mfma_f32_16x16x32_bf16 a[84:87], a[148:151], a[172:175], a[84:87]
    ds_read_b64_tr_b16 a[190:191], v14 offset:30240
    v_mfma_f32_16x16x32_bf16 a[80:83], a[144:147], a[172:175], a[80:83]
    buffer_load_dwordx4 a[116:119], v30, s[8:11], s42 offen offset:0 sc1
    v_mfma_f32_16x16x32_bf16 a[80:83], a[128:131], a[168:171], a[80:83]
    s_waitcnt lgkmcnt(4)
    v_mfma_f32_16x16x32_bf16 v[32:35], a[176:179], a[128:131], v[32:35]
    ds_read_b64_tr_b16 a[160:161], v14 offset:6208
    v_mfma_f32_16x16x32_bf16 v[32:35], a[180:183], a[144:147], v[32:35]
    ds_read_b64_tr_b16 a[162:163], v14 offset:9792
    v_mfma_f32_16x16x32_bf16 v[36:39], a[180:183], a[148:151], v[36:39]
    v_mfma_f32_16x16x32_bf16 v[36:39], a[176:179], a[132:135], v[36:39]
    v_mfma_f32_16x16x32_bf16 v[40:43], a[176:179], a[136:139], v[40:43]
    ds_read_b64_tr_b16 a[164:165], v14 offset:26688
    v_mfma_f32_16x16x32_bf16 v[40:43], a[180:183], a[152:155], v[40:43]
    ds_read_b64_tr_b16 a[166:167], v14 offset:30272
    v_mfma_f32_16x16x32_bf16 v[44:47], a[180:183], a[156:159], v[44:47]
    buffer_load_dwordx4 a[120:123], v7, s[8:11], s42 offen offset:3072 sc1
    v_mfma_f32_16x16x32_bf16 v[44:47], a[176:179], a[140:143], v[44:47]
    s_waitcnt lgkmcnt(4)
    v_mfma_f32_16x16x32_bf16 v[60:63], a[184:187], a[140:143], v[60:63]
    ds_read_b64_tr_b16 a[168:169], v14 offset:6240
    v_mfma_f32_16x16x32_bf16 v[60:63], a[188:191], a[156:159], v[60:63]
    ds_read_b64_tr_b16 a[170:171], v14 offset:9824
    v_mfma_f32_16x16x32_bf16 v[56:59], a[188:191], a[152:155], v[56:59]
    v_mfma_f32_16x16x32_bf16 v[56:59], a[184:187], a[136:139], v[56:59]
    v_mfma_f32_16x16x32_bf16 v[52:55], a[184:187], a[132:135], v[52:55]
    ds_read_b64_tr_b16 a[172:173], v14 offset:26720
    v_mfma_f32_16x16x32_bf16 v[52:55], a[188:191], a[148:151], v[52:55]
    ds_read_b64_tr_b16 a[174:175], v14 offset:30304
    v_mfma_f32_16x16x32_bf16 v[48:51], a[188:191], a[144:147], v[48:51]
    buffer_load_dwordx4 a[124:127], v30, s[8:11], s42 offen offset:3072 sc1
    v_mfma_f32_16x16x32_bf16 v[48:51], a[184:187], a[128:131], v[48:51]
    s_add_u32 s42, s42, 196608
    s_waitcnt lgkmcnt(4)
    v_mfma_f32_16x16x32_bf16 v[64:67], a[160:163], a[128:131], v[64:67]
    ds_read_b64_tr_b16 a[176:177], v14 offset:6272
    v_mfma_f32_16x16x32_bf16 v[64:67], a[164:167], a[144:147], v[64:67]
    ds_read_b64_tr_b16 a[178:179], v14 offset:9856
    v_mfma_f32_16x16x32_bf16 v[68:71], a[164:167], a[148:151], v[68:71]
    v_mfma_f32_16x16x32_bf16 v[68:71], a[160:163], a[132:135], v[68:71]
    v_mfma_f32_16x16x32_bf16 v[72:75], a[160:163], a[136:139], v[72:75]
    ds_read_b64_tr_b16 a[180:181], v14 offset:26752
    v_mfma_f32_16x16x32_bf16 v[72:75], a[164:167], a[152:155], v[72:75]
    ds_read_b64_tr_b16 a[182:183], v14 offset:30336
    v_mfma_f32_16x16x32_bf16 v[76:79], a[164:167], a[156:159], v[76:79]
    v_mfma_f32_16x16x32_bf16 v[76:79], a[160:163], a[140:143], v[76:79]
    s_waitcnt lgkmcnt(4)
    v_mfma_f32_16x16x32_bf16 v[92:95], a[168:171], a[140:143], v[92:95]
    ds_read_b64_tr_b16 a[184:185], v14 offset:6304
    v_mfma_f32_16x16x32_bf16 v[92:95], a[172:175], a[156:159], v[92:95]
    ds_read_b64_tr_b16 a[186:187], v14 offset:9888
    s_add_u32 m0, s44, 0
    v_mfma_f32_16x16x32_bf16 v[88:91], a[172:175], a[152:155], v[88:91]
    buffer_load_dwordx4 v2, s[12:15], s32 offen lds
    v_mfma_f32_16x16x32_bf16 v[88:91], a[168:171], a[136:139], v[88:91]
    s_add_u32 s32, s32, s37
    v_mfma_f32_16x16x32_bf16 v[84:87], a[168:171], a[132:135], v[84:87]
    ds_read_b64_tr_b16 a[188:189], v14 offset:26784
    v_mfma_f32_16x16x32_bf16 v[84:87], a[172:175], a[148:151], v[84:87]
    ds_read_b64_tr_b16 a[190:191], v14 offset:30368
    v_mfma_f32_16x16x32_bf16 v[80:83], a[172:175], a[144:147], v[80:83]
    v_mfma_f32_16x16x32_bf16 v[80:83], a[168:171], a[128:131], v[80:83]
    s_waitcnt lgkmcnt(4)
    v_mfma_f32_16x16x32_bf16 v[96:99], a[176:179], a[128:131], v[96:99]
    ds_read_b64_tr_b16 a[160:161], v14 offset:6336
    v_mfma_f32_16x16x32_bf16 v[96:99], a[180:183], a[144:147], v[96:99]
    ds_read_b64_tr_b16 a[162:163], v14 offset:9920
    s_add_u32 m0, s44, 1024
    v_mfma_f32_16x16x32_bf16 v[100:103], a[180:183], a[148:151], v[100:103]
    buffer_load_dwordx4 v3, s[16:19], s33 offen lds
    v_mfma_f32_16x16x32_bf16 v[100:103], a[176:179], a[132:135], v[100:103]
    s_add_u32 s33, s33, s38
    v_mfma_f32_16x16x32_bf16 v[104:107], a[176:179], a[136:139], v[104:107]
    ds_read_b64_tr_b16 a[164:165], v14 offset:26816
    v_mfma_f32_16x16x32_bf16 v[104:107], a[180:183], a[152:155], v[104:107]
    ds_read_b64_tr_b16 a[166:167], v14 offset:30400
    v_mfma_f32_16x16x32_bf16 v[108:111], a[180:183], a[156:159], v[108:111]
    v_mfma_f32_16x16x32_bf16 v[108:111], a[176:179], a[140:143], v[108:111]
    s_waitcnt lgkmcnt(4)
    v_mfma_f32_16x16x32_bf16 v[124:127], a[184:187], a[140:143], v[124:127]
    ds_read_b64_tr_b16 a[168:169], v14 offset:13312
    v_mfma_f32_16x16x32_bf16 v[124:127], a[188:191], a[156:159], v[124:127]
    ds_read_b64_tr_b16 a[170:171], v14 offset:16896
    s_add_u32 m0, s44, 2048
    v_mfma_f32_16x16x32_bf16 v[120:123], a[188:191], a[152:155], v[120:123]
    buffer_load_dwordx4 v4, s[20:23], s34 offen lds
    v_mfma_f32_16x16x32_bf16 v[120:123], a[184:187], a[136:139], v[120:123]
    s_add_u32 s34, s34, s39
    v_mfma_f32_16x16x32_bf16 v[116:119], a[184:187], a[132:135], v[116:119]
    ds_read_b64_tr_b16 a[172:173], v14 offset:33792
    v_mfma_f32_16x16x32_bf16 v[116:119], a[188:191], a[148:151], v[116:119]
    ds_read_b64_tr_b16 a[174:175], v14 offset:37376
    v_mfma_f32_16x16x32_bf16 v[112:115], a[188:191], a[144:147], v[112:115]
    v_mfma_f32_16x16x32_bf16 v[112:115], a[184:187], a[128:131], v[112:115]
    s_waitcnt lgkmcnt(4)
    v_mfma_f32_16x16x32_bf16 v[128:131], a[160:163], a[128:131], v[128:131]
    ds_read_b64_tr_b16 a[176:177], v14 offset:13344
    v_mfma_f32_16x16x32_bf16 v[128:131], a[164:167], a[144:147], v[128:131]
    ds_read_b64_tr_b16 a[178:179], v14 offset:16928
    s_add_u32 m0, s44, 3072
    v_mfma_f32_16x16x32_bf16 v[132:135], a[164:167], a[148:151], v[132:135]
    buffer_load_dwordx4 v5, s[24:27], s35 offen lds
    v_mfma_f32_16x16x32_bf16 v[132:135], a[160:163], a[132:135], v[132:135]
    s_add_u32 s35, s35, s40
    v_mfma_f32_16x16x32_bf16 v[136:139], a[160:163], a[136:139], v[136:139]
    ds_read_b64_tr_b16 a[180:181], v14 offset:33824
    v_mfma_f32_16x16x32_bf16 v[136:139], a[164:167], a[152:155], v[136:139]
    ds_read_b64_tr_b16 a[182:183], v14 offset:37408
    v_mfma_f32_16x16x32_bf16 v[140:143], a[164:167], a[156:159], v[140:143]
    v_mfma_f32_16x16x32_bf16 v[140:143], a[160:163], a[140:143], v[140:143]
    s_waitcnt lgkmcnt(4)
    v_mfma_f32_16x16x32_bf16 v[156:159], a[168:171], a[140:143], v[156:159]
    ds_read_b64_tr_b16 a[184:185], v14 offset:13376
    v_mfma_f32_16x16x32_bf16 v[156:159], a[172:175], a[156:159], v[156:159]
    ds_read_b64_tr_b16 a[186:187], v14 offset:16960
    s_add_u32 m0, s44, 4096
    v_mfma_f32_16x16x32_bf16 v[152:155], a[172:175], a[152:155], v[152:155]
    buffer_load_dwordx4 v6, s[28:31], s36 offen lds
    v_mfma_f32_16x16x32_bf16 v[152:155], a[168:171], a[136:139], v[152:155]
    s_add_u32 s36, s36, s41
    v_mfma_f32_16x16x32_bf16 v[148:151], a[168:171], a[132:135], v[148:151]
    ds_read_b64_tr_b16 a[188:189], v14 offset:33856
    v_mfma_f32_16x16x32_bf16 v[148:151], a[172:175], a[148:151], v[148:151]
    ds_read_b64_tr_b16 a[190:191], v14 offset:37440
    v_mfma_f32_16x16x32_bf16 v[144:147], a[172:175], a[144:147], v[144:147]
    v_mfma_f32_16x16x32_bf16 v[144:147], a[168:171], a[128:131], v[144:147]
    s_waitcnt lgkmcnt(4)
    v_mfma_f32_16x16x32_bf16 v[160:163], a[176:179], a[128:131], v[160:163]
    ds_read_b64_tr_b16 a[160:161], v14 offset:13408
    v_mfma_f32_16x16x32_bf16 v[160:163], a[180:183], a[144:147], v[160:163]
    ds_read_b64_tr_b16 a[162:163], v14 offset:16992
    s_add_u32 m0, s44, 20480
    v_mfma_f32_16x16x32_bf16 v[164:167], a[180:183], a[148:151], v[164:167]
    buffer_load_dwordx4 v2, s[12:15], s32 offen lds
    v_mfma_f32_16x16x32_bf16 v[164:167], a[176:179], a[132:135], v[164:167]
    s_add_u32 s32, s32, s37
    v_mfma_f32_16x16x32_bf16 v[168:171], a[176:179], a[136:139], v[168:171]
    ds_read_b64_tr_b16 a[164:165], v14 offset:33888
    v_mfma_f32_16x16x32_bf16 v[168:171], a[180:183], a[152:155], v[168:171]
    ds_read_b64_tr_b16 a[166:167], v14 offset:37472
    v_mfma_f32_16x16x32_bf16 v[172:175], a[180:183], a[156:159], v[172:175]
    v_mfma_f32_16x16x32_bf16 v[172:175], a[176:179], a[140:143], v[172:175]
    s_waitcnt lgkmcnt(4)
    v_mfma_f32_16x16x32_bf16 v[188:191], a[184:187], a[140:143], v[188:191]
    ds_read_b64_tr_b16 a[168:169], v14 offset:13440
    v_mfma_f32_16x16x32_bf16 v[188:191], a[188:191], a[156:159], v[188:191]
    ds_read_b64_tr_b16 a[170:171], v14 offset:17024
    s_add_u32 m0, s44, 21504
    v_mfma_f32_16x16x32_bf16 v[184:187], a[188:191], a[152:155], v[184:187]
    buffer_load_dwordx4 v3, s[16:19], s33 offen lds
    v_mfma_f32_16x16x32_bf16 v[184:187], a[184:187], a[136:139], v[184:187]
    s_add_u32 s33, s33, s38
    v_mfma_f32_16x16x32_bf16 v[180:183], a[184:187], a[132:135], v[180:183]
    ds_read_b64_tr_b16 a[172:173], v14 offset:33920
    v_mfma_f32_16x16x32_bf16 v[180:183], a[188:191], a[148:151], v[180:183]
    ds_read_b64_tr_b16 a[174:175], v14 offset:37504
    v_mfma_f32_16x16x32_bf16 v[176:179], a[188:191], a[144:147], v[176:179]
    v_mfma_f32_16x16x32_bf16 v[176:179], a[184:187], a[128:131], v[176:179]
    s_waitcnt lgkmcnt(4)
    v_mfma_f32_16x16x32_bf16 v[192:195], a[160:163], a[128:131], v[192:195]
    ds_read_b64_tr_b16 a[176:177], v14 offset:13472
    v_mfma_f32_16x16x32_bf16 v[192:195], a[164:167], a[144:147], v[192:195]
    ds_read_b64_tr_b16 a[178:179], v14 offset:17056
    s_add_u32 m0, s44, 22528
    v_mfma_f32_16x16x32_bf16 v[196:199], a[164:167], a[148:151], v[196:199]
    buffer_load_dwordx4 v4, s[20:23], s34 offen lds
    v_mfma_f32_16x16x32_bf16 v[196:199], a[160:163], a[132:135], v[196:199]
    s_add_u32 s34, s34, s39
    v_mfma_f32_16x16x32_bf16 v[200:203], a[160:163], a[136:139], v[200:203]
    ds_read_b64_tr_b16 a[180:181], v14 offset:33952
    v_mfma_f32_16x16x32_bf16 v[200:203], a[164:167], a[152:155], v[200:203]
    ds_read_b64_tr_b16 a[182:183], v14 offset:37536
    v_mfma_f32_16x16x32_bf16 v[204:207], a[164:167], a[156:159], v[204:207]
    v_mfma_f32_16x16x32_bf16 v[204:207], a[160:163], a[140:143], v[204:207]
    s_waitcnt lgkmcnt(4)
    v_mfma_f32_16x16x32_bf16 v[220:223], a[168:171], a[140:143], v[220:223]
    ds_read_b64_tr_b16 a[184:185], v14 offset:13504
    v_mfma_f32_16x16x32_bf16 v[220:223], a[172:175], a[156:159], v[220:223]
    ds_read_b64_tr_b16 a[186:187], v14 offset:17088
    s_add_u32 m0, s44, 23552
    v_mfma_f32_16x16x32_bf16 v[216:219], a[172:175], a[152:155], v[216:219]
    buffer_load_dwordx4 v5, s[24:27], s35 offen lds
    v_mfma_f32_16x16x32_bf16 v[216:219], a[168:171], a[136:139], v[216:219]
    s_add_u32 s35, s35, s40
    v_mfma_f32_16x16x32_bf16 v[212:215], a[168:171], a[132:135], v[212:215]
    ds_read_b64_tr_b16 a[188:189], v14 offset:33984
    v_mfma_f32_16x16x32_bf16 v[212:215], a[172:175], a[148:151], v[212:215]
    ds_read_b64_tr_b16 a[190:191], v14 offset:37568
    v_mfma_f32_16x16x32_bf16 v[208:211], a[172:175], a[144:147], v[208:211]
    v_add_u32 v12, s43, v9
    v_add_u32 v13, s43, v10
    v_mfma_f32_16x16x32_bf16 v[208:211], a[168:171], a[128:131], v[208:211]
    v_add_u32 v14, s43, v11
    s_waitcnt lgkmcnt(4)
    v_mfma_f32_16x16x32_bf16 v[224:227], a[176:179], a[128:131], v[224:227]
    s_waitcnt vmcnt(18)
    s_barrier
    ds_read_b64_tr_b16 a[160:161], v12 offset:0
    v_mfma_f32_16x16x32_bf16 v[224:227], a[180:183], a[144:147], v[224:227]
    ds_read_b64_tr_b16 a[162:163], v12 offset:1024
    s_add_u32 m0, s44, 24576
    v_mfma_f32_16x16x32_bf16 v[228:231], a[180:183], a[148:151], v[228:231]
    buffer_load_dwordx4 v6, s[28:31], s36 offen lds
    v_mfma_f32_16x16x32_bf16 v[228:231], a[176:179], a[132:135], v[228:231]
    buffer_store_dword v22, v27, s[80:83], s92 offen sc0 sc1
    s_mov_b32 s92, 3145728
    s_add_u32 s36, s36, s41
    v_mfma_f32_16x16x32_bf16 v[232:235], a[176:179], a[136:139], v[232:235]
    ds_read_b64_tr_b16 a[164:165], v12 offset:20480
    v_mfma_f32_16x16x32_bf16 v[232:235], a[180:183], a[152:155], v[232:235]
    ds_read_b64_tr_b16 a[166:167], v12 offset:21504
    v_mfma_f32_16x16x32_bf16 v[236:239], a[180:183], a[156:159], v[236:239]
    s_sub_u32 s45, s45, 1
    v_mfma_f32_16x16x32_bf16 v[236:239], a[176:179], a[140:143], v[236:239]
    s_waitcnt lgkmcnt(4)
    v_mfma_f32_16x16x32_bf16 v[252:255], a[184:187], a[140:143], v[252:255]
    ds_read_b64_tr_b16 a[168:169], v13 offset:0
    v_mfma_f32_16x16x32_bf16 v[252:255], a[188:191], a[156:159], v[252:255]
    ds_read_b64_tr_b16 a[170:171], v13 offset:1024
    v_mfma_f32_16x16x32_bf16 v[248:251], a[188:191], a[152:155], v[248:251]
    s_bitcmp1_b32 s68, 1
    s_cselect_b32 s86, s69, 0
    v_mfma_f32_16x16x32_bf16 v[248:251], a[184:187], a[136:139], v[248:251]
    buffer_load_dword a210, v8, s[84:87], s89 offen
    s_add_u32 s89, s89, s88
    v_mfma_f32_16x16x32_bf16 v[244:247], a[184:187], a[132:135], v[244:247]
    ds_read_b64_tr_b16 a[172:173], v13 offset:20480
    v_mfma_f32_16x16x32_bf16 v[244:247], a[188:191], a[148:151], v[244:247]
    ds_read_b64_tr_b16 a[174:175], v13 offset:21504
    v_mfma_f32_16x16x32_bf16 v[240:243], a[188:191], a[144:147], v[240:243]
    v_mfma_f32_16x16x32_bf16 v[240:243], a[184:187], a[128:131], v[240:243]
    s_cmp_lg_u32 s45, 0
    s_cbranch_scc1 recurrent_scan__sliding_local_dilated__swiglu_ffn__prompt_kernel_loop
    s_waitcnt vmcnt(12) lgkmcnt(4)
    v_mfma_f32_16x16x32_bf16 a[0:3], a[160:163], a[96:99], a[0:3]
    ds_read_b64_tr_b16 a[176:177], v12 offset:2048
    v_mfma_f32_16x16x32_bf16 a[0:3], a[164:167], a[112:115], a[0:3]
    ds_read_b64_tr_b16 a[178:179], v12 offset:3072
    v_mfma_f32_16x16x32_bf16 a[4:7], a[164:167], a[116:119], a[4:7]
    s_lshl_b32 s96, s77, 10
    v_mfma_f32_16x16x32_bf16 a[4:7], a[160:163], a[100:103], a[4:7]
    s_add_u32 s96, s96, 589824
    v_lshlrev_b32 v24, 4, v1
    v_mfma_f32_16x16x32_bf16 a[8:11], a[160:163], a[104:107], a[8:11]
    ds_read_b64_tr_b16 a[180:181], v12 offset:22528
    v_mfma_f32_16x16x32_bf16 a[8:11], a[164:167], a[120:123], a[8:11]
    ds_read_b64_tr_b16 a[182:183], v12 offset:23552
    v_mfma_f32_16x16x32_bf16 a[12:15], a[164:167], a[124:127], a[12:15]
    buffer_load_dwordx4 a[128:131], v7, s[8:11], s42 offen offset:0 sc1
    buffer_load_dwordx4 v[16:19], v24, s[80:83], s96 offen sc1
    v_mfma_f32_16x16x32_bf16 a[12:15], a[160:163], a[108:111], a[12:15]
    s_cmp_eq_u32 s78, 0
    s_cselect_b32 s67, s90, 3145728
    s_getpc_b64 s[92:93]
recurrent_scan__sliding_local_dilated__swiglu_ffn__prompt_kernel_pc:
    s_waitcnt lgkmcnt(4)
    v_mfma_f32_16x16x32_bf16 a[28:31], a[168:171], a[108:111], a[28:31]
    ds_read_b64_tr_b16 a[184:185], v13 offset:2048
    v_mfma_f32_16x16x32_bf16 a[28:31], a[172:175], a[124:127], a[28:31]
    ds_read_b64_tr_b16 a[186:187], v13 offset:3072
    v_mfma_f32_16x16x32_bf16 a[24:27], a[172:175], a[120:123], a[24:27]
    s_mov_b32 s94, code_end - recurrent_scan__sliding_local_dilated__swiglu_ffn__prompt_kernel_pc
    v_mfma_f32_16x16x32_bf16 a[24:27], a[168:171], a[104:107], a[24:27]
    s_mov_b32 s95, 0x20000
    s_lshl_b32 s91, s7, 2
    v_mfma_f32_16x16x32_bf16 a[20:23], a[168:171], a[100:103], a[20:23]
    ds_read_b64_tr_b16 a[188:189], v13 offset:22528
    v_mfma_f32_16x16x32_bf16 a[20:23], a[172:175], a[116:119], a[20:23]
    ds_read_b64_tr_b16 a[190:191], v13 offset:23552
    v_mfma_f32_16x16x32_bf16 a[16:19], a[172:175], a[112:115], a[16:19]
    buffer_load_dwordx4 a[132:135], v30, s[8:11], s42 offen offset:0 sc1
    s_add_u32 s91, s91, s3
    v_mfma_f32_16x16x32_bf16 a[16:19], a[168:171], a[96:99], a[16:19]
    s_lshl_b32 s91, s91, 13
    buffer_load_dword a210, v15, s[92:95], s91 offen
    s_waitcnt lgkmcnt(4)
    v_mfma_f32_16x16x32_bf16 a[32:35], a[176:179], a[96:99], a[32:35]
    ds_read_b64_tr_b16 a[160:161], v12 offset:4096
    v_mfma_f32_16x16x32_bf16 a[32:35], a[180:183], a[112:115], a[32:35]
    ds_read_b64_tr_b16 a[162:163], v12 offset:5120
    v_mfma_f32_16x16x32_bf16 a[36:39], a[180:183], a[116:119], a[36:39]
    s_bfe_u32 s26, s2, 0x20001
    v_mfma_f32_16x16x32_bf16 a[36:39], a[176:179], a[100:103], a[36:39]
    s_lshl_b32 s26, s26, 2
    s_bfe_u32 s27, s2, 0x20003
    v_mfma_f32_16x16x32_bf16 a[40:43], a[176:179], a[104:107], a[40:43]
    ds_read_b64_tr_b16 a[164:165], v12 offset:24576
    v_mfma_f32_16x16x32_bf16 a[40:43], a[180:183], a[120:123], a[40:43]
    ds_read_b64_tr_b16 a[166:167], v12 offset:25600
    v_mfma_f32_16x16x32_bf16 a[44:47], a[180:183], a[124:127], a[44:47]
    buffer_load_dwordx4 a[136:139], v7, s[8:11], s42 offen offset:3072 sc1
    s_add_u32 s26, s26, s27
    v_mfma_f32_16x16x32_bf16 a[44:47], a[176:179], a[108:111], a[44:47]
    s_and_b32 s27, s2, 1
    s_lshl_b32 s28, s4, 1
    s_waitcnt lgkmcnt(4)
    v_mfma_f32_16x16x32_bf16 a[60:63], a[184:187], a[108:111], a[60:63]
    ds_read_b64_tr_b16 a[168:169], v13 offset:4096
    v_mfma_f32_16x16x32_bf16 a[60:63], a[188:191], a[124:127], a[60:63]
    ds_read_b64_tr_b16 a[170:171], v13 offset:5120
    v_mfma_f32_16x16x32_bf16 a[56:59], a[188:191], a[120:123], a[56:59]
    s_add_u32 s28, s28, s27
    v_mfma_f32_16x16x32_bf16 a[56:59], a[184:187], a[104:107], a[56:59]
recurrent_scan__sliding_local_dilated__swiglu_ffn__prompt_kernel_w3:
    s_cbranch_execz recurrent_scan__sliding_local_dilated__swiglu_ffn__prompt_kernel_w7
    s_lshl_b32 s29, s26, 3
    s_lshl_b32 s31, s3, 1
    v_mfma_f32_16x16x32_bf16 a[52:55], a[184:187], a[100:103], a[52:55]
    ds_read_b64_tr_b16 a[172:173], v13 offset:24576
    v_mfma_f32_16x16x32_bf16 a[52:55], a[188:191], a[116:119], a[52:55]
    ds_read_b64_tr_b16 a[174:175], v13 offset:25600
    v_mfma_f32_16x16x32_bf16 a[48:51], a[188:191], a[112:115], a[48:51]
    buffer_load_dwordx4 a[140:143], v30, s[8:11], s42 offen offset:3072 sc1
    s_add_u32 s29, s29, s31
    v_mfma_f32_16x16x32_bf16 a[48:51], a[184:187], a[96:99], a[48:51]
    s_add_u32 s42, s42, 196608
    v_and_b32 v26, 6, v25
    v_and_b32 v27, 7, v1
    s_waitcnt lgkmcnt(4)
    v_mfma_f32_16x16x32_bf16 a[64:67], a[96:99], a[160:163], a[64:67]
    ds_read_b64_tr_b16 a[176:177], v14 offset:6144
    v_mfma_f32_16x16x32_bf16 a[64:67], a[112:115], a[164:167], a[64:67]
    ds_read_b64_tr_b16 a[178:179], v14 offset:9728
    v_mfma_f32_16x16x32_bf16 a[68:71], a[116:119], a[164:167], a[68:71]
    v_xor_b32 v26, v26, v27
    v_mfma_f32_16x16x32_bf16 a[68:71], a[100:103], a[160:163], a[68:71]
    v_lshlrev_b32 v26, 4, v26
    s_lshl_b32 s93, s3, 4
    v_mfma_f32_16x16x32_bf16 a[72:75], a[104:107], a[160:163], a[72:75]
    ds_read_b64_tr_b16 a[180:181], v14 offset:26624
    v_mfma_f32_16x16x32_bf16 a[72:75], a[120:123], a[164:167], a[72:75]
    ds_read_b64_tr_b16 a[182:183], v14 offset:30208
    v_mfma_f32_16x16x32_bf16 a[76:79], a[124:127], a[164:167], a[76:79]
    buffer_load_dwordx4 a[144:147], v7, s[8:11], s42 offen offset:0 sc1
    s_mul_i32 s31, s27, 1792
    v_mfma_f32_16x16x32_bf16 a[76:79], a[108:111], a[160:163], a[76:79]
    s_add_u32 s31, s31, s93
    s_add_u32 s68, s8, 46137344
    s_addc_u32 s69, s9, 0
    s_waitcnt lgkmcnt(4)
    v_mfma_f32_16x16x32_bf16 a[92:95], a[108:111], a[168:171], a[92:95]
    ds_read_b64_tr_b16 a[184:185], v14 offset:6176
    v_mfma_f32_16x16x32_bf16 a[92:95], a[124:127], a[172:175], a[92:95]
    ds_read_b64_tr_b16 a[186:187], v14 offset:9760
    v_mfma_f32_16x16x32_bf16 a[88:91], a[120:123], a[172:175], a[88:91]
    s_add_u32 s70, s68, 524288
    s_addc_u32 s71, s69, 0
    v_mfma_f32_16x16x32_bf16 a[88:91], a[104:107], a[168:171], a[88:91]
    s_mov_b32 s87, 0x20000
    s_mov_b32 s91, 0x20000
    v_mfma_f32_16x16x32_bf16 a[84:87], a[100:103], a[168:171], a[84:87]
    ds_read_b64_tr_b16 a[188:189], v14 offset:26656
    v_mfma_f32_16x16x32_bf16 a[84:87], a[116:119], a[172:175], a[84:87]
    ds_read_b64_tr_b16 a[190:191], v14 offset:30240
    v_mfma_f32_16x16x32_bf16 a[80:83], a[112:115], a[172:175], a[80:83]
    buffer_load_dwordx4 a[148:151], v30, s[8:11], s42 offen offset:0 sc1
    s_lshl_b32 s46, s3, 12
    v_mfma_f32_16x16x32_bf16 a[80:83], a[96:99], a[168:171], a[80:83]
    s_xor_b32 s72, s28, 0
    s_lshl_b32 s62, s72, 7
    s_waitcnt lgkmcnt(4)
    v_mfma_f32_16x16x32_bf16 v[32:35], a[176:179], a[96:99], v[32:35]
    ds_read_b64_tr_b16 a[160:161], v14 offset:6208
    v_mfma_f32_16x16x32_bf16 v[32:35], a[180:183], a[112:115], v[32:35]
    ds_read_b64_tr_b16 a[162:163], v14 offset:9792
    v_mfma_f32_16x16x32_bf16 v[36:39], a[180:183], a[116:119], v[36:39]
    s_lshr_b32 s63, s72, 3
    v_mfma_f32_16x16x32_bf16 v[36:39], a[176:179], a[100:103], v[36:39]
    s_lshl_b32 s63, s63, 8
    s_and_b32 s72, s72, 7
    v_mfma_f32_16x16x32_bf16 v[40:43], a[176:179], a[104:107], v[40:43]
    ds_read_b64_tr_b16 a[164:165], v14 offset:26688
    v_mfma_f32_16x16x32_bf16 v[40:43], a[180:183], a[120:123], v[40:43]
    ds_read_b64_tr_b16 a[166:167], v14 offset:30272
    v_mfma_f32_16x16x32_bf16 v[44:47], a[180:183], a[124:127], v[44:47]
    buffer_load_dwordx4 a[152:155], v7, s[8:11], s42 offen offset:3072 sc1
    s_cmp_eq_u32 s72, 3
    s_cselect_b32 s62, s63, s62
    s_movk_i32 s63, 2048
    s_cselect_b32 s63, 512, s63
    s_mov_b32 s86, 7340032
    s_cselect_b32 s86, 1835008, s86
    s_cselect_b64 s[84:85], s[70:71], s[60:61]
    s_cselect_b64 s[64:65], s[68:69], s[56:57]
    s_mov_b32 s66, 0x200000
    s_cselect_b32 s66, 524288, s66
    v_mfma_f32_16x16x32_bf16 v[44:47], a[176:179], a[108:111], v[44:47]
    v_mul_lo_u32 v2, v25, s63
    v_add3_u32 v2, v2, v26, s62
    s_waitcnt lgkmcnt(4)
    v_mfma_f32_16x16x32_bf16 v[60:63], a[184:187], a[108:111], v[60:63]
    ds_read_b64_tr_b16 a[168:169], v14 offset:6240
    v_mfma_f32_16x16x32_bf16 v[60:63], a[188:191], a[124:127], v[60:63]
    ds_read_b64_tr_b16 a[170:171], v14 offset:9824
    v_mfma_f32_16x16x32_bf16 v[56:59], a[188:191], a[120:123], v[56:59]
    s_lshl_b32 s72, s63, 3
    v_mfma_f32_16x16x32_bf16 v[56:59], a[184:187], a[104:107], v[56:59]
    s_sub_u32 s72, s72, 1024
    v_add_u32 v3, s72, v2
    v_mfma_f32_16x16x32_bf16 v[52:55], a[184:187], a[100:103], v[52:55]
    ds_read_b64_tr_b16 a[172:173], v14 offset:26720
    v_mfma_f32_16x16x32_bf16 v[52:55], a[188:191], a[116:119], v[52:55]
    ds_read_b64_tr_b16 a[174:175], v14 offset:30304
    v_mfma_f32_16x16x32_bf16 v[48:51], a[188:191], a[112:115], v[48:51]
    buffer_load_dwordx4 a[156:159], v30, s[8:11], s42 offen offset:3072 sc1
    s_mul_i32 s92, s31, s63
    v_mfma_f32_16x16x32_bf16 v[48:51], a[184:187], a[96:99], v[48:51]
    s_add_u32 s42, s42, 196608
    s_lshl_b32 s95, s63, 6
    s_mul_i32 s93, s93, s63
    s_waitcnt lgkmcnt(4)
    v_mfma_f32_16x16x32_bf16 v[64:67], a[160:163], a[96:99], v[64:67]
    ds_read_b64_tr_b16 a[176:177], v14 offset:6272
    v_mfma_f32_16x16x32_bf16 v[64:67], a[164:167], a[112:115], v[64:67]
    ds_read_b64_tr_b16 a[178:179], v14 offset:9856
    v_mfma_f32_16x16x32_bf16 v[68:71], a[164:167], a[116:119], v[68:71]
    s_xor_b32 s72, s28, 1
    v_mfma_f32_16x16x32_bf16 v[68:71], a[160:163], a[100:103], v[68:71]
    s_lshl_b32 s62, s72, 7
    s_lshr_b32 s63, s72, 3
    v_mfma_f32_16x16x32_bf16 v[72:75], a[160:163], a[104:107], v[72:75]
    ds_read_b64_tr_b16 a[180:181], v14 offset:26752
    v_mfma_f32_16x16x32_bf16 v[72:75], a[164:167], a[120:123], v[72:75]
    ds_read_b64_tr_b16 a[182:183], v14 offset:30336
    v_mfma_f32_16x16x32_bf16 v[76:79], a[164:167], a[124:127], v[76:79]
    s_lshl_b32 s63, s63, 8
    v_mfma_f32_16x16x32_bf16 v[76:79], a[160:163], a[108:111], v[76:79]
    s_and_b32 s72, s72, 7
    s_cmp_eq_u32 s72, 3
    s_cselect_b32 s62, s63, s62
    s_movk_i32 s63, 2048
    s_cselect_b32 s63, 512, s63
    s_mov_b32 s90, 7340032
    s_cselect_b32 s90, 1835008, s90
    s_cselect_b64 s[88:89], s[70:71], s[60:61]
    s_waitcnt lgkmcnt(4)
    v_mfma_f32_16x16x32_bf16 v[92:95], a[168:171], a[108:111], v[92:95]
    ds_read_b64_tr_b16 a[184:185], v14 offset:6304
    v_mfma_f32_16x16x32_bf16 v[92:95], a[172:175], a[124:127], v[92:95]
    ds_read_b64_tr_b16 a[186:187], v14 offset:9888
    v_mfma_f32_16x16x32_bf16 v[88:91], a[172:175], a[120:123], v[88:91]
    v_mul_lo_u32 v15, v25, s63
    v_mfma_f32_16x16x32_bf16 v[88:91], a[168:171], a[104:107], v[88:91]
    v_add3_u32 v15, v15, v26, s62
    s_lshl_b32 s72, s63, 3
    v_mfma_f32_16x16x32_bf16 v[84:87], a[168:171], a[100:103], v[84:87]
    ds_read_b64_tr_b16 a[188:189], v14 offset:26784
    v_mfma_f32_16x16x32_bf16 v[84:87], a[172:175], a[116:119], v[84:87]
    ds_read_b64_tr_b16 a[190:191], v14 offset:30368
    v_mfma_f32_16x16x32_bf16 v[80:83], a[172:175], a[112:115], v[80:83]
    s_sub_u32 s72, s72, 1024
    v_mfma_f32_16x16x32_bf16 v[80:83], a[168:171], a[96:99], v[80:83]
    v_add_u32 v28, s72, v15
    s_mul_i32 s94, s31, s63
    s_waitcnt lgkmcnt(4)
    v_mfma_f32_16x16x32_bf16 v[96:99], a[176:179], a[96:99], v[96:99]
    ds_read_b64_tr_b16 a[160:161], v14 offset:6336
    v_mfma_f32_16x16x32_bf16 v[96:99], a[180:183], a[112:115], v[96:99]
    ds_read_b64_tr_b16 a[162:163], v14 offset:9920
    v_mfma_f32_16x16x32_bf16 v[100:103], a[180:183], a[116:119], v[100:103]
    s_lshl_b32 s97, s63, 6
    v_mfma_f32_16x16x32_bf16 v[100:103], a[176:179], a[100:103], v[100:103]
    s_sub_u32 s88, s88, 2048
    s_subb_u32 s89, s89, 0
    s_add_u32 s90, s90, 2048
    v_mfma_f32_16x16x32_bf16 v[104:107], a[176:179], a[104:107], v[104:107]
    ds_read_b64_tr_b16 a[164:165], v14 offset:26816
    s_add_u32 m0, s46, 0
    v_mfma_f32_16x16x32_bf16 v[104:107], a[180:183], a[120:123], v[104:107]
    ds_read_b64_tr_b16 a[166:167], v14 offset:30400
    buffer_load_dwordx4 v2, s[84:87], s92 offen offset:0 sc1 lds
    v_mfma_f32_16x16x32_bf16 v[108:111], a[180:183], a[124:127], v[108:111]
    s_waitcnt vmcnt(9)
    v_mfma_f32_16x16x32_bf16 v[108:111], a[176:179], a[108:111], v[108:111]
recurrent_scan__sliding_local_dilated__swiglu_ffn__prompt_kernel_g_back:
    v_cmp_eq_u32 vcc, v16, v22
    v_cmp_eq_u32 s[32:33], v17, v22
    v_cmp_eq_u32 s[34:35], v18, v22
    v_cmp_eq_u32 s[36:37], v19, v22
    s_and_b64 vcc, vcc, s[32:33]
    s_and_b64 s[34:35], s[34:35], s[36:37]
    s_and_b64 vcc, vcc, s[34:35]
    s_cmp_eq_u64 vcc, exec
    s_cbranch_scc0 recurrent_scan__sliding_local_dilated__swiglu_ffn__prompt_kernel_g_spin
recurrent_scan__sliding_local_dilated__swiglu_ffn__prompt_kernel_g_out:
    buffer_store_dword v22, v23, s[80:83], s67 offen sc0 sc1
    s_waitcnt lgkmcnt(4)
    v_mfma_f32_16x16x32_bf16 v[124:127], a[184:187], a[108:111], v[124:127]
    ds_read_b64_tr_b16 a[168:169], v14 offset:13312
    v_mfma_f32_16x16x32_bf16 v[124:127], a[188:191], a[124:127], v[124:127]
    ds_read_b64_tr_b16 a[170:171], v14 offset:16896
    buffer_load_dwordx4 v3, s[84:87], s92 offen offset:1024 sc1 lds
    s_add_u32 s92, s92, s95
    v_mfma_f32_16x16x32_bf16 v[120:123], a[188:191], a[120:123], v[120:123]
    s_lshl_b32 s40, s29, 15
    v_mfma_f32_16x16x32_bf16 v[120:123], a[184:187], a[104:107], v[120:123]
    s_lshl_b32 s41, s28, 7
    s_add_u32 s40, s40, s41
    v_mfma_f32_16x16x32_bf16 v[116:119], a[184:187], a[100:103], v[116:119]
    ds_read_b64_tr_b16 a[172:173], v14 offset:33792
    v_mfma_f32_16x16x32_bf16 v[116:119], a[188:191], a[116:119], v[116:119]
    ds_read_b64_tr_b16 a[174:175], v14 offset:37376
    buffer_load_dwordx4 v15, s[88:91], s94 offen offset:2048 sc1 lds
    v_mfma_f32_16x16x32_bf16 v[112:115], a[188:191], a[112:115], v[112:115]
    s_add_u32 s41, s40, 0x8000
    v_mfma_f32_16x16x32_bf16 v[112:115], a[184:187], a[96:99], v[112:115]
    v_and_b32 v0, 15, v1
    v_lshlrev_b32 v0, 11, v0
    s_waitcnt lgkmcnt(4)
    v_mfma_f32_16x16x32_bf16 v[128:131], a[160:163], a[96:99], v[128:131]
    ds_read_b64_tr_b16 a[176:177], v14 offset:13344
    v_mfma_f32_16x16x32_bf16 v[128:131], a[164:167], a[112:115], v[128:131]
    ds_read_b64_tr_b16 a[178:179], v14 offset:16928
    buffer_load_dwordx4 v28, s[88:91], s94 offen offset:3072 sc1 lds
    s_add_u32 s94, s94, s97
    v_mfma_f32_16x16x32_bf16 v[132:135], a[164:167], a[116:119], v[132:135]
    v_bfe_u32 v26, v1, 4, 1
    v_mfma_f32_16x16x32_bf16 v[132:135], a[160:163], a[100:103], v[132:135]
    v_lshl_add_u32 v0, v26, 5, v0
    v_lshrrev_b32 v26, 5, v1
    v_mfma_f32_16x16x32_bf16 v[136:139], a[160:163], a[104:107], v[136:139]
    ds_read_b64_tr_b16 a[180:181], v14 offset:33824
    s_add_u32 m0, s46, 16384
    v_mfma_f32_16x16x32_bf16 v[136:139], a[164:167], a[120:123], v[136:139]
    ds_read_b64_tr_b16 a[182:183], v14 offset:37408
    buffer_load_dwordx4 v2, s[84:87], s92 offen offset:0 sc1 lds
    v_mfma_f32_16x16x32_bf16 v[140:143], a[164:167], a[124:127], v[140:143]
    v_lshl_add_u32 v0, v26, 4, v0
    v_mfma_f32_16x16x32_bf16 v[140:143], a[160:163], a[108:111], v[140:143]
    s_mov_b64 s[32:33], s[54:55]
    s_mov_b32 s34, 0x400000
    s_waitcnt lgkmcnt(4)
    v_mfma_f32_16x16x32_bf16 v[156:159], a[168:171], a[108:111], v[156:159]
    ds_read_b64_tr_b16 a[184:185], v14 offset:13376
    v_mfma_f32_16x16x32_bf16 v[156:159], a[172:175], a[124:127], v[156:159]
    ds_read_b64_tr_b16 a[186:187], v14 offset:16960
    buffer_load_dwordx4 v3, s[84:87], s92 offen offset:1024 sc1 lds
    s_add_u32 s92, s92, s95
    v_mfma_f32_16x16x32_bf16 v[152:155], a[172:175], a[120:123], v[152:155]
    s_mov_b32 s35, 0x20000
    v_mfma_f32_16x16x32_bf16 v[152:155], a[168:171], a[104:107], v[152:155]
    buffer_load_dwordx4 a[224:227], v0, s[32:35], s40 offen offset:0
    buffer_load_dwordx4 a[228:231], v0, s[32:35], s40 offen offset:64
    v_mfma_f32_16x16x32_bf16 v[148:151], a[168:171], a[100:103], v[148:151]
    ds_read_b64_tr_b16 a[188:189], v14 offset:33856
    v_mfma_f32_16x16x32_bf16 v[148:151], a[172:175], a[116:119], v[148:151]
    ds_read_b64_tr_b16 a[190:191], v14 offset:37440
    buffer_load_dwordx4 v15, s[88:91], s94 offen offset:2048 sc1 lds
    v_mfma_f32_16x16x32_bf16 v[144:147], a[172:175], a[112:115], v[144:147]
    buffer_load_dwordx4 a[232:235], v0, s[32:35], s41 offen offset:0
    v_mfma_f32_16x16x32_bf16 v[144:147], a[168:171], a[96:99], v[144:147]
    buffer_load_dwordx4 a[236:239], v0, s[32:35], s41 offen offset:64
    s_lshr_b32 s75, s75, 1
    s_waitcnt lgkmcnt(4)
    v_mfma_f32_16x16x32_bf16 v[160:163], a[176:179], a[96:99], v[160:163]
    ds_read_b64_tr_b16 a[160:161], v14 offset:13408
    v_mfma_f32_16x16x32_bf16 v[160:163], a[180:183], a[112:115], v[160:163]
    ds_read_b64_tr_b16 a[162:163], v14 offset:16992
    buffer_load_dwordx4 v28, s[88:91], s94 offen offset:3072 sc1 lds
    s_add_u32 s94, s94, s97
    v_mfma_f32_16x16x32_bf16 v[164:167], a[180:183], a[116:119], v[164:167]
    s_mul_i32 s75, s75, 196608
    v_mfma_f32_16x16x32_bf16 v[164:167], a[176:179], a[100:103], v[164:167]
    s_lshr_b32 s74, s76, 1
    s_mul_i32 s74, s74, 196608
    v_mfma_f32_16x16x32_bf16 v[168:171], a[176:179], a[104:107], v[168:171]
    ds_read_b64_tr_b16 a[164:165], v14 offset:33888
    v_mfma_f32_16x16x32_bf16 v[168:171], a[180:183], a[120:123], v[168:171]
    ds_read_b64_tr_b16 a[166:167], v14 offset:37472
    v_mfma_f32_16x16x32_bf16 v[172:175], a[180:183], a[124:127], v[172:175]
    s_mul_i32 s76, s73, 1280
    v_mfma_f32_16x16x32_bf16 v[172:175], a[176:179], a[108:111], v[172:175]
    s_sub_u32 s76, s74, s76
    s_add_u32 s76, s76, 2560
    s_waitcnt lgkmcnt(4)
    v_mfma_f32_16x16x32_bf16 v[188:191], a[184:187], a[108:111], v[188:191]
    ds_read_b64_tr_b16 a[168:169], v14 offset:13440
    v_mfma_f32_16x16x32_bf16 v[188:191], a[188:191], a[124:127], v[188:191]
    ds_read_b64_tr_b16 a[170:171], v14 offset:17024
    v_mfma_f32_16x16x32_bf16 v[184:187], a[188:191], a[120:123], v[184:187]
    s_lshl_b32 s73, s73, 9
    v_mfma_f32_16x16x32_bf16 v[184:187], a[184:187], a[104:107], v[184:187]
    s_add_u32 s74, s74, s73
    s_add_u32 s74, s74, 512
    v_mfma_f32_16x16x32_bf16 v[180:183], a[184:187], a[100:103], v[180:183]
    ds_read_b64_tr_b16 a[172:173], v14 offset:33920
    v_mfma_f32_16x16x32_bf16 v[180:183], a[188:191], a[116:119], v[180:183]
    ds_read_b64_tr_b16 a[174:175], v14 offset:37504
    v_mfma_f32_16x16x32_bf16 v[176:179], a[188:191], a[112:115], v[176:179]
    v_and_b32 v5, 15, v1
    v_mfma_f32_16x16x32_bf16 v[176:179], a[184:187], a[96:99], v[176:179]
    v_lshrrev_b32 v6, 4, v1
    v_lshlrev_b32 v6, 2, v6
    s_waitcnt lgkmcnt(4)
    v_mfma_f32_16x16x32_bf16 v[192:195], a[160:163], a[96:99], v[192:195]
    ds_read_b64_tr_b16 a[176:177], v14 offset:13472
    v_mfma_f32_16x16x32_bf16 v[192:195], a[164:167], a[112:115], v[192:195]
    ds_read_b64_tr_b16 a[178:179], v14 offset:17056
    v_mfma_f32_16x16x32_bf16 v[196:199], a[164:167], a[116:119], v[196:199]
    v_sub_u32 v5, v5, v6
    v_mfma_f32_16x16x32_bf16 v[196:199], a[160:163], a[100:103], v[196:199]
    v_and_b32 v6, 1, v1
    v_cmp_eq_u32 s[16:17], 1, v6
    v_mfma_f32_16x16x32_bf16 v[200:203], a[160:163], a[104:107], v[200:203]
    ds_read_b64_tr_b16 a[180:181], v14 offset:33952
    v_mfma_f32_16x16x32_bf16 v[200:203], a[164:167], a[120:123], v[200:203]
    ds_read_b64_tr_b16 a[182:183], v14 offset:37536
    v_mfma_f32_16x16x32_bf16 v[204:207], a[164:167], a[124:127], v[204:207]
    v_sub_u32 v5, v5, v6
    v_mfma_f32_16x16x32_bf16 v[204:207], a[160:163], a[108:111], v[204:207]
    v_cmp_le_i32 s[18:19], 0, v5
    v_cmp_le_i32 s[20:21], 2, v5
    s_waitcnt lgkmcnt(4)
    v_mfma_f32_16x16x32_bf16 v[220:223], a[168:171], a[108:111], v[220:223]
    ds_read_b64_tr_b16 a[184:185], v14 offset:13504
    v_mfma_f32_16x16x32_bf16 v[220:223], a[172:175], a[124:127], v[220:223]
    ds_read_b64_tr_b16 a[186:187], v14 offset:17088
    v_mfma_f32_16x16x32_bf16 v[216:219], a[172:175], a[120:123], v[216:219]
    v_mov_b32 v5, 0xffff
    v_mfma_f32_16x16x32_bf16 v[216:219], a[168:171], a[104:107], v[216:219]
    v_mov_b32 v6, 0xffff0000
    s_lshl_b32 s32, s78, 11
    v_mfma_f32_16x16x32_bf16 v[212:215], a[168:171], a[100:103], v[212:215]
    ds_read_b64_tr_b16 a[188:189], v14 offset:33984
    v_mfma_f32_16x16x32_bf16 v[212:215], a[172:175], a[116:119], v[212:215]
    ds_read_b64_tr_b16 a[190:191], v14 offset:37568
    v_mfma_f32_16x16x32_bf16 v[208:211], a[172:175], a[112:115], v[208:211]
    v_add_u32 v12, 122880, v9
    v_add_u32 v13, 122880, v10
    s_add_u32 s32, s32, 1048576
    v_mfma_f32_16x16x32_bf16 v[208:211], a[168:171], a[96:99], v[208:211]
    v_add_u32 v14, 122880, v11
    s_lshl_b32 s33, s78, 7
    s_add_u32 s33, s33, 262144
    s_waitcnt lgkmcnt(4)
    v_mfma_f32_16x16x32_bf16 v[224:227], a[176:179], a[96:99], v[224:227]
    s_waitcnt vmcnt(25)
    s_barrier
    ds_read_b64_tr_b16 a[160:161], v12 offset:0
    v_mfma_f32_16x16x32_bf16 v[224:227], a[180:183], a[112:115], v[224:227]
    ds_read_b64_tr_b16 a[162:163], v12 offset:1024
    v_mfma_f32_16x16x32_bf16 v[228:231], a[180:183], a[116:119], v[228:231]
    s_sub_u32 s34, s78, 1
    v_mfma_f32_16x16x32_bf16 v[228:231], a[176:179], a[100:103], v[228:231]
    s_sub_u32 s35, s78, 125
    v_lshlrev_b32 v31, 4, v1
    v_mfma_f32_16x16x32_bf16 v[232:235], a[176:179], a[104:107], v[232:235]
    ds_read_b64_tr_b16 a[164:165], v12 offset:20480
    s_add_u32 m0, s46, 32768
    v_mfma_f32_16x16x32_bf16 v[232:235], a[180:183], a[120:123], v[232:235]
    ds_read_b64_tr_b16 a[166:167], v12 offset:21504
    buffer_load_dwordx4 v2, s[84:87], s92 offen offset:0 sc1 lds
    v_mfma_f32_16x16x32_bf16 v[236:239], a[180:183], a[124:127], v[236:239]
    s_cmp_eq_u32 s3, 0
    s_cselect_b32 s34, s35, s34
    v_mfma_f32_16x16x32_bf16 v[236:239], a[176:179], a[108:111], v[236:239]
    s_cmp_eq_u32 s6, 0
    s_cselect_b32 s34, s78, s34
    s_lshl_b32 s35, s34, 7
    s_waitcnt lgkmcnt(4)
    v_mfma_f32_16x16x32_bf16 v[252:255], a[184:187], a[108:111], v[252:255]
    ds_read_b64_tr_b16 a[168:169], v13 offset:0
    v_mfma_f32_16x16x32_bf16 v[252:255], a[188:191], a[124:127], v[252:255]
    ds_read_b64_tr_b16 a[170:171], v13 offset:1024
    buffer_load_dwordx4 v3, s[84:87], s92 offen offset:1024 sc1 lds
    s_add_u32 s92, s92, s95
    v_mfma_f32_16x16x32_bf16 v[248:251], a[188:191], a[120:123], v[248:251]
    s_add_u32 s35, s35, 262144
    v_mfma_f32_16x16x32_bf16 v[248:251], a[184:187], a[104:107], v[248:251]
    s_lshl_b32 s34, s34, 11
    s_add_u32 s34, s34, 1048576
    v_mfma_f32_16x16x32_bf16 v[244:247], a[184:187], a[100:103], v[244:247]
    ds_read_b64_tr_b16 a[172:173], v13 offset:20480
    v_mfma_f32_16x16x32_bf16 v[244:247], a[188:191], a[116:119], v[244:247]
    ds_read_b64_tr_b16 a[174:175], v13 offset:21504
    buffer_load_dwordx4 v15, s[88:91], s94 offen offset:2048 sc1 lds
    v_mfma_f32_16x16x32_bf16 v[240:243], a[188:191], a[112:115], v[240:243]
    v_cndmask_b32 v5, v5, v6, s[16:17]
    v_mfma_f32_16x16x32_bf16 v[240:243], a[184:187], a[96:99], v[240:243]
    v_cndmask_b32 v20, 0, v5, s[18:19]
    v_cndmask_b32 v21, 0, v5, s[20:21]
    s_waitcnt vmcnt(16) lgkmcnt(4)
    v_mfma_f32_16x16x32_bf16 a[0:3], a[160:163], a[128:131], a[0:3]
    ds_read_b64_tr_b16 a[176:177], v12 offset:2048
    v_mfma_f32_16x16x32_bf16 a[0:3], a[164:167], a[144:147], a[0:3]
    ds_read_b64_tr_b16 a[178:179], v12 offset:3072
    buffer_load_dwordx4 v28, s[88:91], s94 offen offset:3072 sc1 lds
    s_add_u32 s94, s94, s97
    v_mfma_f32_16x16x32_bf16 a[4:7], a[164:167], a[148:151], a[4:7]
    v_xor_b32 v6, v20, v5
    v_mfma_f32_16x16x32_bf16 a[4:7], a[160:163], a[132:135], a[4:7]
    v_xor_b32 v8, v21, v5
    v_mov_b32 v5, 0xff800000
    v_mfma_f32_16x16x32_bf16 a[8:11], a[160:163], a[136:139], a[8:11]
    ds_read_b64_tr_b16 a[180:181], v12 offset:22528
    s_add_u32 m0, s46, 49152
    v_mfma_f32_16x16x32_bf16 a[8:11], a[164:167], a[152:155], a[8:11]
    ds_read_b64_tr_b16 a[182:183], v12 offset:23552
    buffer_load_dwordx4 v2, s[84:87], s92 offen offset:0 sc1 lds
    v_mfma_f32_16x16x32_bf16 a[12:15], a[164:167], a[156:159], a[12:15]
    s_mov_b32 s38, 0x3e3504f3
    v_mfma_f32_16x16x32_bf16 a[12:15], a[160:163], a[140:143], a[12:15]
    s_mov_b32 s39, s38
    s_mov_b32 s12, 0xbfb8aa3b
    s_waitcnt lgkmcnt(4)
    v_mfma_f32_16x16x32_bf16 a[28:31], a[168:171], a[140:143], a[28:31]
    ds_read_b64_tr_b16 a[184:185], v13 offset:2048
    v_mfma_f32_16x16x32_bf16 a[28:31], a[172:175], a[156:159], a[28:31]
    ds_read_b64_tr_b16 a[186:187], v13 offset:3072
    buffer_load_dwordx4 v3, s[84:87], s92 offen offset:1024 sc1 lds
    s_add_u32 s92, s92, s95
    v_mfma_f32_16x16x32_bf16 a[24:27], a[172:175], a[152:155], a[24:27]
    s_mov_b32 s13, s12
    v_mfma_f32_16x16x32_bf16 a[24:27], a[168:171], a[136:139], a[24:27]
    s_mov_b32 s14, 1.0
    s_mov_b32 s15, 1.0
    v_mfma_f32_16x16x32_bf16 a[20:23], a[168:171], a[132:135], a[20:23]
    ds_read_b64_tr_b16 a[188:189], v13 offset:22528
    v_mfma_f32_16x16x32_bf16 a[20:23], a[172:175], a[148:151], a[20:23]
    ds_read_b64_tr_b16 a[190:191], v13 offset:23552
    buffer_load_dwordx4 v15, s[88:91], s94 offen offset:2048 sc1 lds
    v_mfma_f32_16x16x32_bf16 a[16:19], a[172:175], a[144:147], a[16:19]
    s_cmp_eq_u32 s6, 0
    s_cselect_b64 s[22:23], s[18:19], -1
    s_cselect_b64 s[24:25], s[20:21], -1
    v_mfma_f32_16x16x32_bf16 a[16:19], a[168:171], a[128:131], a[16:19]
    s_waitcnt lgkmcnt(4)
    v_mfma_f32_16x16x32_bf16 a[32:35], a[176:179], a[128:131], a[32:35]
    ds_read_b64_tr_b16 a[160:161], v12 offset:4096
    v_mfma_f32_16x16x32_bf16 a[32:35], a[180:183], a[144:147], a[32:35]
    ds_read_b64_tr_b16 a[162:163], v12 offset:5120
    buffer_load_dwordx4 v28, s[88:91], s94 offen offset:3072 sc1 lds
    s_add_u32 s94, s94, s97
    v_mfma_f32_16x16x32_bf16 a[36:39], a[180:183], a[148:151], a[36:39]
    s_barrier
    v_mfma_f32_16x16x32_bf16 a[36:39], a[176:179], a[132:135], a[36:39]
    v_mfma_f32_16x16x32_bf16 a[40:43], a[176:179], a[136:139], a[40:43]
    ds_read_b64_tr_b16 a[164:165], v12 offset:24576
    s_add_u32 m0, s46, 65536
    v_mfma_f32_16x16x32_bf16 a[40:43], a[180:183], a[152:155], a[40:43]
    ds_read_b64_tr_b16 a[166:167], v12 offset:25600
    buffer_load_dwordx4 v2, s[84:87], s92 offen offset:0 sc1 lds
    v_mfma_f32_16x16x32_bf16 a[44:47], a[180:183], a[156:159], a[44:47]
    v_mfma_f32_16x16x32_bf16 a[44:47], a[176:179], a[140:143], a[44:47]
    s_waitcnt lgkmcnt(4)
    v_mfma_f32_16x16x32_bf16 a[60:63], a[184:187], a[140:143], a[60:63]
    ds_read_b64_tr_b16 a[168:169], v13 offset:4096
    v_mfma_f32_16x16x32_bf16 a[60:63], a[188:191], a[156:159], a[60:63]
    ds_read_b64_tr_b16 a[170:171], v13 offset:5120
    buffer_load_dwordx4 v3, s[84:87], s92 offen offset:1024 sc1 lds
    s_add_u32 s92, s92, s95
    v_mfma_f32_16x16x32_bf16 a[56:59], a[188:191], a[152:155], a[56:59]
    v_mfma_f32_16x16x32_bf16 a[56:59], a[184:187], a[136:139], a[56:59]
    v_mfma_f32_16x16x32_bf16 a[52:55], a[184:187], a[132:135], a[52:55]
    ds_read_b64_tr_b16 a[172:173], v13 offset:24576
    v_mfma_f32_16x16x32_bf16 a[52:55], a[188:191], a[148:151], a[52:55]
    ds_read_b64_tr_b16 a[174:175], v13 offset:25600
    buffer_load_dwordx4 v15, s[88:91], s94 offen offset:2048 sc1 lds
    v_mfma_f32_16x16x32_bf16 a[48:51], a[188:191], a[144:147], a[48:51]
    v_mfma_f32_16x16x32_bf16 a[48:51], a[184:187], a[128:131], a[48:51]
    s_waitcnt lgkmcnt(4)
    v_mfma_f32_16x16x32_bf16 a[64:67], a[128:131], a[160:163], a[64:67]
    ds_read_b64_tr_b16 a[176:177], v14 offset:6144
    v_mfma_f32_16x16x32_bf16 a[64:67], a[144:147], a[164:167], a[64:67]
    ds_read_b64_tr_b16 a[178:179], v14 offset:9728
    buffer_load_dwordx4 v28, s[88:91], s94 offen offset:3072 sc1 lds
    s_add_u32 s94, s94, s97
    v_mfma_f32_16x16x32_bf16 a[68:71], a[148:151], a[164:167], a[68:71]
    v_mfma_f32_16x16x32_bf16 a[68:71], a[132:135], a[160:163], a[68:71]
    v_mfma_f32_16x16x32_bf16 a[72:75], a[136:139], a[160:163], a[72:75]
    ds_read_b64_tr_b16 a[180:181], v14 offset:26624
    s_add_u32 m0, s46, 81920
    v_mfma_f32_16x16x32_bf16 a[72:75], a[152:155], a[164:167], a[72:75]
    ds_read_b64_tr_b16 a[182:183], v14 offset:30208
    buffer_load_dwordx4 v2, s[84:87], s92 offen offset:0 sc1 lds
    v_mfma_f32_16x16x32_bf16 a[76:79], a[156:159], a[164:167], a[76:79]
    v_mfma_f32_16x16x32_bf16 a[76:79], a[140:143], a[160:163], a[76:79]
    s_waitcnt lgkmcnt(4)
    v_mfma_f32_16x16x32_bf16 a[92:95], a[140:143], a[168:171], a[92:95]
    ds_read_b64_tr_b16 a[184:185], v14 offset:6176
    v_mfma_f32_16x16x32_bf16 a[92:95], a[156:159], a[172:175], a[92:95]
    ds_read_b64_tr_b16 a[186:187], v14 offset:9760
    buffer_load_dwordx4 v3, s[84:87], s92 offen offset:1024 sc1 lds
    s_add_u32 s92, s92, s95
    v_mfma_f32_16x16x32_bf16 a[88:91], a[152:155], a[172:175], a[88:91]
    v_mfma_f32_16x16x32_bf16 a[88:91], a[136:139], a[168:171], a[88:91]
    v_mfma_f32_16x16x32_bf16 a[84:87], a[132:135], a[168:171], a[84:87]
    ds_read_b64_tr_b16 a[188:189], v14 offset:26656
    v_mfma_f32_16x16x32_bf16 a[84:87], a[148:151], a[172:175], a[84:87]
    ds_read_b64_tr_b16 a[190:191], v14 offset:30240
    buffer_load_dwordx4 v15, s[88:91], s94 offen offset:2048 sc1 lds
    v_mfma_f32_16x16x32_bf16 a[80:83], a[144:147], a[172:175], a[80:83]
    v_mfma_f32_16x16x32_bf16 a[80:83], a[128:131], a[168:171], a[80:83]
    s_waitcnt lgkmcnt(4)
    v_mfma_f32_16x16x32_bf16 v[32:35], a[176:179], a[128:131], v[32:35]
    ds_read_b64_tr_b16 a[160:161], v14 offset:6208
    v_mfma_f32_16x16x32_bf16 v[32:35], a[180:183], a[144:147], v[32:35]
    ds_read_b64_tr_b16 a[162:163], v14 offset:9792
    buffer_load_dwordx4 v28, s[88:91], s94 offen offset:3072 sc1 lds
    s_add_u32 s94, s94, s97
    v_mfma_f32_16x16x32_bf16 v[36:39], a[180:183], a[148:151], v[36:39]
    v_mfma_f32_16x16x32_bf16 v[36:39], a[176:179], a[132:135], v[36:39]
    v_mfma_f32_16x16x32_bf16 v[40:43], a[176:179], a[136:139], v[40:43]
    ds_read_b64_tr_b16 a[164:165], v14 offset:26688
    s_add_u32 m0, s46, 98304
    v_mfma_f32_16x16x32_bf16 v[40:43], a[180:183], a[152:155], v[40:43]
    ds_read_b64_tr_b16 a[166:167], v14 offset:30272
    buffer_load_dwordx4 v2, s[84:87], s92 offen offset:0 sc1 lds
    v_mfma_f32_16x16x32_bf16 v[44:47], a[180:183], a[156:159], v[44:47]
    v_mfma_f32_16x16x32_bf16 v[44:47], a[176:179], a[140:143], v[44:47]
    s_waitcnt lgkmcnt(4)
    v_mfma_f32_16x16x32_bf16 v[60:63], a[184:187], a[140:143], v[60:63]
    ds_read_b64_tr_b16 a[168:169], v14 offset:6240
    v_mfma_f32_16x16x32_bf16 v[60:63], a[188:191], a[156:159], v[60:63]
    ds_read_b64_tr_b16 a[170:171], v14 offset:9824
    buffer_load_dwordx4 v3, s[84:87], s92 offen offset:1024 sc1 lds
    s_add_u32 s92, s92, s95
    v_mfma_f32_16x16x32_bf16 v[56:59], a[188:191], a[152:155], v[56:59]
    v_accvgpr_read_b32 v9, a44
    v_mfma_f32_16x16x32_bf16 v[56:59], a[184:187], a[136:139], v[56:59]
    v_accvgpr_read_b32 v10, a45
    v_accvgpr_read_b32 v11, a46
    v_mfma_f32_16x16x32_bf16 v[52:55], a[184:187], a[132:135], v[52:55]
    ds_read_b64_tr_b16 a[172:173], v14 offset:26720
    v_mfma_f32_16x16x32_bf16 v[52:55], a[188:191], a[148:151], v[52:55]
    ds_read_b64_tr_b16 a[174:175], v14 offset:30304
    buffer_load_dwordx4 v15, s[88:91], s94 offen offset:2048 sc1 lds
    v_mfma_f32_16x16x32_bf16 v[48:51], a[188:191], a[144:147], v[48:51]
    v_accvgpr_read_b32 v17, a47
    v_mfma_f32_16x16x32_bf16 v[48:51], a[184:187], a[128:131], v[48:51]
    v_cvt_pk_bf16_f32 v16, v9, v10
    v_cvt_pk_bf16_f32 v17, v11, v17
    s_waitcnt lgkmcnt(4)
    v_mfma_f32_16x16x32_bf16 v[64:67], a[160:163], a[128:131], v[64:67]
    ds_read_b64_tr_b16 a[176:177], v14 offset:6272
    v_mfma_f32_16x16x32_bf16 v[64:67], a[164:167], a[144:147], v[64:67]
    ds_read_b64_tr_b16 a[178:179], v14 offset:9856
    buffer_load_dwordx4 v28, s[88:91], s94 offen offset:3072 sc1 lds
    s_add_u32 s94, s94, s97
    v_mfma_f32_16x16x32_bf16 v[68:71], a[164:167], a[148:151], v[68:71]
    v_accvgpr_read_b32 v9, a60
    v_mfma_f32_16x16x32_bf16 v[68:71], a[160:163], a[132:135], v[68:71]
    v_accvgpr_read_b32 v10, a61
    v_accvgpr_read_b32 v11, a62
    v_mfma_f32_16x16x32_bf16 v[72:75], a[160:163], a[136:139], v[72:75]
    ds_read_b64_tr_b16 a[180:181], v14 offset:26752
    v_mfma_f32_16x16x32_bf16 v[72:75], a[164:167], a[152:155], v[72:75]
    ds_read_b64_tr_b16 a[182:183], v14 offset:30336
    v_mfma_f32_16x16x32_bf16 v[76:79], a[164:167], a[156:159], v[76:79]
    v_accvgpr_read_b32 v19, a63
    v_mfma_f32_16x16x32_bf16 v[76:79], a[160:163], a[140:143], v[76:79]
    v_cvt_pk_bf16_f32 v18, v9, v10
    v_cvt_pk_bf16_f32 v19, v11, v19
    s_waitcnt lgkmcnt(4)
    v_mfma_f32_16x16x32_bf16 v[92:95], a[168:171], a[140:143], v[92:95]
    ds_read_b64_tr_b16 a[184:185], v14 offset:6304
    v_mfma_f32_16x16x32_bf16 v[92:95], a[172:175], a[156:159], v[92:95]
    ds_read_b64_tr_b16 a[186:187], v14 offset:9888
    v_mfma_f32_16x16x32_bf16 v[88:91], a[172:175], a[152:155], v[88:91]
    buffer_store_dwordx4 v[16:19], v31, s[80:83], s32 offen sc0 sc1
    v_mfma_f32_16x16x32_bf16 v[88:91], a[168:171], a[136:139], v[88:91]
    v_accvgpr_read_b32 v9, a76
    v_accvgpr_read_b32 v10, a77
    v_mfma_f32_16x16x32_bf16 v[84:87], a[168:171], a[132:135], v[84:87]
    ds_read_b64_tr_b16 a[188:189], v14 offset:26784
    v_mfma_f32_16x16x32_bf16 v[84:87], a[172:175], a[148:151], v[84:87]
    ds_read_b64_tr_b16 a[190:191], v14 offset:30368
    v_mfma_f32_16x16x32_bf16 v[80:83], a[172:175], a[144:147], v[80:83]
    v_accvgpr_read_b32 v11, a78
    v_mfma_f32_16x16x32_bf16 v[80:83], a[168:171], a[128:131], v[80:83]
    v_accvgpr_read_b32 v25, a79
    v_cvt_pk_bf16_f32 v24, v9, v10
    s_waitcnt lgkmcnt(4)
    v_mfma_f32_16x16x32_bf16 v[96:99], a[176:179], a[128:131], v[96:99]
    ds_read_b64_tr_b16 a[160:161], v14 offset:6336
    v_mfma_f32_16x16x32_bf16 v[96:99], a[180:183], a[144:147], v[96:99]
    ds_read_b64_tr_b16 a[162:163], v14 offset:9920
    v_mfma_f32_16x16x32_bf16 v[100:103], a[180:183], a[148:151], v[100:103]
    v_cvt_pk_bf16_f32 v25, v11, v25
    v_mfma_f32_16x16x32_bf16 v[100:103], a[176:179], a[132:135], v[100:103]
    v_accvgpr_read_b32 v9, a92
    v_accvgpr_read_b32 v10, a93
    v_mfma_f32_16x16x32_bf16 v[104:107], a[176:179], a[136:139], v[104:107]
    ds_read_b64_tr_b16 a[164:165], v14 offset:26816
recurrent_scan__sliding_local_dilated__swiglu_ffn__prompt_kernel_w4:
    s_cbranch_execz recurrent_scan__sliding_local_dilated__swiglu_ffn__prompt_kernel_w8
    v_mfma_f32_16x16x32_bf16 v[104:107], a[180:183], a[152:155], v[104:107]
    ds_read_b64_tr_b16 a[166:167], v14 offset:30400
    v_mfma_f32_16x16x32_bf16 v[108:111], a[180:183], a[156:159], v[108:111]
    v_accvgpr_read_b32 v11, a94
    v_mfma_f32_16x16x32_bf16 v[108:111], a[176:179], a[140:143], v[108:111]
    v_accvgpr_read_b32 v27, a95
    v_cvt_pk_bf16_f32 v26, v9, v10
    s_waitcnt lgkmcnt(4)
    v_mfma_f32_16x16x32_bf16 v[124:127], a[184:187], a[140:143], v[124:127]
    ds_read_b64_tr_b16 a[168:169], v14 offset:13312
    v_mfma_f32_16x16x32_bf16 v[124:127], a[188:191], a[156:159], v[124:127]
    ds_read_b64_tr_b16 a[170:171], v14 offset:16896
    v_mfma_f32_16x16x32_bf16 v[120:123], a[188:191], a[152:155], v[120:123]
    v_cvt_pk_bf16_f32 v27, v11, v27
    v_mfma_f32_16x16x32_bf16 v[120:123], a[184:187], a[136:139], v[120:123]
    buffer_store_dwordx4 v[24:27], v31, s[80:83], s32 offen offset:1024 sc0 sc1
    s_lshl_b32 s0, s2, 7
    v_mfma_f32_16x16x32_bf16 v[116:119], a[184:187], a[132:135], v[116:119]
    ds_read_b64_tr_b16 a[172:173], v14 offset:33792
    v_mfma_f32_16x16x32_bf16 v[116:119], a[188:191], a[148:151], v[116:119]
    ds_read_b64_tr_b16 a[174:175], v14 offset:37376
    v_mfma_f32_16x16x32_bf16 v[112:115], a[188:191], a[144:147], v[112:115]
    s_add_u32 s0, s0, 655360
    v_mfma_f32_16x16x32_bf16 v[112:115], a[184:187], a[128:131], v[112:115]
    v_and_b32 v10, 1, v1
    v_lshlrev_b32 v10, 16, v10
    s_waitcnt lgkmcnt(4)
    v_mfma_f32_16x16x32_bf16 v[128:131], a[160:163], a[128:131], v[128:131]
    ds_read_b64_tr_b16 a[176:177], v14 offset:13344
    v_mfma_f32_16x16x32_bf16 v[128:131], a[164:167], a[144:147], v[128:131]
    ds_read_b64_tr_b16 a[178:179], v14 offset:16928
    v_mfma_f32_16x16x32_bf16 v[132:135], a[164:167], a[148:151], v[132:135]
    buffer_load_dword a210, v10, s[80:83], s0 offen sc0 sc1
    v_mfma_f32_16x16x32_bf16 v[132:135], a[160:163], a[132:135], v[132:135]
    v_mfma_f32_16x16x32_bf16 v[136:139], a[160:163], a[136:139], v[136:139]
    ds_read_b64_tr_b16 a[180:181], v14 offset:33824
    v_mfma_f32_16x16x32_bf16 v[136:139], a[164:167], a[152:155], v[136:139]
    ds_read_b64_tr_b16 a[182:183], v14 offset:37408
    v_mfma_f32_16x16x32_bf16 v[140:143], a[164:167], a[156:159], v[140:143]
    v_mfma_f32_16x16x32_bf16 v[140:143], a[160:163], a[140:143], v[140:143]
    s_waitcnt lgkmcnt(4)
    v_mfma_f32_16x16x32_bf16 v[156:159], a[168:171], a[140:143], v[156:159]
    ds_read_b64_tr_b16 a[184:185], v14 offset:13376
    v_mfma_f32_16x16x32_bf16 v[156:159], a[172:175], a[156:159], v[156:159]
    ds_read_b64_tr_b16 a[186:187], v14 offset:16960
    v_mfma_f32_16x16x32_bf16 v[152:155], a[172:175], a[152:155], v[152:155]
    v_mfma_f32_16x16x32_bf16 v[152:155], a[168:171], a[136:139], v[152:155]
    v_mfma_f32_16x16x32_bf16 v[148:151], a[168:171], a[132:135], v[148:151]
    ds_read_b64_tr_b16 a[188:189], v14 offset:33856
    v_mfma_f32_16x16x32_bf16 v[148:151], a[172:175], a[148:151], v[148:151]
    ds_read_b64_tr_b16 a[190:191], v14 offset:37440
    v_mfma_f32_16x16x32_bf16 v[144:147], a[172:175], a[144:147], v[144:147]
    v_mfma_f32_16x16x32_bf16 v[144:147], a[168:171], a[128:131], v[144:147]
    s_waitcnt lgkmcnt(4)
    v_mfma_f32_16x16x32_bf16 v[160:163], a[176:179], a[128:131], v[160:163]
    ds_read_b64_tr_b16 a[160:161], v14 offset:13408
    v_mfma_f32_16x16x32_bf16 v[160:163], a[180:183], a[144:147], v[160:163]
    ds_read_b64_tr_b16 a[162:163], v14 offset:16992
    v_mfma_f32_16x16x32_bf16 v[164:167], a[180:183], a[148:151], v[164:167]
    v_mfma_f32_16x16x32_bf16 v[164:167], a[176:179], a[132:135], v[164:167]
    v_mfma_f32_16x16x32_bf16 v[168:171], a[176:179], a[136:139], v[168:171]
    ds_read_b64_tr_b16 a[164:165], v14 offset:33888
    v_mfma_f32_16x16x32_bf16 v[168:171], a[180:183], a[152:155], v[168:171]
    ds_read_b64_tr_b16 a[166:167], v14 offset:37472
    v_mfma_f32_16x16x32_bf16 v[172:175], a[180:183], a[156:159], v[172:175]
    v_mfma_f32_16x16x32_bf16 v[172:175], a[176:179], a[140:143], v[172:175]
    s_waitcnt lgkmcnt(4)
    v_mfma_f32_16x16x32_bf16 v[188:191], a[184:187], a[140:143], v[188:191]
    ds_read_b64_tr_b16 a[168:169], v14 offset:13440
    v_mfma_f32_16x16x32_bf16 v[188:191], a[188:191], a[156:159], v[188:191]
    ds_read_b64_tr_b16 a[170:171], v14 offset:17024
    v_mfma_f32_16x16x32_bf16 v[184:187], a[188:191], a[152:155], v[184:187]
    v_mfma_f32_16x16x32_bf16 v[184:187], a[184:187], a[136:139], v[184:187]
    v_mfma_f32_16x16x32_bf16 v[180:183], a[184:187], a[132:135], v[180:183]
    ds_read_b64_tr_b16 a[172:173], v14 offset:33920
    v_mfma_f32_16x16x32_bf16 v[180:183], a[188:191], a[148:151], v[180:183]
    ds_read_b64_tr_b16 a[174:175], v14 offset:37504
    v_mfma_f32_16x16x32_bf16 v[176:179], a[188:191], a[144:147], v[176:179]
    v_mfma_f32_16x16x32_bf16 v[176:179], a[184:187], a[128:131], v[176:179]
    s_waitcnt lgkmcnt(4)
    v_mfma_f32_16x16x32_bf16 v[192:195], a[160:163], a[128:131], v[192:195]
    ds_read_b64_tr_b16 a[176:177], v14 offset:13472
    v_mfma_f32_16x16x32_bf16 v[192:195], a[164:167], a[144:147], v[192:195]
    ds_read_b64_tr_b16 a[178:179], v14 offset:17056
    v_mfma_f32_16x16x32_bf16 v[196:199], a[164:167], a[148:151], v[196:199]
    v_mfma_f32_16x16x32_bf16 v[196:199], a[160:163], a[132:135], v[196:199]
    v_mfma_f32_16x16x32_bf16 v[200:203], a[160:163], a[136:139], v[200:203]
    ds_read_b64_tr_b16 a[180:181], v14 offset:33952
    v_mfma_f32_16x16x32_bf16 v[200:203], a[164:167], a[152:155], v[200:203]
    ds_read_b64_tr_b16 a[182:183], v14 offset:37536
    v_mfma_f32_16x16x32_bf16 v[204:207], a[164:167], a[156:159], v[204:207]
    v_mfma_f32_16x16x32_bf16 v[204:207], a[160:163], a[140:143], v[204:207]
    s_waitcnt lgkmcnt(4)
    v_mfma_f32_16x16x32_bf16 v[220:223], a[168:171], a[140:143], v[220:223]
    ds_read_b64_tr_b16 a[184:185], v14 offset:13504
    v_mfma_f32_16x16x32_bf16 v[220:223], a[172:175], a[156:159], v[220:223]
    ds_read_b64_tr_b16 a[186:187], v14 offset:17088
    v_mfma_f32_16x16x32_bf16 v[216:219], a[172:175], a[152:155], v[216:219]
    v_mfma_f32_16x16x32_bf16 v[216:219], a[168:171], a[136:139], v[216:219]
    v_mfma_f32_16x16x32_bf16 v[212:215], a[168:171], a[132:135], v[212:215]
    ds_read_b64_tr_b16 a[188:189], v14 offset:33984
    v_mfma_f32_16x16x32_bf16 v[212:215], a[172:175], a[148:151], v[212:215]
    ds_read_b64_tr_b16 a[190:191], v14 offset:37568
    v_mfma_f32_16x16x32_bf16 v[208:211], a[172:175], a[144:147], v[208:211]
    v_mfma_f32_16x16x32_bf16 v[208:211], a[168:171], a[128:131], v[208:211]
    s_waitcnt lgkmcnt(4)
    v_mfma_f32_16x16x32_bf16 v[224:227], a[176:179], a[128:131], v[224:227]
    v_mfma_f32_16x16x32_bf16 v[224:227], a[180:183], a[144:147], v[224:227]
    v_mfma_f32_16x16x32_bf16 v[228:231], a[180:183], a[148:151], v[228:231]
    v_mfma_f32_16x16x32_bf16 v[228:231], a[176:179], a[132:135], v[228:231]
    v_mfma_f32_16x16x32_bf16 v[232:235], a[176:179], a[136:139], v[232:235]
    v_mfma_f32_16x16x32_bf16 v[232:235], a[180:183], a[152:155], v[232:235]
    v_mfma_f32_16x16x32_bf16 v[236:239], a[180:183], a[156:159], v[236:239]
    v_mfma_f32_16x16x32_bf16 v[236:239], a[176:179], a[140:143], v[236:239]
    s_waitcnt lgkmcnt(0)
    v_mfma_f32_16x16x32_bf16 v[252:255], a[184:187], a[140:143], v[252:255]
    v_mfma_f32_16x16x32_bf16 v[252:255], a[188:191], a[156:159], v[252:255]
    v_mfma_f32_16x16x32_bf16 v[248:251], a[188:191], a[152:155], v[248:251]
    s_waitcnt vmcnt(1)
    v_mfma_f32_16x16x32_bf16 v[248:251], a[184:187], a[136:139], v[248:251]
    buffer_store_dword v22, v23, s[80:83], s33 offen sc0 sc1
    v_mfma_f32_16x16x32_bf16 v[244:247], a[184:187], a[132:135], v[244:247]
    v_mfma_f32_16x16x32_bf16 v[244:247], a[188:191], a[148:151], v[244:247]
    v_mfma_f32_16x16x32_bf16 v[240:243], a[188:191], a[144:147], v[240:243]
    v_mfma_f32_16x16x32_bf16 v[240:243], a[184:187], a[128:131], v[240:243]
    s_mul_i32 s36, s6, 1536
    v_lshl_add_u32 v14, v1, 3, s36
    v_pk_mul_f32 v[144:145], v[32:33], v[144:145]
    v_pk_mul_f32 v[32:33], v[32:33], s[12:13]
    v_pk_mul_f32 v[146:147], v[34:35], v[146:147]
    v_pk_mul_f32 v[34:35], v[34:35], s[12:13]
    v_pk_mul_f32 v[160:161], v[48:49], v[160:161]
    v_pk_mul_f32 v[48:49], v[48:49], s[12:13]
    v_pk_mul_f32 v[162:163], v[50:51], v[162:163]
    v_pk_mul_f32 v[50:51], v[50:51], s[12:13]
    v_exp_f32 v32, v32
    v_exp_f32 v33, v33
    v_exp_f32 v34, v34
    v_exp_f32 v35, v35
    v_exp_f32 v48, v48
    v_exp_f32 v49, v49
    v_exp_f32 v50, v50
    v_exp_f32 v51, v51
    v_pk_add_f32 v[32:33], v[32:33], s[14:15]
    v_pk_add_f32 v[34:35], v[34:35], s[14:15]
    v_pk_add_f32 v[48:49], v[48:49], s[14:15]
    v_pk_add_f32 v[50:51], v[50:51], s[14:15]
    v_rcp_f32 v32, v32
    v_rcp_f32 v33, v33
    v_rcp_f32 v34, v34
    v_rcp_f32 v35, v35
    v_rcp_f32 v48, v48
    v_rcp_f32 v49, v49
    v_rcp_f32 v50, v50
    v_rcp_f32 v51, v51
    v_pk_mul_f32 v[32:33], v[32:33], v[144:145]
    v_pk_mul_f32 v[34:35], v[34:35], v[146:147]
    v_pk_mul_f32 v[48:49], v[48:49], v[160:161]
    v_pk_mul_f32 v[50:51], v[50:51], v[162:163]
    v_cvt_pk_bf16_f32 v144, v32, v33
    v_cvt_pk_bf16_f32 v145, v34, v35
    v_cvt_pk_bf16_f32 v146, v48, v49
    v_cvt_pk_bf16_f32 v147, v50, v51
    buffer_store_dwordx4 v[144:147], v7, s[48:51], s75 offen offset:0 sc0 sc1
    v_pk_mul_f32 v[148:149], v[36:37], v[148:149]
    v_pk_mul_f32 v[36:37], v[36:37], s[12:13]
    v_pk_mul_f32 v[150:151], v[38:39], v[150:151]
    v_pk_mul_f32 v[38:39], v[38:39], s[12:13]
    v_pk_mul_f32 v[164:165], v[52:53], v[164:165]
    v_pk_mul_f32 v[52:53], v[52:53], s[12:13]
    v_pk_mul_f32 v[166:167], v[54:55], v[166:167]
    v_pk_mul_f32 v[54:55], v[54:55], s[12:13]
    v_exp_f32 v36, v36
    v_exp_f32 v37, v37
    v_exp_f32 v38, v38
    v_exp_f32 v39, v39
    v_exp_f32 v52, v52
    v_exp_f32 v53, v53
    v_exp_f32 v54, v54
    v_exp_f32 v55, v55
    v_pk_add_f32 v[36:37], v[36:37], s[14:15]
    v_pk_add_f32 v[38:39], v[38:39], s[14:15]
    v_pk_add_f32 v[52:53], v[52:53], s[14:15]
    v_pk_add_f32 v[54:55], v[54:55], s[14:15]
    v_rcp_f32 v36, v36
    v_rcp_f32 v37, v37
    v_rcp_f32 v38, v38
    v_rcp_f32 v39, v39
    v_rcp_f32 v52, v52
    v_rcp_f32 v53, v53
    v_rcp_f32 v54, v54
    v_rcp_f32 v55, v55
    v_pk_mul_f32 v[36:37], v[36:37], v[148:149]
    v_pk_mul_f32 v[38:39], v[38:39], v[150:151]
    v_pk_mul_f32 v[52:53], v[52:53], v[164:165]
    v_pk_mul_f32 v[54:55], v[54:55], v[166:167]
    v_cvt_pk_bf16_f32 v148, v36, v37
    v_cvt_pk_bf16_f32 v149, v38, v39
    v_cvt_pk_bf16_f32 v150, v52, v53
    v_cvt_pk_bf16_f32 v151, v54, v55
    buffer_store_dwordx4 v[148:151], v30, s[48:51], s75 offen offset:0 sc0 sc1
    v_pk_mul_f32 v[152:153], v[40:41], v[152:153]
    v_pk_mul_f32 v[40:41], v[40:41], s[12:13]
    v_pk_mul_f32 v[154:155], v[42:43], v[154:155]
    v_pk_mul_f32 v[42:43], v[42:43], s[12:13]
    v_pk_mul_f32 v[168:169], v[56:57], v[168:169]
    v_pk_mul_f32 v[56:57], v[56:57], s[12:13]
    v_pk_mul_f32 v[170:171], v[58:59], v[170:171]
    v_pk_mul_f32 v[58:59], v[58:59], s[12:13]
    v_exp_f32 v40, v40
    v_exp_f32 v41, v41
    v_exp_f32 v42, v42
    v_exp_f32 v43, v43
    v_exp_f32 v56, v56
    v_exp_f32 v57, v57
    v_exp_f32 v58, v58
    v_exp_f32 v59, v59
    v_pk_add_f32 v[40:41], v[40:41], s[14:15]
    v_pk_add_f32 v[42:43], v[42:43], s[14:15]
    v_pk_add_f32 v[56:57], v[56:57], s[14:15]
    v_pk_add_f32 v[58:59], v[58:59], s[14:15]
    v_rcp_f32 v40, v40
    v_rcp_f32 v41, v41
    v_rcp_f32 v42, v42
    v_rcp_f32 v43, v43
    v_rcp_f32 v56, v56
    v_rcp_f32 v57, v57
    v_rcp_f32 v58, v58
    v_rcp_f32 v59, v59
    v_pk_mul_f32 v[40:41], v[40:41], v[152:153]
    v_pk_mul_f32 v[42:43], v[42:43], v[154:155]
    v_pk_mul_f32 v[56:57], v[56:57], v[168:169]
    v_pk_mul_f32 v[58:59], v[58:59], v[170:171]
    v_cvt_pk_bf16_f32 v152, v40, v41
    v_cvt_pk_bf16_f32 v153, v42, v43
    v_cvt_pk_bf16_f32 v154, v56, v57
    v_cvt_pk_bf16_f32 v155, v58, v59
    buffer_store_dwordx4 v[152:155], v7, s[48:51], s75 offen offset:3072 sc0 sc1
    v_pk_mul_f32 v[156:157], v[44:45], v[156:157]
    v_pk_mul_f32 v[44:45], v[44:45], s[12:13]
    v_pk_mul_f32 v[158:159], v[46:47], v[158:159]
    v_pk_mul_f32 v[46:47], v[46:47], s[12:13]
    v_pk_mul_f32 v[172:173], v[60:61], v[172:173]
    v_pk_mul_f32 v[60:61], v[60:61], s[12:13]
    v_pk_mul_f32 v[174:175], v[62:63], v[174:175]
    v_pk_mul_f32 v[62:63], v[62:63], s[12:13]
    v_exp_f32 v44, v44
    v_exp_f32 v45, v45
    v_exp_f32 v46, v46
    v_exp_f32 v47, v47
    v_exp_f32 v60, v60
    v_exp_f32 v61, v61
    v_exp_f32 v62, v62
    v_exp_f32 v63, v63
    v_pk_add_f32 v[44:45], v[44:45], s[14:15]
    v_pk_add_f32 v[46:47], v[46:47], s[14:15]
    v_pk_add_f32 v[60:61], v[60:61], s[14:15]
    v_pk_add_f32 v[62:63], v[62:63], s[14:15]
    v_rcp_f32 v44, v44
    v_rcp_f32 v45, v45
    v_rcp_f32 v46, v46
    v_rcp_f32 v47, v47
    v_rcp_f32 v60, v60
    v_rcp_f32 v61, v61
    v_rcp_f32 v62, v62
    v_rcp_f32 v63, v63
    v_pk_mul_f32 v[44:45], v[44:45], v[156:157]
    v_pk_mul_f32 v[46:47], v[46:47], v[158:159]
    v_pk_mul_f32 v[60:61], v[60:61], v[172:173]
    v_pk_mul_f32 v[62:63], v[62:63], v[174:175]
    v_cvt_pk_bf16_f32 v156, v44, v45
    v_cvt_pk_bf16_f32 v157, v46, v47
    v_cvt_pk_bf16_f32 v158, v60, v61
    v_cvt_pk_bf16_f32 v159, v62, v63
    buffer_store_dwordx4 v[156:159], v30, s[48:51], s75 offen offset:3072 sc0 sc1
    s_add_u32 s75, s75, 196608
    v_pk_mul_f32 v[176:177], v[64:65], v[176:177]
    v_pk_mul_f32 v[64:65], v[64:65], s[12:13]
    v_pk_mul_f32 v[178:179], v[66:67], v[178:179]
    v_pk_mul_f32 v[66:67], v[66:67], s[12:13]
    v_pk_mul_f32 v[192:193], v[80:81], v[192:193]
    v_pk_mul_f32 v[80:81], v[80:81], s[12:13]
    v_pk_mul_f32 v[194:195], v[82:83], v[194:195]
    v_pk_mul_f32 v[82:83], v[82:83], s[12:13]
    v_exp_f32 v64, v64
    v_exp_f32 v65, v65
    v_exp_f32 v66, v66
    v_exp_f32 v67, v67
    v_exp_f32 v80, v80
    v_exp_f32 v81, v81
    v_exp_f32 v82, v82
    v_exp_f32 v83, v83
    v_pk_add_f32 v[64:65], v[64:65], s[14:15]
    v_pk_add_f32 v[66:67], v[66:67], s[14:15]
    v_pk_add_f32 v[80:81], v[80:81], s[14:15]
    v_pk_add_f32 v[82:83], v[82:83], s[14:15]
    v_rcp_f32 v64, v64
    v_rcp_f32 v65, v65
    v_rcp_f32 v66, v66
    v_rcp_f32 v67, v67
    v_rcp_f32 v80, v80
    v_rcp_f32 v81, v81
    v_rcp_f32 v82, v82
    v_rcp_f32 v83, v83
    v_pk_mul_f32 v[64:65], v[64:65], v[176:177]
    v_pk_mul_f32 v[66:67], v[66:67], v[178:179]
    v_pk_mul_f32 v[80:81], v[80:81], v[192:193]
    v_pk_mul_f32 v[82:83], v[82:83], v[194:195]
    v_cvt_pk_bf16_f32 v176, v64, v65
    v_cvt_pk_bf16_f32 v177, v66, v67
    v_cvt_pk_bf16_f32 v178, v80, v81
    v_cvt_pk_bf16_f32 v179, v82, v83
    buffer_load_dword v12, v23, s[80:83], s35 offen sc0 sc1
    buffer_store_dwordx4 v[176:179], v7, s[48:51], s75 offen offset:0 sc0 sc1
    v_pk_mul_f32 v[180:181], v[68:69], v[180:181]
    v_pk_mul_f32 v[68:69], v[68:69], s[12:13]
    v_pk_mul_f32 v[182:183], v[70:71], v[182:183]
    v_pk_mul_f32 v[70:71], v[70:71], s[12:13]
    v_pk_mul_f32 v[196:197], v[84:85], v[196:197]
    v_pk_mul_f32 v[84:85], v[84:85], s[12:13]
    v_pk_mul_f32 v[198:199], v[86:87], v[198:199]
    v_pk_mul_f32 v[86:87], v[86:87], s[12:13]
    v_exp_f32 v68, v68
    v_exp_f32 v69, v69
    v_exp_f32 v70, v70
    v_exp_f32 v71, v71
    v_exp_f32 v84, v84
    v_exp_f32 v85, v85
    v_exp_f32 v86, v86
    v_exp_f32 v87, v87
    v_pk_add_f32 v[68:69], v[68:69], s[14:15]
    v_pk_add_f32 v[70:71], v[70:71], s[14:15]
    v_pk_add_f32 v[84:85], v[84:85], s[14:15]
    v_pk_add_f32 v[86:87], v[86:87], s[14:15]
    v_rcp_f32 v68, v68
    v_rcp_f32 v69, v69
    v_rcp_f32 v70, v70
    v_rcp_f32 v71, v71
    v_rcp_f32 v84, v84
    v_rcp_f32 v85, v85
    v_rcp_f32 v86, v86
    v_rcp_f32 v87, v87
    v_pk_mul_f32 v[68:69], v[68:69], v[180:181]
    v_pk_mul_f32 v[70:71], v[70:71], v[182:183]
    v_pk_mul_f32 v[84:85], v[84:85], v[196:197]
    v_pk_mul_f32 v[86:87], v[86:87], v[198:199]
    v_cvt_pk_bf16_f32 v180, v68, v69
    v_cvt_pk_bf16_f32 v181, v70, v71
    v_cvt_pk_bf16_f32 v182, v84, v85
    v_cvt_pk_bf16_f32 v183, v86, v87
    buffer_store_dwordx4 v[180:183], v30, s[48:51], s75 offen offset:0 sc0 sc1
    v_pk_mul_f32 v[184:185], v[72:73], v[184:185]
    v_pk_mul_f32 v[72:73], v[72:73], s[12:13]
    v_pk_mul_f32 v[186:187], v[74:75], v[186:187]
    v_pk_mul_f32 v[74:75], v[74:75], s[12:13]
    v_pk_mul_f32 v[200:201], v[88:89], v[200:201]
    v_pk_mul_f32 v[88:89], v[88:89], s[12:13]
    v_pk_mul_f32 v[202:203], v[90:91], v[202:203]
    v_pk_mul_f32 v[90:91], v[90:91], s[12:13]
    v_exp_f32 v72, v72
    v_exp_f32 v73, v73
    v_exp_f32 v74, v74
    v_exp_f32 v75, v75
    v_exp_f32 v88, v88
    v_exp_f32 v89, v89
    v_exp_f32 v90, v90
    v_exp_f32 v91, v91
    v_pk_add_f32 v[72:73], v[72:73], s[14:15]
    v_pk_add_f32 v[74:75], v[74:75], s[14:15]
    v_pk_add_f32 v[88:89], v[88:89], s[14:15]
    v_pk_add_f32 v[90:91], v[90:91], s[14:15]
    v_rcp_f32 v72, v72
    v_rcp_f32 v73, v73
    v_rcp_f32 v74, v74
    v_rcp_f32 v75, v75
    v_rcp_f32 v88, v88
    v_rcp_f32 v89, v89
    v_rcp_f32 v90, v90
    v_rcp_f32 v91, v91
    v_pk_mul_f32 v[72:73], v[72:73], v[184:185]
    v_pk_mul_f32 v[74:75], v[74:75], v[186:187]
    v_pk_mul_f32 v[88:89], v[88:89], v[200:201]
    v_pk_mul_f32 v[90:91], v[90:91], v[202:203]
    v_cvt_pk_bf16_f32 v184, v72, v73
    v_cvt_pk_bf16_f32 v185, v74, v75
    v_cvt_pk_bf16_f32 v186, v88, v89
    v_cvt_pk_bf16_f32 v187, v90, v91
    buffer_store_dwordx4 v[184:187], v7, s[48:51], s75 offen offset:3072 sc0 sc1
    v_pk_mul_f32 v[188:189], v[76:77], v[188:189]
    v_pk_mul_f32 v[76:77], v[76:77], s[12:13]
    v_pk_mul_f32 v[190:191], v[78:79], v[190:191]
    v_pk_mul_f32 v[78:79], v[78:79], s[12:13]
    v_pk_mul_f32 v[204:205], v[92:93], v[204:205]
    v_pk_mul_f32 v[92:93], v[92:93], s[12:13]
    v_pk_mul_f32 v[206:207], v[94:95], v[206:207]
    v_pk_mul_f32 v[94:95], v[94:95], s[12:13]
    v_exp_f32 v76, v76
    v_exp_f32 v77, v77
    v_exp_f32 v78, v78
    v_exp_f32 v79, v79
    v_exp_f32 v92, v92
    v_exp_f32 v93, v93
    v_exp_f32 v94, v94
    v_exp_f32 v95, v95
    v_pk_add_f32 v[76:77], v[76:77], s[14:15]
    v_pk_add_f32 v[78:79], v[78:79], s[14:15]
    v_pk_add_f32 v[92:93], v[92:93], s[14:15]
    v_pk_add_f32 v[94:95], v[94:95], s[14:15]
    v_rcp_f32 v76, v76
    v_rcp_f32 v77, v77
    v_rcp_f32 v78, v78
    v_rcp_f32 v79, v79
    v_rcp_f32 v92, v92
    v_rcp_f32 v93, v93
    v_rcp_f32 v94, v94
    v_rcp_f32 v95, v95
    v_pk_mul_f32 v[76:77], v[76:77], v[188:189]
    v_pk_mul_f32 v[78:79], v[78:79], v[190:191]
    v_pk_mul_f32 v[92:93], v[92:93], v[204:205]
    v_pk_mul_f32 v[94:95], v[94:95], v[206:207]
    v_cvt_pk_bf16_f32 v188, v76, v77
    v_cvt_pk_bf16_f32 v189, v78, v79
    v_cvt_pk_bf16_f32 v190, v92, v93
    v_cvt_pk_bf16_f32 v191, v94, v95
    buffer_store_dwordx4 v[188:191], v30, s[48:51], s75 offen offset:3072 sc0 sc1
    s_add_u32 s75, s75, 196608
    v_pk_mul_f32 v[208:209], v[96:97], v[208:209]
    v_pk_mul_f32 v[96:97], v[96:97], s[12:13]
    v_pk_mul_f32 v[210:211], v[98:99], v[210:211]
    v_pk_mul_f32 v[98:99], v[98:99], s[12:13]
    v_pk_mul_f32 v[224:225], v[112:113], v[224:225]
    v_pk_mul_f32 v[112:113], v[112:113], s[12:13]
    v_pk_mul_f32 v[226:227], v[114:115], v[226:227]
    v_pk_mul_f32 v[114:115], v[114:115], s[12:13]
    v_exp_f32 v96, v96
    v_exp_f32 v97, v97
    v_exp_f32 v98, v98
    v_exp_f32 v99, v99
    v_exp_f32 v112, v112
    v_exp_f32 v113, v113
    v_exp_f32 v114, v114
    v_exp_f32 v115, v115
    v_pk_add_f32 v[96:97], v[96:97], s[14:15]
    v_pk_add_f32 v[98:99], v[98:99], s[14:15]
    v_pk_add_f32 v[112:113], v[112:113], s[14:15]
    v_pk_add_f32 v[114:115], v[114:115], s[14:15]
    v_rcp_f32 v96, v96
    v_rcp_f32 v97, v97
    v_rcp_f32 v98, v98
    v_rcp_f32 v99, v99
    v_rcp_f32 v112, v112
    v_rcp_f32 v113, v113
    v_rcp_f32 v114, v114
    v_rcp_f32 v115, v115
    v_pk_mul_f32 v[96:97], v[96:97], v[208:209]
    v_pk_mul_f32 v[98:99], v[98:99], v[210:211]
    v_pk_mul_f32 v[112:113], v[112:113], v[224:225]
    v_pk_mul_f32 v[114:115], v[114:115], v[226:227]
    v_cvt_pk_bf16_f32 v208, v96, v97
    v_cvt_pk_bf16_f32 v209, v98, v99
    v_cvt_pk_bf16_f32 v210, v112, v113
    v_cvt_pk_bf16_f32 v211, v114, v115
    buffer_store_dwordx4 v[208:211], v7, s[48:51], s75 offen offset:0 sc0 sc1
    v_pk_mul_f32 v[212:213], v[100:101], v[212:213]
    v_pk_mul_f32 v[100:101], v[100:101], s[12:13]
    v_pk_mul_f32 v[214:215], v[102:103], v[214:215]
    v_pk_mul_f32 v[102:103], v[102:103], s[12:13]
    v_pk_mul_f32 v[228:229], v[116:117], v[228:229]
    v_pk_mul_f32 v[116:117], v[116:117], s[12:13]
    v_pk_mul_f32 v[230:231], v[118:119], v[230:231]
    v_pk_mul_f32 v[118:119], v[118:119], s[12:13]
    v_exp_f32 v100, v100
    v_exp_f32 v101, v101
    v_exp_f32 v102, v102
    v_exp_f32 v103, v103
    v_exp_f32 v116, v116
    v_exp_f32 v117, v117
    v_exp_f32 v118, v118
    v_exp_f32 v119, v119
    v_pk_add_f32 v[100:101], v[100:101], s[14:15]
    v_pk_add_f32 v[102:103], v[102:103], s[14:15]
    v_pk_add_f32 v[116:117], v[116:117], s[14:15]
    v_pk_add_f32 v[118:119], v[118:119], s[14:15]
    v_rcp_f32 v100, v100
    v_rcp_f32 v101, v101
    v_rcp_f32 v102, v102
    v_rcp_f32 v103, v103
    v_rcp_f32 v116, v116
    v_rcp_f32 v117, v117
    v_rcp_f32 v118, v118
    v_rcp_f32 v119, v119
    v_pk_mul_f32 v[100:101], v[100:101], v[212:213]
    v_pk_mul_f32 v[102:103], v[102:103], v[214:215]
    v_pk_mul_f32 v[116:117], v[116:117], v[228:229]
    v_pk_mul_f32 v[118:119], v[118:119], v[230:231]
    v_cvt_pk_bf16_f32 v212, v100, v101
    v_cvt_pk_bf16_f32 v213, v102, v103
    v_cvt_pk_bf16_f32 v214, v116, v117
    v_cvt_pk_bf16_f32 v215, v118, v119
    buffer_store_dwordx4 v[212:215], v30, s[48:51], s75 offen offset:0 sc0 sc1
    v_pk_mul_f32 v[216:217], v[104:105], v[216:217]
    v_pk_mul_f32 v[104:105], v[104:105], s[12:13]
    v_pk_mul_f32 v[218:219], v[106:107], v[218:219]
    v_pk_mul_f32 v[106:107], v[106:107], s[12:13]
    v_pk_mul_f32 v[232:233], v[120:121], v[232:233]
    v_pk_mul_f32 v[120:121], v[120:121], s[12:13]
    v_pk_mul_f32 v[234:235], v[122:123], v[234:235]
    v_pk_mul_f32 v[122:123], v[122:123], s[12:13]
    v_exp_f32 v104, v104
    v_exp_f32 v105, v105
    v_exp_f32 v106, v106
    v_exp_f32 v107, v107
    v_exp_f32 v120, v120
    v_exp_f32 v121, v121
    v_exp_f32 v122, v122
    v_exp_f32 v123, v123
    v_pk_add_f32 v[104:105], v[104:105], s[14:15]
    v_pk_add_f32 v[106:107], v[106:107], s[14:15]
    v_pk_add_f32 v[120:121], v[120:121], s[14:15]
    v_pk_add_f32 v[122:123], v[122:123], s[14:15]
    v_rcp_f32 v104, v104
    v_rcp_f32 v105, v105
    v_rcp_f32 v106, v106
    v_rcp_f32 v107, v107
    v_rcp_f32 v120, v120
    v_rcp_f32 v121, v121
    v_rcp_f32 v122, v122
    v_rcp_f32 v123, v123
    v_pk_mul_f32 v[104:105], v[104:105], v[216:217]
    v_pk_mul_f32 v[106:107], v[106:107], v[218:219]
    v_pk_mul_f32 v[120:121], v[120:121], v[232:233]
    v_pk_mul_f32 v[122:123], v[122:123], v[234:235]
    v_cvt_pk_bf16_f32 v216, v104, v105
    v_cvt_pk_bf16_f32 v217, v106, v107
    v_cvt_pk_bf16_f32 v218, v120, v121
    v_cvt_pk_bf16_f32 v219, v122, v123
    buffer_store_dwordx4 v[216:219], v7, s[48:51], s75 offen offset:3072 sc0 sc1
    v_pk_mul_f32 v[220:221], v[108:109], v[220:221]
    v_pk_mul_f32 v[108:109], v[108:109], s[12:13]
    v_pk_mul_f32 v[222:223], v[110:111], v[222:223]
    v_pk_mul_f32 v[110:111], v[110:111], s[12:13]
    v_pk_mul_f32 v[236:237], v[124:125], v[236:237]
    v_pk_mul_f32 v[124:125], v[124:125], s[12:13]
    v_pk_mul_f32 v[238:239], v[126:127], v[238:239]
    v_pk_mul_f32 v[126:127], v[126:127], s[12:13]
    v_exp_f32 v108, v108
    v_exp_f32 v109, v109
    v_exp_f32 v110, v110
    v_exp_f32 v111, v111
    v_exp_f32 v124, v124
    v_exp_f32 v125, v125
    v_exp_f32 v126, v126
    v_exp_f32 v127, v127
    v_pk_add_f32 v[108:109], v[108:109], s[14:15]
    v_pk_add_f32 v[110:111], v[110:111], s[14:15]
    v_pk_add_f32 v[124:125], v[124:125], s[14:15]
    v_pk_add_f32 v[126:127], v[126:127], s[14:15]
    v_rcp_f32 v108, v108
    v_rcp_f32 v109, v109
    v_rcp_f32 v110, v110
    v_rcp_f32 v111, v111
    v_rcp_f32 v124, v124
    v_rcp_f32 v125, v125
    v_rcp_f32 v126, v126
    v_rcp_f32 v127, v127
    v_pk_mul_f32 v[108:109], v[108:109], v[220:221]
    v_pk_mul_f32 v[110:111], v[110:111], v[222:223]
    v_pk_mul_f32 v[124:125], v[124:125], v[236:237]
    v_pk_mul_f32 v[126:127], v[126:127], v[238:239]
    v_cvt_pk_bf16_f32 v220, v108, v109
    v_cvt_pk_bf16_f32 v221, v110, v111
    v_cvt_pk_bf16_f32 v222, v124, v125
    v_cvt_pk_bf16_f32 v223, v126, v127
    s_waitcnt vmcnt(7)
recurrent_scan__sliding_local_dilated__swiglu_ffn__prompt_kernel_spin_back:
    v_cmp_eq_u32 vcc, v12, v22
    s_cmp_eq_u64 vcc, exec
    s_cbranch_scc0 recurrent_scan__sliding_local_dilated__swiglu_ffn__prompt_kernel_spin_spin
recurrent_scan__sliding_local_dilated__swiglu_ffn__prompt_kernel_spin_out:
    buffer_load_dwordx4 v[48:51], v31, s[80:83], s34 offen sc0 sc1
    buffer_load_dwordx4 v[64:67], v31, s[80:83], s34 offen offset:1024 sc0 sc1
    buffer_store_dwordx4 v[220:223], v30, s[48:51], s75 offen offset:3072 sc0 sc1
    s_add_u32 s75, s75, 196608
    v_pk_mul_f32 v[240:241], v[128:129], v[240:241]
    v_pk_mul_f32 v[128:129], v[128:129], s[12:13]
    v_pk_mul_f32 v[242:243], v[130:131], v[242:243]
    v_pk_mul_f32 v[130:131], v[130:131], s[12:13]
    v_pk_mul_f32 v[244:245], v[132:133], v[244:245]
    v_pk_mul_f32 v[132:133], v[132:133], s[12:13]
    v_pk_mul_f32 v[246:247], v[134:135], v[246:247]
    v_pk_mul_f32 v[134:135], v[134:135], s[12:13]
    v_exp_f32 v128, v128
    v_exp_f32 v129, v129
    v_exp_f32 v130, v130
    v_exp_f32 v131, v131
    v_exp_f32 v132, v132
    v_exp_f32 v133, v133
    v_exp_f32 v134, v134
    v_exp_f32 v135, v135
    v_pk_add_f32 v[128:129], v[128:129], s[14:15]
    v_pk_add_f32 v[130:131], v[130:131], s[14:15]
    v_pk_add_f32 v[132:133], v[132:133], s[14:15]
    v_pk_add_f32 v[134:135], v[134:135], s[14:15]
    v_rcp_f32 v128, v128
    v_rcp_f32 v129, v129
    v_rcp_f32 v130, v130
    v_rcp_f32 v131, v131
    v_rcp_f32 v132, v132
    v_rcp_f32 v133, v133
    v_rcp_f32 v134, v134
    v_rcp_f32 v135, v135
    v_pk_mul_f32 v[128:129], v[128:129], v[240:241]
    v_pk_mul_f32 v[130:131], v[130:131], v[242:243]
    v_pk_mul_f32 v[132:133], v[132:133], v[244:245]
    v_pk_mul_f32 v[134:135], v[134:135], v[246:247]
    v_cvt_pk_bf16_f32 v240, v128, v129
    v_cvt_pk_bf16_f32 v241, v130, v131
    v_cvt_pk_bf16_f32 v242, v132, v133
    v_cvt_pk_bf16_f32 v243, v134, v135
    buffer_store_dwordx2 v[240:241], v14, s[48:51], s74 offen offset:0 sc0 sc1
    buffer_store_dwordx2 v[242:243], v14, s[48:51], s76 offen offset:0 sc0 sc1
    v_pk_mul_f32 v[248:249], v[136:137], v[248:249]
    v_pk_mul_f32 v[136:137], v[136:137], s[12:13]
    v_pk_mul_f32 v[250:251], v[138:139], v[250:251]
    v_pk_mul_f32 v[138:139], v[138:139], s[12:13]
    v_pk_mul_f32 v[252:253], v[140:141], v[252:253]
recurrent_scan__sliding_local_dilated__swiglu_ffn__prompt_kernel_w5:
    s_cbranch_execz recurrent_scan__sliding_local_dilated__swiglu_ffn__prompt_kernel_w9
    v_pk_mul_f32 v[140:141], v[140:141], s[12:13]
    v_pk_mul_f32 v[254:255], v[142:143], v[254:255]
    v_pk_mul_f32 v[142:143], v[142:143], s[12:13]
    v_exp_f32 v136, v136
    v_exp_f32 v137, v137
    v_exp_f32 v138, v138
    v_exp_f32 v139, v139
    v_exp_f32 v140, v140
    v_exp_f32 v141, v141
    v_exp_f32 v142, v142
    v_exp_f32 v143, v143
    v_pk_add_f32 v[136:137], v[136:137], s[14:15]
    v_pk_add_f32 v[138:139], v[138:139], s[14:15]
    v_pk_add_f32 v[140:141], v[140:141], s[14:15]
    v_pk_add_f32 v[142:143], v[142:143], s[14:15]
    v_rcp_f32 v136, v136
    v_rcp_f32 v137, v137
    v_rcp_f32 v138, v138
    v_rcp_f32 v139, v139
    v_rcp_f32 v140, v140
    v_rcp_f32 v141, v141
    v_rcp_f32 v142, v142
    v_rcp_f32 v143, v143
    v_pk_mul_f32 v[136:137], v[136:137], v[248:249]
    v_pk_mul_f32 v[138:139], v[138:139], v[250:251]
    v_pk_mul_f32 v[140:141], v[140:141], v[252:253]
    v_pk_mul_f32 v[142:143], v[142:143], v[254:255]
    v_cvt_pk_bf16_f32 v248, v136, v137
    v_cvt_pk_bf16_f32 v249, v138, v139
    v_cvt_pk_bf16_f32 v250, v140, v141
    v_cvt_pk_bf16_f32 v251, v142, v143
    buffer_store_dwordx2 v[248:249], v14, s[48:51], s74 offen offset:3072 sc0 sc1
    buffer_store_dwordx2 v[250:251], v14, s[48:51], s76 offen offset:3072 sc0 sc1
    s_lshr_b32 s62, s79, 4
    s_lshl_b32 s62, s62, 11
    s_and_b32 s63, s79, 15
    s_lshl_b32 s63, s63, 2
    s_add_u32 s62, s62, s63
    s_add_u32 s62, s62, 655360
    s_lshl_b32 s63, s4, 12
    s_lshl_b32 s72, s5, 2
    s_add_u32 s63, s63, s72
    s_add_u32 s63, s63, 720896
    s_cmp_eq_u32 s3, 0
    s_cselect_b32 s62, s62, 3145728
    s_cselect_b32 s63, s63, 3145728
    s_mov_b64 s[0:1], s[54:55]
    s_mul_i32 s42, s27, 11010048
    s_mov_b32 s54, 0x400000
    s_mov_b32 s55, 0x20000
    s_lshr_b32 s31, s26, 1
    s_and_b32 s72, s26, 1
    s_lshl_b32 s72, s72, 3
    s_add_u32 s72, s72, s4
    s_lshl_b32 s70, s72, 1
    s_add_u32 s70, s70, s27
    s_xor_b32 s71, s70, 1
    s_mul_i32 s70, s70, 196608
    s_mul_i32 s71, s71, 196608
    s_add_u32 s70, s70, 0
    s_add_u32 s71, s71, 0
    s_mov_b32 s10, 12582912
    s_lshl_b32 s30, s31, 1
    s_add_u32 s30, s30, s27
    s_lshl_b32 s30, s30, 4
    s_add_u32 s30, s30, s72
    s_lshl_b32 s30, s30, 7
    s_lshl_b32 s68, s2, 2
    s_add_u32 s68, s68, s3
    s_xor_b32 s69, s68, 4
    s_lshl_b32 s68, s68, 8
    s_lshl_b32 s69, s69, 8
    s_sub_u32 s72, s29, s6
    s_mul_i32 s72, s72, 1536
    v_add_u32 v220, s72, v7
    v_add_u32 v221, s72, v30
    s_mul_i32 s72, s29, 1536
    v_lshl_add_u32 v222, v1, 3, s72
    s_sub_u32 s72, s31, s4
    s_mul_i32 s72, s72, 24576
    v_add_u32 v224, s72, v7
    v_add_u32 v225, s72, v30
    v_and_b32 v226, 15, v1
    v_lshlrev_b32 v226, 2, v226
    s_and_b32 s47, s30, 0xfffff9ff
    s_add_u32 s47, s47, 655360
    s_and_b32 s30, s30, 0xfffff87f
    s_add_u32 s30, s30, 720896
    v_accvgpr_read_b32 v96, a0
    v_accvgpr_read_b32 v97, a1
    v_accvgpr_read_b32 v98, a2
    v_accvgpr_read_b32 v99, a3
    v_cvt_pk_bf16_f32 v32, v96, v97
    v_cvt_pk_bf16_f32 v33, v98, v99
    v_accvgpr_read_b32 v100, a16
    v_accvgpr_read_b32 v101, a17
    v_accvgpr_read_b32 v102, a18
    v_accvgpr_read_b32 v103, a19
    v_cvt_pk_bf16_f32 v34, v100, v101
    v_cvt_pk_bf16_f32 v35, v102, v103
    v_accvgpr_read_b32 v104, a32
    v_accvgpr_read_b32 v105, a33
    v_accvgpr_read_b32 v106, a34
    v_accvgpr_read_b32 v107, a35
    v_cvt_pk_bf16_f32 v52, v104, v105
    v_cvt_pk_bf16_f32 v53, v106, v107
    v_accvgpr_read_b32 v108, a48
    v_accvgpr_read_b32 v109, a49
    v_accvgpr_read_b32 v110, a50
    v_accvgpr_read_b32 v111, a51
    v_cvt_pk_bf16_f32 v54, v108, v109
    v_cvt_pk_bf16_f32 v55, v110, v111
    v_accvgpr_read_b32 v96, a64
    v_accvgpr_read_b32 v97, a65
    v_accvgpr_read_b32 v98, a66
    v_accvgpr_read_b32 v99, a67
    v_cvt_pk_bf16_f32 v70, v96, v97
    v_cvt_pk_bf16_f32 v71, v98, v99
    v_accvgpr_read_b32 v100, a80
    v_accvgpr_read_b32 v101, a81
    v_accvgpr_read_b32 v102, a82
    v_accvgpr_read_b32 v103, a83
    v_cvt_pk_bf16_f32 v80, v100, v101
    v_cvt_pk_bf16_f32 v81, v102, v103
    v_accvgpr_read_b32 v104, a4
    v_accvgpr_read_b32 v105, a5
    v_accvgpr_read_b32 v106, a6
    v_accvgpr_read_b32 v107, a7
    v_cvt_pk_bf16_f32 v36, v104, v105
    v_cvt_pk_bf16_f32 v37, v106, v107
    v_accvgpr_read_b32 v108, a20
    v_accvgpr_read_b32 v109, a21
    v_accvgpr_read_b32 v110, a22
    v_accvgpr_read_b32 v111, a23
    v_cvt_pk_bf16_f32 v38, v108, v109
    v_cvt_pk_bf16_f32 v39, v110, v111
    v_accvgpr_read_b32 v96, a36
    v_accvgpr_read_b32 v97, a37
    v_accvgpr_read_b32 v98, a38
    v_accvgpr_read_b32 v99, a39
    v_cvt_pk_bf16_f32 v56, v96, v97
    v_cvt_pk_bf16_f32 v57, v98, v99
    v_accvgpr_read_b32 v100, a52
    v_accvgpr_read_b32 v101, a53
    v_accvgpr_read_b32 v102, a54
    v_accvgpr_read_b32 v103, a55
    v_cvt_pk_bf16_f32 v58, v100, v101
    v_cvt_pk_bf16_f32 v59, v102, v103
    v_accvgpr_read_b32 v104, a68
    v_accvgpr_read_b32 v105, a69
    v_accvgpr_read_b32 v106, a70
    v_accvgpr_read_b32 v107, a71
    v_cvt_pk_bf16_f32 v72, v104, v105
    v_cvt_pk_bf16_f32 v73, v106, v107
    v_accvgpr_read_b32 v108, a84
    v_accvgpr_read_b32 v109, a85
    v_accvgpr_read_b32 v110, a86
    v_accvgpr_read_b32 v111, a87
    v_cvt_pk_bf16_f32 v82, v108, v109
    v_cvt_pk_bf16_f32 v83, v110, v111
    v_accvgpr_read_b32 v96, a8
    v_accvgpr_read_b32 v97, a9
    v_accvgpr_read_b32 v98, a10
    v_accvgpr_read_b32 v99, a11
    v_cvt_pk_bf16_f32 v40, v96, v97
    v_cvt_pk_bf16_f32 v41, v98, v99
    v_accvgpr_read_b32 v100, a24
    v_accvgpr_read_b32 v101, a25
    v_accvgpr_read_b32 v102, a26
    v_accvgpr_read_b32 v103, a27
    v_cvt_pk_bf16_f32 v42, v100, v101
    v_cvt_pk_bf16_f32 v43, v102, v103
    v_accvgpr_read_b32 v104, a40
    v_accvgpr_read_b32 v105, a41
    v_accvgpr_read_b32 v106, a42
    v_accvgpr_read_b32 v107, a43
    v_cvt_pk_bf16_f32 v60, v104, v105
    v_cvt_pk_bf16_f32 v61, v106, v107
    v_accvgpr_read_b32 v108, a56
    v_accvgpr_read_b32 v109, a57
    v_accvgpr_read_b32 v110, a58
    v_accvgpr_read_b32 v111, a59
    v_cvt_pk_bf16_f32 v62, v108, v109
    v_cvt_pk_bf16_f32 v63, v110, v111
    v_accvgpr_read_b32 v96, a72
    v_accvgpr_read_b32 v97, a73
    v_accvgpr_read_b32 v98, a74
    v_accvgpr_read_b32 v99, a75
    v_cvt_pk_bf16_f32 v74, v96, v97
    v_cvt_pk_bf16_f32 v75, v98, v99
    v_accvgpr_read_b32 v100, a88
    v_accvgpr_read_b32 v101, a89
    v_accvgpr_read_b32 v102, a90
    v_accvgpr_read_b32 v103, a91
    v_cvt_pk_bf16_f32 v84, v100, v101
    v_cvt_pk_bf16_f32 v85, v102, v103
    v_accvgpr_read_b32 v104, a12
    v_accvgpr_read_b32 v105, a13
    v_accvgpr_read_b32 v106, a14
    v_accvgpr_read_b32 v107, a15
    v_cvt_pk_bf16_f32 v44, v104, v105
    v_cvt_pk_bf16_f32 v45, v106, v107
    v_accvgpr_read_b32 v108, a28
    v_accvgpr_read_b32 v109, a29
    v_accvgpr_read_b32 v110, a30
    v_accvgpr_read_b32 v111, a31
    v_cvt_pk_bf16_f32 v46, v108, v109
    v_cvt_pk_bf16_f32 v47, v110, v111
    v_mov_b32 v76, v24
    v_mov_b32 v77, v25
    v_mov_b32 v86, v26
    v_mov_b32 v87, v27
    s_waitcnt vmcnt(5)
    v_and_b32 v14, 3, v1
    v_lshlrev_b32 v14, 7, v14
    s_waitcnt vmcnt(0)
    s_barrier
    buffer_store_dword v22, v14, s[80:83], s62 offen sc0 sc1
    v_mfma_f32_16x16x32_bf16 v[112:115], v[48:51], v[32:35], 0
    v_mfma_f32_16x16x32_bf16 v[116:119], v[52:55], v[32:35], 0
    v_mfma_f32_16x16x32_bf16 v[120:123], v[52:55], v[36:39], 0
    v_mfma_f32_16x16x32_bf16 v[124:127], v[56:59], v[36:39], 0
    v_mfma_f32_16x16x32_bf16 v[128:131], v[56:59], v[40:43], 0
    v_mfma_f32_16x16x32_bf16 v[132:135], v[60:63], v[40:43], 0
    v_mfma_f32_16x16x32_bf16 v[136:139], v[60:63], v[44:47], 0
    v_mfma_f32_16x16x32_bf16 v[140:143], v[16:19], v[44:47], 0
    v_mov_b32 v68, v64
    v_mov_b32 v69, v65
    v_mov_b32 v78, v66
    v_mov_b32 v79, v67
    s_mov_b32 s96, 0x3fb8aa3b
    v_cndmask_b32 v112, v112, v113, s[16:17]
    v_cndmask_b32 v116, v116, v117, s[16:17]
    v_cndmask_b32 v114, v114, v115, s[16:17]
    v_cndmask_b32 v118, v118, v119, s[16:17]
    v_cndmask_b32 v96, v112, v116, s[18:19]
    v_cndmask_b32 v97, v114, v118, s[20:21]
    v_cndmask_b32 v120, v120, v121, s[16:17]
    v_cndmask_b32 v124, v124, v125, s[16:17]
    v_cndmask_b32 v122, v122, v123, s[16:17]
    v_cndmask_b32 v126, v126, v127, s[16:17]
    v_cndmask_b32 v98, v120, v124, s[18:19]
    v_cndmask_b32 v99, v122, v126, s[20:21]
    v_cndmask_b32 v128, v128, v129, s[16:17]
    v_cndmask_b32 v132, v132, v133, s[16:17]
    v_cndmask_b32 v130, v130, v131, s[16:17]
    v_cndmask_b32 v134, v134, v135, s[16:17]
    v_cndmask_b32 v100, v128, v132, s[18:19]
    v_cndmask_b32 v101, v130, v134, s[20:21]
    v_cndmask_b32 v136, v136, v137, s[16:17]
    v_cndmask_b32 v140, v140, v141, s[16:17]
    v_cndmask_b32 v138, v138, v139, s[16:17]
    v_cndmask_b32 v142, v142, v143, s[16:17]
    v_cndmask_b32 v102, v136, v140, s[18:19]
    v_cndmask_b32 v103, v138, v142, s[20:21]
    v_cvt_pk_bf16_f32 v97, v96, v97
    v_cvt_pk_bf16_f32 v99, v98, v99
    v_cvt_pk_bf16_f32 v101, v100, v101
    v_cvt_pk_bf16_f32 v103, v102, v103
    v_lshlrev_b32 v96, 16, v97
    v_and_b32 v97, 0xffff0000, v97
    v_lshlrev_b32 v98, 16, v99
    v_and_b32 v99, 0xffff0000, v99
    v_lshlrev_b32 v100, 16, v101
    v_and_b32 v101, 0xffff0000, v101
    v_lshlrev_b32 v102, 16, v103
    v_and_b32 v103, 0xffff0000, v103
    v_pk_mul_f32 v[96:97], v[96:97], s[38:39]
    v_pk_mul_f32 v[98:99], v[98:99], s[38:39]
    v_pk_mul_f32 v[100:101], v[100:101], s[38:39]
    v_pk_mul_f32 v[102:103], v[102:103], s[38:39]
    v_cvt_pk_bf16_f32 v97, v96, v97
    v_cvt_pk_bf16_f32 v99, v98, v99
    v_cvt_pk_bf16_f32 v101, v100, v101
    v_cvt_pk_bf16_f32 v103, v102, v103
    v_lshlrev_b32 v96, 16, v97
    v_and_b32 v97, 0xffff0000, v97
    v_lshlrev_b32 v98, 16, v99
    v_and_b32 v99, 0xffff0000, v99
    v_lshlrev_b32 v100, 16, v101
    v_and_b32 v101, 0xffff0000, v101
    v_lshlrev_b32 v102, 16, v103
    v_and_b32 v103, 0xffff0000, v103
    v_cndmask_b32 v96, v5, v96, s[22:23]
    v_cndmask_b32 v97, v5, v97, s[24:25]
    v_max_f32 v104, v96, v97
    v_max_f32 v105, v98, v99
    v_max_f32 v106, v100, v101
    v_max_f32 v107, v102, v103
    buffer_load_dword v227, v226, s[80:83], s47 offen sc0 sc1
    v_mov_b32 v108, v104
    v_mov_b32 v109, v105
    v_mov_b32 v110, v106
    v_mov_b32 v111, v107
    v_permlane16_swap_b32 v104, v108
    v_permlane16_swap_b32 v105, v109
    v_permlane16_swap_b32 v106, v110
    v_permlane16_swap_b32 v107, v111
    v_max_f32 v104, v104, v108
    v_max_f32 v105, v105, v109
    v_max_f32 v106, v106, v110
    v_max_f32 v107, v107, v111
    v_mov_b32 v108, v104
    v_mov_b32 v109, v105
    v_mov_b32 v110, v106
    v_mov_b32 v111, v107
    v_permlane32_swap_b32 v104, v108
    v_permlane32_swap_b32 v105, v109
    v_permlane32_swap_b32 v106, v110
    v_permlane32_swap_b32 v107, v111
    v_max_f32 v104, v104, v108
    v_max_f32 v105, v105, v109
    v_max_f32 v106, v106, v110
    v_max_f32 v107, v107, v111
    v_mul_f32 v104, s96, v104
    v_mul_f32 v105, s96, v105
    v_mul_f32 v106, s96, v106
    v_mul_f32 v107, s96, v107
    v_fma_f32 v96, v96, s96, -v104
    v_fma_f32 v97, v97, s96, -v104
    v_fma_f32 v98, v98, s96, -v105
    v_fma_f32 v99, v99, s96, -v105
    v_fma_f32 v100, v100, s96, -v106
    v_fma_f32 v101, v101, s96, -v106
    v_fma_f32 v102, v102, s96, -v107
    v_fma_f32 v103, v103, s96, -v107
    v_exp_f32 v96, v96
    v_exp_f32 v97, v97
    v_exp_f32 v98, v98
    v_exp_f32 v99, v99
    v_exp_f32 v100, v100
    v_exp_f32 v101, v101
    v_exp_f32 v102, v102
    v_exp_f32 v103, v103
    v_add_f32 v104, v96, v97
    v_add_f32 v105, v98, v99
    v_add_f32 v106, v100, v101
    v_add_f32 v107, v102, v103
    v_mov_b32 v108, v104
    v_mov_b32 v109, v105
    v_mov_b32 v110, v106
    v_mov_b32 v111, v107
    v_permlane16_swap_b32 v104, v108
    v_permlane16_swap_b32 v105, v109
    v_permlane16_swap_b32 v106, v110
    v_permlane16_swap_b32 v107, v111
    v_add_f32 v104, v104, v108
    v_add_f32 v105, v105, v109
    v_add_f32 v106, v106, v110
    v_add_f32 v107, v107, v111
    v_mov_b32 v108, v104
    v_mov_b32 v109, v105
    v_mov_b32 v110, v106
    v_mov_b32 v111, v107
    v_permlane32_swap_b32 v104, v108
    v_permlane32_swap_b32 v105, v109
    v_permlane32_swap_b32 v106, v110
    v_permlane32_swap_b32 v107, v111
    v_add_f32 v104, v104, v108
    v_add_f32 v105, v105, v109
    v_add_f32 v106, v106, v110
    v_add_f32 v107, v107, v111
    v_rcp_f32 v104, v104
    v_rcp_f32 v105, v105
    v_rcp_f32 v106, v106
    v_rcp_f32 v107, v107
    v_mul_f32 v96, v96, v104
    v_mul_f32 v97, v97, v104
    v_mul_f32 v98, v98, v105
    v_mul_f32 v99, v99, v105
    v_mul_f32 v100, v100, v106
    v_mul_f32 v101, v101, v106
    v_mul_f32 v102, v102, v107
    v_mul_f32 v103, v103, v107
    v_cvt_pk_bf16_f32 v96, v96, v96
    v_cvt_pk_bf16_f32 v97, v97, v97
    v_cvt_pk_bf16_f32 v98, v98, v98
    v_cvt_pk_bf16_f32 v99, v99, v99
    v_cvt_pk_bf16_f32 v100, v100, v100
    v_cvt_pk_bf16_f32 v101, v101, v101
    v_cvt_pk_bf16_f32 v102, v102, v102
    v_cvt_pk_bf16_f32 v103, v103, v103
    v_and_b32 v32, v6, v96
    v_and_b32 v33, v8, v97
    v_and_b32 v34, v20, v96
    v_and_b32 v35, v21, v97
    v_and_b32 v36, v6, v98
    v_and_b32 v37, v8, v99
    v_and_b32 v38, v20, v98
    v_and_b32 v39, v21, v99
    v_and_b32 v40, v6, v100
    v_and_b32 v41, v8, v101
    v_and_b32 v42, v20, v100
    v_and_b32 v43, v21, v101
    v_and_b32 v44, v6, v102
    v_and_b32 v45, v8, v103
    v_and_b32 v46, v20, v102
    v_and_b32 v47, v21, v103
    s_waitcnt vmcnt(0)
    v_cmp_eq_u32 vcc, v227, v22
    s_cmp_eq_u64 vcc, exec
    s_cselect_b32 s36, 1, 0
    s_cbranch_scc0 recurrent_scan__sliding_local_dilated__swiglu_ffn__prompt_kernel_h_skip
    buffer_load_dwordx4 a[32:35], v220, s[48:51], s42 offen sc1
    buffer_load_dwordx4 a[36:39], v221, s[48:51], s42 offen sc1
    s_add_u32 s42, s42, 196608
    buffer_load_dwordx4 a[40:43], v220, s[48:51], s42 offen sc1
    buffer_load_dwordx4 a[44:47], v221, s[48:51], s42 offen sc1
    s_add_u32 s42, s42, 196608
    buffer_load_dwordx4 a[48:51], v220, s[48:51], s42 offen sc1
    buffer_load_dwordx4 a[52:55], v221, s[48:51], s42 offen sc1
    s_add_u32 s42, s42, 196608
    buffer_load_dwordx2 a[56:57], v222, s[48:51], s42 offen offset:512 sc1
    buffer_load_dwordx2 a[58:59], v222, s[48:51], s42 offen offset:1536 sc1
    buffer_load_dwordx2 a[60:61], v222, s[48:51], s42 offen offset:2560 sc1
    buffer_load_dwordx2 a[62:63], v222, s[48:51], s42 offen offset:0 sc1
    s_add_u32 s42, s42, 196608
recurrent_scan__sliding_local_dilated__swiglu_ffn__prompt_kernel_h_skip:
    v_accvgpr_read_b32 v144, a224
    v_accvgpr_read_b32 v145, a225
    v_accvgpr_read_b32 v146, a226
    v_accvgpr_read_b32 v147, a227
    v_accvgpr_read_b32 v148, a228
    v_accvgpr_read_b32 v149, a229
    v_accvgpr_read_b32 v150, a230
    v_accvgpr_read_b32 v151, a231
    v_accvgpr_read_b32 v152, a232
    v_accvgpr_read_b32 v153, a233
    v_accvgpr_read_b32 v154, a234
    v_accvgpr_read_b32 v155, a235
    v_accvgpr_read_b32 v156, a236
    v_accvgpr_read_b32 v157, a237
    v_accvgpr_read_b32 v158, a238
    v_accvgpr_read_b32 v159, a239
    s_nop 0
    v_permlane16_swap_b32 v144, v146
    v_permlane16_swap_b32 v145, v147
    v_permlane16_swap_b32 v148, v150
    v_permlane16_swap_b32 v149, v151
    v_permlane16_swap_b32 v152, v154
    v_permlane16_swap_b32 v153, v155
    v_permlane16_swap_b32 v156, v158
    v_permlane16_swap_b32 v157, v159
    v_lshlrev_b32 v160, 16, v144
    v_and_b32 v161, 0xffff0000, v144
    v_lshlrev_b32 v162, 16, v145
    v_and_b32 v163, 0xffff0000, v145
    v_lshlrev_b32 v168, 16, v146
    v_and_b32 v169, 0xffff0000, v146
    v_lshlrev_b32 v170, 16, v147
    v_and_b32 v171, 0xffff0000, v147
    v_lshlrev_b32 v232, 16, v148
    v_and_b32 v233, 0xffff0000, v148
    v_lshlrev_b32 v234, 16, v149
    v_and_b32 v235, 0xffff0000, v149
    v_lshlrev_b32 v240, 16, v150
    v_and_b32 v241, 0xffff0000, v150
    v_lshlrev_b32 v242, 16, v151
    v_and_b32 v243, 0xffff0000, v151
    v_lshlrev_b32 v164, 16, v152
    v_and_b32 v165, 0xffff0000, v152
    v_lshlrev_b32 v166, 16, v153
    v_and_b32 v167, 0xffff0000, v153
    v_lshlrev_b32 v172, 16, v154
    v_and_b32 v173, 0xffff0000, v154
    v_lshlrev_b32 v174, 16, v155
    v_and_b32 v175, 0xffff0000, v155
    v_lshlrev_b32 v236, 16, v156
    v_and_b32 v237, 0xffff0000, v156
    v_lshlrev_b32 v238, 16, v157
    v_and_b32 v239, 0xffff0000, v157
    v_lshlrev_b32 v244, 16, v158
    v_and_b32 v245, 0xffff0000, v158
    v_lshlrev_b32 v246, 16, v159
    v_and_b32 v247, 0xffff0000, v159
    v_lshrrev_b32 v92, 5, v1
    v_lshlrev_b32 v208, 10, v92
    v_bfe_u32 v92, v1, 2, 3
    v_lshl_add_u32 v208, v92, 7, v208
    v_lshrrev_b32 v92, 1, v92
    v_lshl_add_u32 v208, v92, 5, v208
    v_and_b32 v92, 3, v1
    v_lshl_add_u32 v208, v92, 3, v208
    v_xor_b32 v209, 32, v208
    v_xor_b32 v210, 64, v208
    v_xor_b32 v211, 96, v208
    v_add_u32 v212, 0x10000, v208
    v_add_u32 v213, 0x10000, v209
    v_add_u32 v214, 0x10000, v210
    v_add_u32 v215, 0x10000, v211
    v_add_u32 v216, 0x10000, v212
    v_add_u32 v217, 0x10000, v213
    v_add_u32 v218, 0x10000, v214
    v_add_u32 v219, 0x10000, v215
    v_mfma_f32_16x16x32_bf16 v[112:115], v[68:71], v[32:35], 0
    v_mfma_f32_16x16x32_bf16 v[116:119], v[78:81], v[32:35], 0
    v_mfma_f32_16x16x32_bf16 v[120:123], v[70:73], v[36:39], 0
    v_mfma_f32_16x16x32_bf16 v[124:127], v[80:83], v[36:39], 0
    v_mfma_f32_16x16x32_bf16 v[128:131], v[72:75], v[40:43], 0
    v_mfma_f32_16x16x32_bf16 v[132:135], v[82:85], v[40:43], 0
    v_mfma_f32_16x16x32_bf16 v[136:139], v[74:77], v[44:47], 0
    v_mfma_f32_16x16x32_bf16 v[140:143], v[84:87], v[44:47], 0
    s_add_u32 s75, s5, 112
    s_mul_i32 s75, s75, 196608
    s_nop 1
    v_cvt_pk_bf16_f32 v48, v112, v113
    v_cvt_pk_bf16_f32 v49, v114, v115
    v_cvt_pk_bf16_f32 v50, v116, v117
    v_cvt_pk_bf16_f32 v51, v118, v119
    v_cvt_pk_bf16_f32 v52, v120, v121
    v_cvt_pk_bf16_f32 v53, v122, v123
    v_cvt_pk_bf16_f32 v54, v124, v125
    v_cvt_pk_bf16_f32 v55, v126, v127
    v_cvt_pk_bf16_f32 v56, v128, v129
    v_cvt_pk_bf16_f32 v57, v130, v131
    v_cvt_pk_bf16_f32 v58, v132, v133
    v_cvt_pk_bf16_f32 v59, v134, v135
    v_cvt_pk_bf16_f32 v60, v136, v137
    v_cvt_pk_bf16_f32 v61, v138, v139
    v_cvt_pk_bf16_f32 v62, v140, v141
    v_cvt_pk_bf16_f32 v63, v142, v143
    s_cmp_eq_u32 s36, 0
    s_cbranch_scc1 recurrent_scan__sliding_local_dilated__swiglu_ffn__prompt_kernel_h_spin
recurrent_scan__sliding_local_dilated__swiglu_ffn__prompt_kernel_h_ret:
    buffer_store_dwordx4 v[48:51], v7, s[48:51], s75 offen offset:0 sc0 sc1
    buffer_store_dwordx4 v[52:55], v30, s[48:51], s75 offen offset:0 sc0 sc1
    buffer_store_dwordx4 v[56:59], v7, s[48:51], s75 offen offset:3072 sc0 sc1
    buffer_store_dwordx4 v[60:63], v30, s[48:51], s75 offen offset:3072 sc0 sc1
    s_waitcnt vmcnt(59)
    s_barrier
    ds_read_b64_tr_b16 a[0:1], v208 offset:0
    ds_read_b64_tr_b16 a[2:3], v208 offset:4096
    ds_read_b64_tr_b16 a[4:5], v208 offset:8192
    ds_read_b64_tr_b16 a[6:7], v208 offset:12288
    ds_read_b64_tr_b16 a[8:9], v209 offset:0
    ds_read_b64_tr_b16 a[10:11], v209 offset:4096
    ds_read_b64_tr_b16 a[12:13], v209 offset:8192
    ds_read_b64_tr_b16 a[14:15], v209 offset:12288
    ds_read_b64_tr_b16 a[16:17], v210 offset:0
    ds_read_b64_tr_b16 a[18:19], v210 offset:4096
    ds_read_b64_tr_b16 a[20:21], v210 offset:8192
    ds_read_b64_tr_b16 a[22:23], v210 offset:12288
    v_and_b32 v24, 31, v1
    v_and_b32 v26, 16, v24
    v_lshlrev_b32 v26, 7, v26
    v_lshlrev_b32 v25, 7, v24
    v_lshlrev_b32 v24, 2, v24
    v_lshlrev_b32 v20, 2, v1
    s_waitcnt vmcnt(10) lgkmcnt(4)
    v_mfma_f32_16x16x32_bf16 v[32:35], a[0:3], a[32:35], 0
    ds_read_b64_tr_b16 a[24:25], v211 offset:0
    ds_read_b64_tr_b16 a[26:27], v211 offset:4096
    v_mfma_f32_16x16x32_bf16 v[32:35], a[4:7], a[40:43], v[32:35]
    ds_read_b64_tr_b16 a[28:29], v211 offset:8192
    v_mfma_f32_16x16x32_bf16 v[36:39], a[4:7], a[44:47], 0
    s_nop 0
    buffer_load_dwordx4 a[64:67], v220, s[48:51], s42 offen sc1
    v_mfma_f32_16x16x32_bf16 v[36:39], a[0:3], a[36:39], v[36:39]
    ds_read_b64_tr_b16 a[30:31], v211 offset:12288
    buffer_load_dwordx4 a[68:71], v221, s[48:51], s42 offen sc1
    v_mfma_f32_16x16x32_bf16 v[44:47], a[8:11], a[36:39], 0
    ds_read_b64_tr_b16 a[0:1], v208 offset:2048
    ds_read_b64_tr_b16 a[2:3], v208 offset:6144
    v_mfma_f32_16x16x32_bf16 v[44:47], a[12:15], a[44:47], v[44:47]
    ds_read_b64_tr_b16 a[4:5], v208 offset:10240
    s_add_u32 s42, s42, 196608
    v_mfma_f32_16x16x32_bf16 v[40:43], a[12:15], a[40:43], 0
    buffer_load_dwordx4 a[72:75], v220, s[48:51], s42 offen sc1
    v_mfma_f32_16x16x32_bf16 v[40:43], a[8:11], a[32:35], v[40:43]
    ds_read_b64_tr_b16 a[6:7], v208 offset:14336
    buffer_load_dwordx4 a[76:79], v221, s[48:51], s42 offen sc1
    s_waitcnt lgkmcnt(4)
    v_mfma_f32_16x16x32_bf16 v[48:51], a[16:19], a[32:35], 0
    ds_read_b64_tr_b16 a[8:9], v209 offset:2048
    ds_read_b64_tr_b16 a[10:11], v209 offset:6144
    v_mfma_f32_16x16x32_bf16 v[48:51], a[20:23], a[40:43], v[48:51]
    ds_read_b64_tr_b16 a[12:13], v209 offset:10240
    s_add_u32 s42, s42, 196608
    v_mfma_f32_16x16x32_bf16 v[52:55], a[20:23], a[44:47], 0
    buffer_load_dwordx4 a[80:83], v220, s[48:51], s42 offen sc1
    v_mfma_f32_16x16x32_bf16 v[52:55], a[16:19], a[36:39], v[52:55]
    ds_read_b64_tr_b16 a[14:15], v209 offset:14336
    buffer_load_dwordx4 a[84:87], v221, s[48:51], s42 offen sc1
    v_mfma_f32_16x16x32_bf16 v[60:63], a[24:27], a[36:39], 0
    ds_read_b64_tr_b16 a[16:17], v210 offset:2048
    ds_read_b64_tr_b16 a[18:19], v210 offset:6144
    v_mfma_f32_16x16x32_bf16 v[60:63], a[28:31], a[44:47], v[60:63]
    ds_read_b64_tr_b16 a[20:21], v210 offset:10240
    s_add_u32 s42, s42, 196608
    v_mfma_f32_16x16x32_bf16 v[56:59], a[28:31], a[40:43], 0
    v_mfma_f32_16x16x32_bf16 v[56:59], a[24:27], a[32:35], v[56:59]
    ds_read_b64_tr_b16 a[22:23], v210 offset:14336
    s_waitcnt lgkmcnt(4)
    v_mfma_f32_16x16x32_bf16 v[64:67], a[0:3], a[32:35], 0
    ds_read_b64_tr_b16 a[24:25], v211 offset:2048
    ds_read_b64_tr_b16 a[26:27], v211 offset:6144
    v_mfma_f32_16x16x32_bf16 v[64:67], a[4:7], a[40:43], v[64:67]
    ds_read_b64_tr_b16 a[28:29], v211 offset:10240
    v_mfma_f32_16x16x32_bf16 v[68:71], a[4:7], a[44:47], 0
    buffer_load_dwordx4 a[88:91], v220, s[48:51], s42 offen sc1
    v_mfma_f32_16x16x32_bf16 v[68:71], a[0:3], a[36:39], v[68:71]
    ds_read_b64_tr_b16 a[30:31], v211 offset:14336
    v_mfma_f32_16x16x32_bf16 v[76:79], a[8:11], a[36:39], 0
    ds_read_b64_tr_b16 a[0:1], v208 offset:16384
    ds_read_b64_tr_b16 a[2:3], v208 offset:20480
    v_mfma_f32_16x16x32_bf16 v[76:79], a[12:15], a[44:47], v[76:79]
    ds_read_b64_tr_b16 a[4:5], v208 offset:24576
    v_mfma_f32_16x16x32_bf16 v[72:75], a[12:15], a[40:43], 0
    v_mfma_f32_16x16x32_bf16 v[72:75], a[8:11], a[32:35], v[72:75]
    ds_read_b64_tr_b16 a[6:7], v208 offset:28672
    s_waitcnt lgkmcnt(4)
    v_mfma_f32_16x16x32_bf16 v[80:83], a[16:19], a[32:35], 0
    ds_read_b64_tr_b16 a[8:9], v209 offset:16384
    ds_read_b64_tr_b16 a[10:11], v209 offset:20480
    v_mfma_f32_16x16x32_bf16 v[80:83], a[20:23], a[40:43], v[80:83]
    ds_read_b64_tr_b16 a[12:13], v209 offset:24576
    s_add_u32 m0, s46, 114688
    v_mfma_f32_16x16x32_bf16 v[84:87], a[20:23], a[44:47], 0
    buffer_load_dwordx4 v2, s[84:87], s92 offen offset:0 sc1 lds
    v_mfma_f32_16x16x32_bf16 v[84:87], a[16:19], a[36:39], v[84:87]
    ds_read_b64_tr_b16 a[14:15], v209 offset:28672
    buffer_load_dwordx4 a[92:95], v221, s[48:51], s42 offen sc1
    v_mfma_f32_16x16x32_bf16 v[92:95], a[24:27], a[36:39], 0
    ds_read_b64_tr_b16 a[16:17], v210 offset:16384
recurrent_scan__sliding_local_dilated__swiglu_ffn__prompt_kernel_w6:
    s_cbranch_execz recurrent_scan__sliding_local_dilated__swiglu_ffn__prompt_kernel_w10
    ds_read_b64_tr_b16 a[18:19], v210 offset:20480
    v_mfma_f32_16x16x32_bf16 v[92:95], a[28:31], a[44:47], v[92:95]
    ds_read_b64_tr_b16 a[20:21], v210 offset:24576
    s_add_u32 s42, s42, 196608
    v_mfma_f32_16x16x32_bf16 v[88:91], a[28:31], a[40:43], 0
    v_mfma_f32_16x16x32_bf16 v[88:91], a[24:27], a[32:35], v[88:91]
    ds_read_b64_tr_b16 a[22:23], v210 offset:28672
    s_waitcnt vmcnt(13) lgkmcnt(4)
    v_mfma_f32_16x16x32_bf16 v[32:35], a[0:3], a[48:51], v[32:35]
    ds_read_b64_tr_b16 a[24:25], v211 offset:16384
    ds_read_b64_tr_b16 a[26:27], v211 offset:20480
    v_mfma_f32_16x16x32_bf16 v[32:35], a[4:7], a[56:59], v[32:35]
    ds_read_b64_tr_b16 a[28:29], v211 offset:24576
    v_mfma_f32_16x16x32_bf16 v[36:39], a[4:7], a[60:63], v[36:39]
    buffer_load_dwordx4 v3, s[84:87], s92 offen offset:1024 sc1 lds
    v_mfma_f32_16x16x32_bf16 v[36:39], a[0:3], a[52:55], v[36:39]
    ds_read_b64_tr_b16 a[30:31], v211 offset:28672
    v_mfma_f32_16x16x32_bf16 v[44:47], a[8:11], a[52:55], v[44:47]
    ds_read_b64_tr_b16 a[0:1], v208 offset:18432
    ds_read_b64_tr_b16 a[2:3], v208 offset:22528
    v_mfma_f32_16x16x32_bf16 v[44:47], a[12:15], a[60:63], v[44:47]
    ds_read_b64_tr_b16 a[4:5], v208 offset:26624
    s_add_u32 s92, s92, s95
    v_mfma_f32_16x16x32_bf16 v[40:43], a[12:15], a[56:59], v[40:43]
    buffer_load_dwordx4 a[32:35], v220, s[48:51], s42 offen sc1
    v_mfma_f32_16x16x32_bf16 v[40:43], a[8:11], a[48:51], v[40:43]
    ds_read_b64_tr_b16 a[6:7], v208 offset:30720
    s_waitcnt lgkmcnt(4)
    v_mfma_f32_16x16x32_bf16 v[48:51], a[16:19], a[48:51], v[48:51]
    ds_read_b64_tr_b16 a[8:9], v209 offset:18432
    ds_read_b64_tr_b16 a[10:11], v209 offset:22528
    v_mfma_f32_16x16x32_bf16 v[48:51], a[20:23], a[56:59], v[48:51]
    ds_read_b64_tr_b16 a[12:13], v209 offset:26624
    v_mfma_f32_16x16x32_bf16 v[52:55], a[20:23], a[60:63], v[52:55]
    buffer_load_dwordx4 v15, s[88:91], s94 offen offset:2048 sc1 lds
    v_mfma_f32_16x16x32_bf16 v[52:55], a[16:19], a[52:55], v[52:55]
    ds_read_b64_tr_b16 a[14:15], v209 offset:30720
    v_mfma_f32_16x16x32_bf16 v[60:63], a[24:27], a[52:55], v[60:63]
    ds_read_b64_tr_b16 a[16:17], v210 offset:18432
    ds_read_b64_tr_b16 a[18:19], v210 offset:22528
    v_mfma_f32_16x16x32_bf16 v[60:63], a[28:31], a[60:63], v[60:63]
    ds_read_b64_tr_b16 a[20:21], v210 offset:26624
    v_mfma_f32_16x16x32_bf16 v[56:59], a[28:31], a[56:59], v[56:59]
    buffer_load_dwordx4 a[36:39], v221, s[48:51], s42 offen sc1
    v_mfma_f32_16x16x32_bf16 v[56:59], a[24:27], a[48:51], v[56:59]
    ds_read_b64_tr_b16 a[22:23], v210 offset:30720
    s_waitcnt lgkmcnt(4)
    v_mfma_f32_16x16x32_bf16 v[64:67], a[0:3], a[48:51], v[64:67]
    ds_read_b64_tr_b16 a[24:25], v211 offset:18432
    ds_read_b64_tr_b16 a[26:27], v211 offset:22528
    v_mfma_f32_16x16x32_bf16 v[64:67], a[4:7], a[56:59], v[64:67]
    ds_read_b64_tr_b16 a[28:29], v211 offset:26624
    s_add_u32 s42, s42, 196608
    v_mfma_f32_16x16x32_bf16 v[68:71], a[4:7], a[60:63], v[68:71]
    buffer_load_dwordx4 a[40:43], v220, s[48:51], s42 offen sc1
    v_mfma_f32_16x16x32_bf16 v[68:71], a[0:3], a[52:55], v[68:71]
    ds_read_b64_tr_b16 a[30:31], v211 offset:30720
    v_mfma_f32_16x16x32_bf16 v[76:79], a[8:11], a[52:55], v[76:79]
    s_waitcnt vmcnt(63)
    s_barrier
    ds_read_b64_tr_b16 a[0:1], v208 offset:32768
    ds_read_b64_tr_b16 a[2:3], v208 offset:36864
    v_mfma_f32_16x16x32_bf16 v[76:79], a[12:15], a[60:63], v[76:79]
    ds_read_b64_tr_b16 a[4:5], v208 offset:40960
    v_mfma_f32_16x16x32_bf16 v[72:75], a[12:15], a[56:59], v[72:75]
    buffer_load_dwordx4 v28, s[88:91], s94 offen offset:3072 sc1 lds
    v_mfma_f32_16x16x32_bf16 v[72:75], a[8:11], a[48:51], v[72:75]
    ds_read_b64_tr_b16 a[6:7], v208 offset:45056
    s_waitcnt lgkmcnt(4)
    v_mfma_f32_16x16x32_bf16 v[80:83], a[16:19], a[48:51], v[80:83]
    ds_read_b64_tr_b16 a[8:9], v209 offset:32768
    ds_read_b64_tr_b16 a[10:11], v209 offset:36864
    v_mfma_f32_16x16x32_bf16 v[80:83], a[20:23], a[56:59], v[80:83]
    ds_read_b64_tr_b16 a[12:13], v209 offset:40960
    s_add_u32 s94, s94, s97
    v_mfma_f32_16x16x32_bf16 v[84:87], a[20:23], a[60:63], v[84:87]
    buffer_load_dwordx4 a[44:47], v221, s[48:51], s42 offen sc1
    v_mfma_f32_16x16x32_bf16 v[84:87], a[16:19], a[52:55], v[84:87]
    ds_read_b64_tr_b16 a[14:15], v209 offset:45056
    v_mfma_f32_16x16x32_bf16 v[92:95], a[24:27], a[52:55], v[92:95]
    ds_read_b64_tr_b16 a[16:17], v210 offset:32768
    ds_read_b64_tr_b16 a[18:19], v210 offset:36864
    v_mfma_f32_16x16x32_bf16 v[92:95], a[28:31], a[60:63], v[92:95]
    ds_read_b64_tr_b16 a[20:21], v210 offset:40960
    s_add_u32 s42, s42, 196608
    s_add_u32 m0, s46, 131072
    v_mfma_f32_16x16x32_bf16 v[88:91], a[28:31], a[56:59], v[88:91]
    buffer_load_dwordx4 v2, s[84:87], s92 offen offset:0 sc1 lds
    v_mfma_f32_16x16x32_bf16 v[88:91], a[24:27], a[48:51], v[88:91]
    ds_read_b64_tr_b16 a[22:23], v210 offset:45056
    s_waitcnt vmcnt(13) lgkmcnt(4)
    v_mfma_f32_16x16x32_bf16 v[32:35], a[0:3], a[64:67], v[32:35]
    ds_read_b64_tr_b16 a[24:25], v211 offset:32768
    ds_read_b64_tr_b16 a[26:27], v211 offset:36864
    v_mfma_f32_16x16x32_bf16 v[32:35], a[4:7], a[72:75], v[32:35]
    ds_read_b64_tr_b16 a[28:29], v211 offset:40960
    v_mfma_f32_16x16x32_bf16 v[36:39], a[4:7], a[76:79], v[36:39]
    buffer_load_dwordx2 a[48:49], v222, s[48:51], s42 offen offset:512 sc1
    v_mfma_f32_16x16x32_bf16 v[36:39], a[0:3], a[68:71], v[36:39]
    ds_read_b64_tr_b16 a[30:31], v211 offset:45056
    buffer_load_dwordx2 a[50:51], v222, s[48:51], s42 offen offset:1536 sc1
    v_mfma_f32_16x16x32_bf16 v[44:47], a[8:11], a[68:71], v[44:47]
    ds_read_b64_tr_b16 a[0:1], v208 offset:34816
    ds_read_b64_tr_b16 a[2:3], v208 offset:38912
    v_mfma_f32_16x16x32_bf16 v[44:47], a[12:15], a[76:79], v[44:47]
    ds_read_b64_tr_b16 a[4:5], v208 offset:43008
    v_mfma_f32_16x16x32_bf16 v[40:43], a[12:15], a[72:75], v[40:43]
    buffer_load_dwordx4 v3, s[84:87], s92 offen offset:1024 sc1 lds
    v_mfma_f32_16x16x32_bf16 v[40:43], a[8:11], a[64:67], v[40:43]
    ds_read_b64_tr_b16 a[6:7], v208 offset:47104
    s_waitcnt lgkmcnt(4)
    v_mfma_f32_16x16x32_bf16 v[48:51], a[16:19], a[64:67], v[48:51]
    ds_read_b64_tr_b16 a[8:9], v209 offset:34816
    ds_read_b64_tr_b16 a[10:11], v209 offset:38912
    v_mfma_f32_16x16x32_bf16 v[48:51], a[20:23], a[72:75], v[48:51]
    ds_read_b64_tr_b16 a[12:13], v209 offset:43008
    s_add_u32 s92, s92, s95
    v_mfma_f32_16x16x32_bf16 v[52:55], a[20:23], a[76:79], v[52:55]
    buffer_load_dwordx2 a[52:53], v222, s[48:51], s42 offen offset:2560 sc1
    v_mfma_f32_16x16x32_bf16 v[52:55], a[16:19], a[68:71], v[52:55]
    ds_read_b64_tr_b16 a[14:15], v209 offset:47104
    buffer_load_dwordx2 a[54:55], v222, s[48:51], s42 offen offset:0 sc1
    v_mfma_f32_16x16x32_bf16 v[60:63], a[24:27], a[68:71], v[60:63]
    ds_read_b64_tr_b16 a[16:17], v210 offset:34816
    ds_read_b64_tr_b16 a[18:19], v210 offset:38912
    v_mfma_f32_16x16x32_bf16 v[60:63], a[28:31], a[76:79], v[60:63]
    ds_read_b64_tr_b16 a[20:21], v210 offset:43008
    s_add_u32 s42, s42, 196608
    v_mfma_f32_16x16x32_bf16 v[56:59], a[28:31], a[72:75], v[56:59]
    buffer_load_dwordx4 v15, s[88:91], s94 offen offset:2048 sc1 lds
    v_mfma_f32_16x16x32_bf16 v[56:59], a[24:27], a[64:67], v[56:59]
    ds_read_b64_tr_b16 a[22:23], v210 offset:47104
    s_waitcnt lgkmcnt(4)
    v_mfma_f32_16x16x32_bf16 v[64:67], a[0:3], a[64:67], v[64:67]
    ds_read_b64_tr_b16 a[24:25], v211 offset:34816
    ds_read_b64_tr_b16 a[26:27], v211 offset:38912
    v_mfma_f32_16x16x32_bf16 v[64:67], a[4:7], a[72:75], v[64:67]
    ds_read_b64_tr_b16 a[28:29], v211 offset:43008
    v_mfma_f32_16x16x32_bf16 v[68:71], a[4:7], a[76:79], v[68:71]
    buffer_load_dwordx4 a[56:59], v220, s[48:51], s42 offen sc1
    v_mfma_f32_16x16x32_bf16 v[68:71], a[0:3], a[68:71], v[68:71]
    ds_read_b64_tr_b16 a[30:31], v211 offset:47104
    v_mfma_f32_16x16x32_bf16 v[76:79], a[8:11], a[68:71], v[76:79]
    ds_read_b64_tr_b16 a[0:1], v208 offset:49152
    ds_read_b64_tr_b16 a[2:3], v208 offset:53248
    v_mfma_f32_16x16x32_bf16 v[76:79], a[12:15], a[76:79], v[76:79]
    ds_read_b64_tr_b16 a[4:5], v208 offset:57344
    v_mfma_f32_16x16x32_bf16 v[72:75], a[12:15], a[72:75], v[72:75]
    buffer_load_dwordx4 v28, s[88:91], s94 offen offset:3072 sc1 lds
    v_mfma_f32_16x16x32_bf16 v[72:75], a[8:11], a[64:67], v[72:75]
    ds_read_b64_tr_b16 a[6:7], v208 offset:61440
    s_waitcnt lgkmcnt(4)
    v_mfma_f32_16x16x32_bf16 v[80:83], a[16:19], a[64:67], v[80:83]
    ds_read_b64_tr_b16 a[8:9], v209 offset:49152
    ds_read_b64_tr_b16 a[10:11], v209 offset:53248
    v_mfma_f32_16x16x32_bf16 v[80:83], a[20:23], a[72:75], v[80:83]
    ds_read_b64_tr_b16 a[12:13], v209 offset:57344
    s_add_u32 s94, s94, s97
    v_mfma_f32_16x16x32_bf16 v[84:87], a[20:23], a[76:79], v[84:87]
    buffer_load_dwordx4 a[60:63], v221, s[48:51], s42 offen sc1
    v_mfma_f32_16x16x32_bf16 v[84:87], a[16:19], a[68:71], v[84:87]
    ds_read_b64_tr_b16 a[14:15], v209 offset:61440
    v_mfma_f32_16x16x32_bf16 v[92:95], a[24:27], a[68:71], v[92:95]
    ds_read_b64_tr_b16 a[16:17], v210 offset:49152
    ds_read_b64_tr_b16 a[18:19], v210 offset:53248
    v_mfma_f32_16x16x32_bf16 v[92:95], a[28:31], a[76:79], v[92:95]
    ds_read_b64_tr_b16 a[20:21], v210 offset:57344
    s_add_u32 s42, s42, 196608
    s_add_u32 m0, s46, 147456
    v_mfma_f32_16x16x32_bf16 v[88:91], a[28:31], a[72:75], v[88:91]
    buffer_load_dwordx4 v2, s[84:87], s92 offen offset:0 sc1 lds
    v_mfma_f32_16x16x32_bf16 v[88:91], a[24:27], a[64:67], v[88:91]
    ds_read_b64_tr_b16 a[22:23], v210 offset:61440
    s_waitcnt vmcnt(18) lgkmcnt(4)
    v_mfma_f32_16x16x32_bf16 v[32:35], a[0:3], a[80:83], v[32:35]
    ds_read_b64_tr_b16 a[24:25], v211 offset:49152
    ds_read_b64_tr_b16 a[26:27], v211 offset:53248
    v_mfma_f32_16x16x32_bf16 v[32:35], a[4:7], a[88:91], v[32:35]
    ds_read_b64_tr_b16 a[28:29], v211 offset:57344
    v_mfma_f32_16x16x32_bf16 v[36:39], a[4:7], a[92:95], v[36:39]
    buffer_load_dwordx4 a[64:67], v220, s[48:51], s42 offen sc1
    v_mfma_f32_16x16x32_bf16 v[36:39], a[0:3], a[84:87], v[36:39]
    ds_read_b64_tr_b16 a[30:31], v211 offset:61440
    v_mfma_f32_16x16x32_bf16 v[44:47], a[8:11], a[84:87], v[44:47]
    ds_read_b64_tr_b16 a[0:1], v208 offset:51200
    ds_read_b64_tr_b16 a[2:3], v208 offset:55296
    v_mfma_f32_16x16x32_bf16 v[44:47], a[12:15], a[92:95], v[44:47]
    ds_read_b64_tr_b16 a[4:5], v208 offset:59392
    v_mfma_f32_16x16x32_bf16 v[40:43], a[12:15], a[88:91], v[40:43]
    buffer_load_dwordx4 v3, s[84:87], s92 offen offset:1024 sc1 lds
    v_mfma_f32_16x16x32_bf16 v[40:43], a[8:11], a[80:83], v[40:43]
    ds_read_b64_tr_b16 a[6:7], v208 offset:63488
    s_waitcnt lgkmcnt(4)
    v_mfma_f32_16x16x32_bf16 v[48:51], a[16:19], a[80:83], v[48:51]
    ds_read_b64_tr_b16 a[8:9], v209 offset:51200
    ds_read_b64_tr_b16 a[10:11], v209 offset:55296
    v_mfma_f32_16x16x32_bf16 v[48:51], a[20:23], a[88:91], v[48:51]
    ds_read_b64_tr_b16 a[12:13], v209 offset:59392
    s_add_u32 s92, s92, s95
    v_mfma_f32_16x16x32_bf16 v[52:55], a[20:23], a[92:95], v[52:55]
    buffer_load_dwordx4 a[68:71], v221, s[48:51], s42 offen sc1
    v_mfma_f32_16x16x32_bf16 v[52:55], a[16:19], a[84:87], v[52:55]
    ds_read_b64_tr_b16 a[14:15], v209 offset:63488
    v_mfma_f32_16x16x32_bf16 v[60:63], a[24:27], a[84:87], v[60:63]
    ds_read_b64_tr_b16 a[16:17], v210 offset:51200
    ds_read_b64_tr_b16 a[18:19], v210 offset:55296
    v_mfma_f32_16x16x32_bf16 v[60:63], a[28:31], a[92:95], v[60:63]
    ds_read_b64_tr_b16 a[20:21], v210 offset:59392
    s_add_u32 s42, s42, 196608
    v_mfma_f32_16x16x32_bf16 v[56:59], a[28:31], a[88:91], v[56:59]
    buffer_load_dwordx4 v15, s[88:91], s94 offen offset:2048 sc1 lds
    v_mfma_f32_16x16x32_bf16 v[56:59], a[24:27], a[80:83], v[56:59]
    ds_read_b64_tr_b16 a[22:23], v210 offset:63488
    s_waitcnt lgkmcnt(4)
    v_mfma_f32_16x16x32_bf16 v[64:67], a[0:3], a[80:83], v[64:67]
    ds_read_b64_tr_b16 a[24:25], v211 offset:51200
    ds_read_b64_tr_b16 a[26:27], v211 offset:55296
    v_mfma_f32_16x16x32_bf16 v[64:67], a[4:7], a[88:91], v[64:67]
    ds_read_b64_tr_b16 a[28:29], v211 offset:59392
    v_mfma_f32_16x16x32_bf16 v[68:71], a[4:7], a[92:95], v[68:71]
    buffer_load_dwordx4 a[72:75], v220, s[48:51], s42 offen sc1
    v_mfma_f32_16x16x32_bf16 v[68:71], a[0:3], a[84:87], v[68:71]
    ds_read_b64_tr_b16 a[30:31], v211 offset:63488
    v_mfma_f32_16x16x32_bf16 v[76:79], a[8:11], a[84:87], v[76:79]
    s_waitcnt vmcnt(32)
    s_barrier
    ds_read_b64_tr_b16 a[0:1], v212 offset:0
    ds_read_b64_tr_b16 a[2:3], v212 offset:4096
    v_mfma_f32_16x16x32_bf16 v[76:79], a[12:15], a[92:95], v[76:79]
    buffer_store_dword v22, v26, s[80:83], s63 offen sc0 sc1
    ds_read_b64_tr_b16 a[4:5], v212 offset:8192
    v_mfma_f32_16x16x32_bf16 v[72:75], a[12:15], a[88:91], v[72:75]
    buffer_load_dwordx4 v28, s[88:91], s94 offen offset:3072 sc1 lds
    v_mfma_f32_16x16x32_bf16 v[72:75], a[8:11], a[80:83], v[72:75]
    ds_read_b64_tr_b16 a[6:7], v212 offset:12288
    s_waitcnt lgkmcnt(4)
    v_mfma_f32_16x16x32_bf16 v[80:83], a[16:19], a[80:83], v[80:83]
    ds_read_b64_tr_b16 a[8:9], v213 offset:0
    ds_read_b64_tr_b16 a[10:11], v213 offset:4096
    v_mfma_f32_16x16x32_bf16 v[80:83], a[20:23], a[88:91], v[80:83]
    ds_read_b64_tr_b16 a[12:13], v213 offset:8192
    s_add_u32 s94, s94, s97
    v_mfma_f32_16x16x32_bf16 v[84:87], a[20:23], a[92:95], v[84:87]
    buffer_load_dwordx4 a[76:79], v221, s[48:51], s42 offen sc1
    v_mfma_f32_16x16x32_bf16 v[84:87], a[16:19], a[84:87], v[84:87]
    ds_read_b64_tr_b16 a[14:15], v213 offset:12288
    v_mfma_f32_16x16x32_bf16 v[92:95], a[24:27], a[84:87], v[92:95]
    ds_read_b64_tr_b16 a[16:17], v214 offset:0
    ds_read_b64_tr_b16 a[18:19], v214 offset:4096
    v_mfma_f32_16x16x32_bf16 v[92:95], a[28:31], a[92:95], v[92:95]
    ds_read_b64_tr_b16 a[20:21], v214 offset:8192
    s_add_u32 s42, s42, 196608
    v_mfma_f32_16x16x32_bf16 v[88:91], a[28:31], a[88:91], v[88:91]
    v_mfma_f32_16x16x32_bf16 v[88:91], a[24:27], a[80:83], v[88:91]
    ds_read_b64_tr_b16 a[22:23], v214 offset:12288
    s_waitcnt vmcnt(19) lgkmcnt(4)
    v_mfma_f32_16x16x32_bf16 v[32:35], a[0:3], a[32:35], v[32:35]
    ds_read_b64_tr_b16 a[24:25], v215 offset:0
    ds_read_b64_tr_b16 a[26:27], v215 offset:4096
    v_mfma_f32_16x16x32_bf16 v[32:35], a[4:7], a[40:43], v[32:35]
    ds_read_b64_tr_b16 a[28:29], v215 offset:8192
    s_add_u32 m0, s46, 0
    v_mfma_f32_16x16x32_bf16 v[36:39], a[4:7], a[44:47], v[36:39]
    buffer_load_dwordx4 v2, s[84:87], s92 offen offset:0 sc1 lds
    v_mfma_f32_16x16x32_bf16 v[36:39], a[0:3], a[36:39], v[36:39]
    ds_read_b64_tr_b16 a[30:31], v215 offset:12288
    v_mfma_f32_16x16x32_bf16 v[44:47], a[8:11], a[36:39], v[44:47]
    ds_read_b64_tr_b16 a[0:1], v212 offset:2048
    ds_read_b64_tr_b16 a[2:3], v212 offset:6144
    v_mfma_f32_16x16x32_bf16 v[44:47], a[12:15], a[44:47], v[44:47]
    ds_read_b64_tr_b16 a[4:5], v212 offset:10240
    v_mfma_f32_16x16x32_bf16 v[40:43], a[12:15], a[40:43], v[40:43]
    buffer_load_dwordx4 a[80:83], v220, s[48:51], s42 offen sc1
    v_mfma_f32_16x16x32_bf16 v[40:43], a[8:11], a[32:35], v[40:43]
    ds_read_b64_tr_b16 a[6:7], v212 offset:14336
    s_waitcnt lgkmcnt(4)
    v_mfma_f32_16x16x32_bf16 v[48:51], a[16:19], a[32:35], v[48:51]
    ds_read_b64_tr_b16 a[8:9], v213 offset:2048
    ds_read_b64_tr_b16 a[10:11], v213 offset:6144
    v_mfma_f32_16x16x32_bf16 v[48:51], a[20:23], a[40:43], v[48:51]
    ds_read_b64_tr_b16 a[12:13], v213 offset:10240
    v_mfma_f32_16x16x32_bf16 v[52:55], a[20:23], a[44:47], v[52:55]
    buffer_load_dwordx4 v3, s[84:87], s92 offen offset:1024 sc1 lds
    v_mfma_f32_16x16x32_bf16 v[52:55], a[16:19], a[36:39], v[52:55]
    ds_read_b64_tr_b16 a[14:15], v213 offset:14336
    v_mfma_f32_16x16x32_bf16 v[60:63], a[24:27], a[36:39], v[60:63]
    ds_read_b64_tr_b16 a[16:17], v214 offset:2048
    ds_read_b64_tr_b16 a[18:19], v214 offset:6144
    v_mfma_f32_16x16x32_bf16 v[60:63], a[28:31], a[44:47], v[60:63]
    ds_read_b64_tr_b16 a[20:21], v214 offset:10240
    s_add_u32 s92, s92, s95
    v_mfma_f32_16x16x32_bf16 v[56:59], a[28:31], a[40:43], v[56:59]
    buffer_load_dwordx4 a[84:87], v221, s[48:51], s42 offen sc1
    v_mfma_f32_16x16x32_bf16 v[56:59], a[24:27], a[32:35], v[56:59]
    ds_read_b64_tr_b16 a[22:23], v214 offset:14336
    s_waitcnt lgkmcnt(4)
    v_mfma_f32_16x16x32_bf16 v[64:67], a[0:3], a[32:35], v[64:67]
    ds_read_b64_tr_b16 a[24:25], v215 offset:2048
    ds_read_b64_tr_b16 a[26:27], v215 offset:6144
    v_mfma_f32_16x16x32_bf16 v[64:67], a[4:7], a[40:43], v[64:67]
    ds_read_b64_tr_b16 a[28:29], v215 offset:10240
    s_add_u32 s42, s42, 196608
    v_mfma_f32_16x16x32_bf16 v[68:71], a[4:7], a[44:47], v[68:71]
    buffer_load_dwordx4 a[88:91], v220, s[48:51], s42 offen sc1
    v_mfma_f32_16x16x32_bf16 v[68:71], a[0:3], a[36:39], v[68:71]
    ds_read_b64_tr_b16 a[30:31], v215 offset:14336
    v_mfma_f32_16x16x32_bf16 v[76:79], a[8:11], a[36:39], v[76:79]
    ds_read_b64_tr_b16 a[0:1], v212 offset:16384
    ds_read_b64_tr_b16 a[2:3], v212 offset:20480
    v_mfma_f32_16x16x32_bf16 v[76:79], a[12:15], a[44:47], v[76:79]
    ds_read_b64_tr_b16 a[4:5], v212 offset:24576
    v_mfma_f32_16x16x32_bf16 v[72:75], a[12:15], a[40:43], v[72:75]
    buffer_load_dwordx4 v15, s[88:91], s94 offen offset:2048 sc1 lds
    v_mfma_f32_16x16x32_bf16 v[72:75], a[8:11], a[32:35], v[72:75]
    ds_read_b64_tr_b16 a[6:7], v212 offset:28672
    s_waitcnt lgkmcnt(4)
    v_mfma_f32_16x16x32_bf16 v[80:83], a[16:19], a[32:35], v[80:83]
    ds_read_b64_tr_b16 a[8:9], v213 offset:16384
    ds_read_b64_tr_b16 a[10:11], v213 offset:20480
    v_mfma_f32_16x16x32_bf16 v[80:83], a[20:23], a[40:43], v[80:83]
    ds_read_b64_tr_b16 a[12:13], v213 offset:24576
    v_mfma_f32_16x16x32_bf16 v[84:87], a[20:23], a[44:47], v[84:87]
    buffer_load_dwordx4 a[92:95], v221, s[48:51], s42 offen sc1
    v_mfma_f32_16x16x32_bf16 v[84:87], a[16:19], a[36:39], v[84:87]
    ds_read_b64_tr_b16 a[14:15], v213 offset:28672
    v_mfma_f32_16x16x32_bf16 v[92:95], a[24:27], a[36:39], v[92:95]
    ds_read_b64_tr_b16 a[16:17], v214 offset:16384
    ds_read_b64_tr_b16 a[18:19], v214 offset:20480
    v_mfma_f32_16x16x32_bf16 v[92:95], a[28:31], a[44:47], v[92:95]
    ds_read_b64_tr_b16 a[20:21], v214 offset:24576
    s_add_u32 s42, s42, 196608
    v_mfma_f32_16x16x32_bf16 v[88:91], a[28:31], a[40:43], v[88:91]
    buffer_load_dwordx4 v28, s[88:91], s94 offen offset:3072 sc1 lds
    v_mfma_f32_16x16x32_bf16 v[88:91], a[24:27], a[32:35], v[88:91]
    ds_read_b64_tr_b16 a[22:23], v214 offset:28672
    s_waitcnt vmcnt(17) lgkmcnt(4)
    v_mfma_f32_16x16x32_bf16 v[32:35], a[0:3], a[48:51], v[32:35]
    ds_read_b64_tr_b16 a[24:25], v215 offset:16384
    ds_read_b64_tr_b16 a[26:27], v215 offset:20480
    v_mfma_f32_16x16x32_bf16 v[32:35], a[4:7], a[56:59], v[32:35]
    ds_read_b64_tr_b16 a[28:29], v215 offset:24576
    s_add_u32 s94, s94, s97
    v_mfma_f32_16x16x32_bf16 v[36:39], a[4:7], a[60:63], v[36:39]
    buffer_load_dwordx4 a[32:35], v220, s[48:51], s42 offen sc1
    v_mfma_f32_16x16x32_bf16 v[36:39], a[0:3], a[52:55], v[36:39]
    ds_read_b64_tr_b16 a[30:31], v215 offset:28672
    v_mfma_f32_16x16x32_bf16 v[44:47], a[8:11], a[52:55], v[44:47]
    ds_read_b64_tr_b16 a[0:1], v212 offset:18432
    ds_read_b64_tr_b16 a[2:3], v212 offset:22528
    v_mfma_f32_16x16x32_bf16 v[44:47], a[12:15], a[60:63], v[44:47]
    ds_read_b64_tr_b16 a[4:5], v212 offset:26624
    s_add_u32 m0, s46, 16384
    v_mfma_f32_16x16x32_bf16 v[40:43], a[12:15], a[56:59], v[40:43]
    buffer_load_dwordx4 v2, s[84:87], s92 offen offset:0 sc1 lds
    v_mfma_f32_16x16x32_bf16 v[40:43], a[8:11], a[48:51], v[40:43]
    ds_read_b64_tr_b16 a[6:7], v212 offset:30720
    s_waitcnt lgkmcnt(4)
    v_mfma_f32_16x16x32_bf16 v[48:51], a[16:19], a[48:51], v[48:51]
    ds_read_b64_tr_b16 a[8:9], v213 offset:18432
    ds_read_b64_tr_b16 a[10:11], v213 offset:22528
    v_mfma_f32_16x16x32_bf16 v[48:51], a[20:23], a[56:59], v[48:51]
    ds_read_b64_tr_b16 a[12:13], v213 offset:26624
    v_mfma_f32_16x16x32_bf16 v[52:55], a[20:23], a[60:63], v[52:55]
    buffer_load_dwordx4 a[36:39], v221, s[48:51], s42 offen sc1
    v_mfma_f32_16x16x32_bf16 v[52:55], a[16:19], a[52:55], v[52:55]
    ds_read_b64_tr_b16 a[14:15], v213 offset:30720
    v_mfma_f32_16x16x32_bf16 v[60:63], a[24:27], a[52:55], v[60:63]
    ds_read_b64_tr_b16 a[16:17], v214 offset:18432
    ds_read_b64_tr_b16 a[18:19], v214 offset:22528
    v_mfma_f32_16x16x32_bf16 v[60:63], a[28:31], a[60:63], v[60:63]
    ds_read_b64_tr_b16 a[20:21], v214 offset:26624
    s_add_u32 s42, s42, 196608
    v_mfma_f32_16x16x32_bf16 v[56:59], a[28:31], a[56:59], v[56:59]
    buffer_load_dwordx4 v3, s[84:87], s92 offen offset:1024 sc1 lds
    v_mfma_f32_16x16x32_bf16 v[56:59], a[24:27], a[48:51], v[56:59]
    ds_read_b64_tr_b16 a[22:23], v214 offset:30720
    s_waitcnt lgkmcnt(4)
    v_mfma_f32_16x16x32_bf16 v[64:67], a[0:3], a[48:51], v[64:67]
    ds_read_b64_tr_b16 a[24:25], v215 offset:18432
    ds_read_b64_tr_b16 a[26:27], v215 offset:22528
    v_mfma_f32_16x16x32_bf16 v[64:67], a[4:7], a[56:59], v[64:67]
    ds_read_b64_tr_b16 a[28:29], v215 offset:26624
    s_add_u32 s92, s92, s95
    v_mfma_f32_16x16x32_bf16 v[68:71], a[4:7], a[60:63], v[68:71]
    buffer_load_dwordx2 a[40:41], v222, s[48:51], s42 offen offset:512 sc1
    v_mfma_f32_16x16x32_bf16 v[68:71], a[0:3], a[52:55], v[68:71]
    ds_read_b64_tr_b16 a[30:31], v215 offset:30720
    buffer_load_dwordx2 a[42:43], v222, s[48:51], s42 offen offset:1536 sc1
    v_mfma_f32_16x16x32_bf16 v[76:79], a[8:11], a[52:55], v[76:79]
    s_waitcnt vmcnt(34)
    s_barrier
    ds_read_b64_tr_b16 a[0:1], v212 offset:32768
    ds_read_b64_tr_b16 a[2:3], v212 offset:36864
    v_mfma_f32_16x16x32_bf16 v[76:79], a[12:15], a[60:63], v[76:79]
    ds_read_b64_tr_b16 a[4:5], v212 offset:40960
    v_mfma_f32_16x16x32_bf16 v[72:75], a[12:15], a[56:59], v[72:75]
    buffer_load_dwordx4 v15, s[88:91], s94 offen offset:2048 sc1 lds
    v_mfma_f32_16x16x32_bf16 v[72:75], a[8:11], a[48:51], v[72:75]
    ds_read_b64_tr_b16 a[6:7], v212 offset:45056
    s_waitcnt lgkmcnt(4)
    v_mfma_f32_16x16x32_bf16 v[80:83], a[16:19], a[48:51], v[80:83]
    ds_read_b64_tr_b16 a[8:9], v213 offset:32768
    ds_read_b64_tr_b16 a[10:11], v213 offset:36864
    v_mfma_f32_16x16x32_bf16 v[80:83], a[20:23], a[56:59], v[80:83]
    ds_read_b64_tr_b16 a[12:13], v213 offset:40960
    v_mfma_f32_16x16x32_bf16 v[84:87], a[20:23], a[60:63], v[84:87]
    buffer_load_dwordx2 a[44:45], v222, s[48:51], s42 offen offset:2560 sc1
    v_mfma_f32_16x16x32_bf16 v[84:87], a[16:19], a[52:55], v[84:87]
    ds_read_b64_tr_b16 a[14:15], v213 offset:45056
    buffer_load_dwordx2 a[46:47], v222, s[48:51], s42 offen offset:0 sc1
    v_mfma_f32_16x16x32_bf16 v[92:95], a[24:27], a[52:55], v[92:95]
    ds_read_b64_tr_b16 a[16:17], v214 offset:32768
    ds_read_b64_tr_b16 a[18:19], v214 offset:36864
    v_mfma_f32_16x16x32_bf16 v[92:95], a[28:31], a[60:63], v[92:95]
    ds_read_b64_tr_b16 a[20:21], v214 offset:40960
    s_add_u32 s42, s42, 196608
    v_mfma_f32_16x16x32_bf16 v[88:91], a[28:31], a[56:59], v[88:91]
    buffer_load_dwordx4 v28, s[88:91], s94 offen offset:3072 sc1 lds
    v_mfma_f32_16x16x32_bf16 v[88:91], a[24:27], a[48:51], v[88:91]
    ds_read_b64_tr_b16 a[22:23], v214 offset:45056
    s_waitcnt vmcnt(18) lgkmcnt(4)
    v_mfma_f32_16x16x32_bf16 v[32:35], a[0:3], a[64:67], v[32:35]
    ds_read_b64_tr_b16 a[24:25], v215 offset:32768
    ds_read_b64_tr_b16 a[26:27], v215 offset:36864
    v_mfma_f32_16x16x32_bf16 v[32:35], a[4:7], a[72:75], v[32:35]
    ds_read_b64_tr_b16 a[28:29], v215 offset:40960
    s_add_u32 s94, s94, s97
    v_mfma_f32_16x16x32_bf16 v[36:39], a[4:7], a[76:79], v[36:39]
    buffer_load_dwordx4 a[48:51], v220, s[48:51], s42 offen sc1
    v_mfma_f32_16x16x32_bf16 v[36:39], a[0:3], a[68:71], v[36:39]
    ds_read_b64_tr_b16 a[30:31], v215 offset:45056
    v_mfma_f32_16x16x32_bf16 v[44:47], a[8:11], a[68:71], v[44:47]
    ds_read_b64_tr_b16 a[0:1], v212 offset:34816
    ds_read_b64_tr_b16 a[2:3], v212 offset:38912
    v_mfma_f32_16x16x32_bf16 v[44:47], a[12:15], a[76:79], v[44:47]
    ds_read_b64_tr_b16 a[4:5], v212 offset:43008
    s_add_u32 m0, s46, 32768
    v_mfma_f32_16x16x32_bf16 v[40:43], a[12:15], a[72:75], v[40:43]
    s_getpc_b64 s[16:17]
recurrent_scan__sliding_local_dilated__swiglu_ffn__prompt_kernel_pc12:
    s_mov_b32 s18, code_end - recurrent_scan__sliding_local_dilated__swiglu_ffn__prompt_kernel_pc12
    s_mov_b32 s19, 0x20000
    buffer_load_dwordx4 v2, s[84:87], s92 offen offset:0 sc1 lds
    v_mfma_f32_16x16x32_bf16 v[40:43], a[8:11], a[64:67], v[40:43]
    ds_read_b64_tr_b16 a[6:7], v212 offset:47104
    s_lshl_b32 s20, s7, 2
    s_add_u32 s20, s20, s3
    s_lshl_b32 s20, s20, 8
    v_and_b32 v6, 0x80, v25
    buffer_load_dword a210, v6, s[16:19], s20 offen
    s_waitcnt lgkmcnt(4)
    v_mfma_f32_16x16x32_bf16 v[48:51], a[16:19], a[64:67], v[48:51]
    ds_read_b64_tr_b16 a[8:9], v213 offset:34816
    ds_read_b64_tr_b16 a[10:11], v213 offset:38912
    v_mfma_f32_16x16x32_bf16 v[48:51], a[20:23], a[72:75], v[48:51]
    ds_read_b64_tr_b16 a[12:13], v213 offset:43008
    v_mfma_f32_16x16x32_bf16 v[52:55], a[20:23], a[76:79], v[52:55]
    buffer_load_dwordx4 a[52:55], v221, s[48:51], s42 offen sc1
    v_mfma_f32_16x16x32_bf16 v[52:55], a[16:19], a[68:71], v[52:55]
    ds_read_b64_tr_b16 a[14:15], v213 offset:47104
    v_mfma_f32_16x16x32_bf16 v[60:63], a[24:27], a[68:71], v[60:63]
    ds_read_b64_tr_b16 a[16:17], v214 offset:34816
    ds_read_b64_tr_b16 a[18:19], v214 offset:38912
    v_mfma_f32_16x16x32_bf16 v[60:63], a[28:31], a[76:79], v[60:63]
    ds_read_b64_tr_b16 a[20:21], v214 offset:43008
    s_add_u32 s42, s42, 196608
    v_mfma_f32_16x16x32_bf16 v[56:59], a[28:31], a[72:75], v[56:59]
    buffer_load_dwordx4 v3, s[84:87], s92 offen offset:1024 sc1 lds
    v_mfma_f32_16x16x32_bf16 v[56:59], a[24:27], a[64:67], v[56:59]
    ds_read_b64_tr_b16 a[22:23], v214 offset:47104
    s_waitcnt lgkmcnt(4)
    v_mfma_f32_16x16x32_bf16 v[64:67], a[0:3], a[64:67], v[64:67]
    ds_read_b64_tr_b16 a[24:25], v215 offset:34816
    ds_read_b64_tr_b16 a[26:27], v215 offset:38912
    v_mfma_f32_16x16x32_bf16 v[64:67], a[4:7], a[72:75], v[64:67]
    ds_read_b64_tr_b16 a[28:29], v215 offset:43008
    s_add_u32 s92, s92, s95
    v_mfma_f32_16x16x32_bf16 v[68:71], a[4:7], a[76:79], v[68:71]
    buffer_load_dwordx4 a[56:59], v220, s[48:51], s42 offen sc1
    v_mfma_f32_16x16x32_bf16 v[68:71], a[0:3], a[68:71], v[68:71]
    ds_read_b64_tr_b16 a[30:31], v215 offset:47104
    v_mfma_f32_16x16x32_bf16 v[76:79], a[8:11], a[68:71], v[76:79]
    ds_read_b64_tr_b16 a[0:1], v212 offset:49152
    ds_read_b64_tr_b16 a[2:3], v212 offset:53248
    v_mfma_f32_16x16x32_bf16 v[76:79], a[12:15], a[76:79], v[76:79]
    ds_read_b64_tr_b16 a[4:5], v212 offset:57344
    v_mfma_f32_16x16x32_bf16 v[72:75], a[12:15], a[72:75], v[72:75]
    buffer_load_dwordx4 v15, s[88:91], s94 offen offset:2048 sc1 lds
    v_mfma_f32_16x16x32_bf16 v[72:75], a[8:11], a[64:67], v[72:75]
    ds_read_b64_tr_b16 a[6:7], v212 offset:61440
    s_waitcnt lgkmcnt(4)
    v_mfma_f32_16x16x32_bf16 v[80:83], a[16:19], a[64:67], v[80:83]
    ds_read_b64_tr_b16 a[8:9], v213 offset:49152
    ds_read_b64_tr_b16 a[10:11], v213 offset:53248
    v_mfma_f32_16x16x32_bf16 v[80:83], a[20:23], a[72:75], v[80:83]
    ds_read_b64_tr_b16 a[12:13], v213 offset:57344
    v_mfma_f32_16x16x32_bf16 v[84:87], a[20:23], a[76:79], v[84:87]
    buffer_load_dwordx4 a[60:63], v221, s[48:51], s42 offen sc1
    v_mfma_f32_16x16x32_bf16 v[84:87], a[16:19], a[68:71], v[84:87]
    ds_read_b64_tr_b16 a[14:15], v213 offset:61440
    v_mfma_f32_16x16x32_bf16 v[92:95], a[24:27], a[68:71], v[92:95]
    ds_read_b64_tr_b16 a[16:17], v214 offset:49152
    ds_read_b64_tr_b16 a[18:19], v214 offset:53248
    v_mfma_f32_16x16x32_bf16 v[92:95], a[28:31], a[76:79], v[92:95]
    ds_read_b64_tr_b16 a[20:21], v214 offset:57344
    s_add_u32 s42, s42, 196608
    v_mfma_f32_16x16x32_bf16 v[88:91], a[28:31], a[72:75], v[88:91]
    v_mfma_f32_16x16x32_bf16 v[88:91], a[24:27], a[64:67], v[88:91]
    ds_read_b64_tr_b16 a[22:23], v214 offset:61440
    s_waitcnt vmcnt(19) lgkmcnt(4)
    v_mfma_f32_16x16x32_bf16 v[32:35], a[0:3], a[80:83], v[32:35]
    ds_read_b64_tr_b16 a[24:25], v215 offset:49152
    ds_read_b64_tr_b16 a[26:27], v215 offset:53248
    v_mfma_f32_16x16x32_bf16 v[32:35], a[4:7], a[88:91], v[32:35]
    ds_read_b64_tr_b16 a[28:29], v215 offset:57344
    v_mfma_f32_16x16x32_bf16 v[36:39], a[4:7], a[92:95], v[36:39]
    buffer_load_dwordx4 v28, s[88:91], s94 offen offset:3072 sc1 lds
    v_mfma_f32_16x16x32_bf16 v[36:39], a[0:3], a[84:87], v[36:39]
    ds_read_b64_tr_b16 a[30:31], v215 offset:61440
    v_mfma_f32_16x16x32_bf16 v[44:47], a[8:11], a[84:87], v[44:47]
    ds_read_b64_tr_b16 a[0:1], v212 offset:51200
    ds_read_b64_tr_b16 a[2:3], v212 offset:55296
    v_mfma_f32_16x16x32_bf16 v[44:47], a[12:15], a[92:95], v[44:47]
    ds_read_b64_tr_b16 a[4:5], v212 offset:59392
    s_add_u32 s94, s94, s97
    v_mfma_f32_16x16x32_bf16 v[40:43], a[12:15], a[88:91], v[40:43]
    buffer_load_dwordx4 a[64:67], v220, s[48:51], s42 offen sc1
    v_mfma_f32_16x16x32_bf16 v[40:43], a[8:11], a[80:83], v[40:43]
    ds_read_b64_tr_b16 a[6:7], v212 offset:63488
    s_waitcnt lgkmcnt(4)
    v_mfma_f32_16x16x32_bf16 v[48:51], a[16:19], a[80:83], v[48:51]
    ds_read_b64_tr_b16 a[8:9], v213 offset:51200
    ds_read_b64_tr_b16 a[10:11], v213 offset:55296
    v_mfma_f32_16x16x32_bf16 v[48:51], a[20:23], a[88:91], v[48:51]
    ds_read_b64_tr_b16 a[12:13], v213 offset:59392
    s_add_u32 m0, s46, 49152
    v_mfma_f32_16x16x32_bf16 v[52:55], a[20:23], a[92:95], v[52:55]
recurrent_scan__sliding_local_dilated__swiglu_ffn__prompt_kernel_w7:
    s_cbranch_execz recurrent_scan__sliding_local_dilated__swiglu_ffn__prompt_kernel_w11
    buffer_load_dwordx4 v2, s[84:87], s92 offen offset:0 sc1 lds
    v_mfma_f32_16x16x32_bf16 v[52:55], a[16:19], a[84:87], v[52:55]
    ds_read_b64_tr_b16 a[14:15], v213 offset:63488
    v_mfma_f32_16x16x32_bf16 v[60:63], a[24:27], a[84:87], v[60:63]
    ds_read_b64_tr_b16 a[16:17], v214 offset:51200
    ds_read_b64_tr_b16 a[18:19], v214 offset:55296
    v_mfma_f32_16x16x32_bf16 v[60:63], a[28:31], a[92:95], v[60:63]
    ds_read_b64_tr_b16 a[20:21], v214 offset:59392
    v_mfma_f32_16x16x32_bf16 v[56:59], a[28:31], a[88:91], v[56:59]
    buffer_load_dwordx4 a[68:71], v221, s[48:51], s42 offen sc1
    v_mfma_f32_16x16x32_bf16 v[56:59], a[24:27], a[80:83], v[56:59]
    ds_read_b64_tr_b16 a[22:23], v214 offset:63488
    s_waitcnt lgkmcnt(4)
    v_mfma_f32_16x16x32_bf16 v[64:67], a[0:3], a[80:83], v[64:67]
    ds_read_b64_tr_b16 a[24:25], v215 offset:51200
    ds_read_b64_tr_b16 a[26:27], v215 offset:55296
    v_mfma_f32_16x16x32_bf16 v[64:67], a[4:7], a[88:91], v[64:67]
    ds_read_b64_tr_b16 a[28:29], v215 offset:59392
    s_add_u32 s42, s42, 196608
    v_mfma_f32_16x16x32_bf16 v[68:71], a[4:7], a[92:95], v[68:71]
    buffer_load_dwordx4 v3, s[84:87], s92 offen offset:1024 sc1 lds
    v_mfma_f32_16x16x32_bf16 v[68:71], a[0:3], a[84:87], v[68:71]
    ds_read_b64_tr_b16 a[30:31], v215 offset:63488
    v_mfma_f32_16x16x32_bf16 v[76:79], a[8:11], a[84:87], v[76:79]
    s_waitcnt vmcnt(32)
    s_barrier
    ds_read_b64_tr_b16 a[0:1], v216 offset:0
    ds_read_b64_tr_b16 a[2:3], v216 offset:4096
    v_mfma_f32_16x16x32_bf16 v[76:79], a[12:15], a[92:95], v[76:79]
    ds_read_b64_tr_b16 a[4:5], v216 offset:8192
    s_add_u32 s92, s92, s95
    v_mfma_f32_16x16x32_bf16 v[72:75], a[12:15], a[88:91], v[72:75]
    buffer_load_dwordx4 a[72:75], v220, s[48:51], s42 offen sc1
    v_mfma_f32_16x16x32_bf16 v[72:75], a[8:11], a[80:83], v[72:75]
    ds_read_b64_tr_b16 a[6:7], v216 offset:12288
    s_waitcnt lgkmcnt(4)
    v_mfma_f32_16x16x32_bf16 v[80:83], a[16:19], a[80:83], v[80:83]
    ds_read_b64_tr_b16 a[8:9], v217 offset:0
    ds_read_b64_tr_b16 a[10:11], v217 offset:4096
    v_mfma_f32_16x16x32_bf16 v[80:83], a[20:23], a[88:91], v[80:83]
    ds_read_b64_tr_b16 a[12:13], v217 offset:8192
    v_mfma_f32_16x16x32_bf16 v[84:87], a[20:23], a[92:95], v[84:87]
    buffer_load_dwordx4 a[76:79], v221, s[48:51], s42 offen sc1
    v_mfma_f32_16x16x32_bf16 v[84:87], a[16:19], a[84:87], v[84:87]
    ds_read_b64_tr_b16 a[14:15], v217 offset:12288
    v_mfma_f32_16x16x32_bf16 v[92:95], a[24:27], a[84:87], v[92:95]
    ds_read_b64_tr_b16 a[16:17], v218 offset:0
    ds_read_b64_tr_b16 a[18:19], v218 offset:4096
    v_mfma_f32_16x16x32_bf16 v[92:95], a[28:31], a[92:95], v[92:95]
    ds_read_b64_tr_b16 a[20:21], v218 offset:8192
    s_add_u32 s42, s42, 196608
    v_mfma_f32_16x16x32_bf16 v[88:91], a[28:31], a[88:91], v[88:91]
    buffer_load_dwordx4 v15, s[88:91], s94 offen offset:2048 sc1 lds
    v_mfma_f32_16x16x32_bf16 v[88:91], a[24:27], a[80:83], v[88:91]
    ds_read_b64_tr_b16 a[22:23], v218 offset:12288
    s_waitcnt vmcnt(17) lgkmcnt(4)
    v_mfma_f32_16x16x32_bf16 v[32:35], a[0:3], a[32:35], v[32:35]
    ds_read_b64_tr_b16 a[24:25], v219 offset:0
    ds_read_b64_tr_b16 a[26:27], v219 offset:4096
    v_mfma_f32_16x16x32_bf16 v[32:35], a[4:7], a[40:43], v[32:35]
    ds_read_b64_tr_b16 a[28:29], v219 offset:8192
    v_mfma_f32_16x16x32_bf16 v[36:39], a[4:7], a[44:47], v[36:39]
    buffer_load_dwordx4 a[80:83], v220, s[48:51], s42 offen sc1
    v_mfma_f32_16x16x32_bf16 v[36:39], a[0:3], a[36:39], v[36:39]
    ds_read_b64_tr_b16 a[30:31], v219 offset:12288
    v_mfma_f32_16x16x32_bf16 v[44:47], a[8:11], a[36:39], v[44:47]
    ds_read_b64_tr_b16 a[0:1], v216 offset:2048
    ds_read_b64_tr_b16 a[2:3], v216 offset:6144
    v_mfma_f32_16x16x32_bf16 v[44:47], a[12:15], a[44:47], v[44:47]
    ds_read_b64_tr_b16 a[4:5], v216 offset:10240
    v_mfma_f32_16x16x32_bf16 v[40:43], a[12:15], a[40:43], v[40:43]
    buffer_load_dwordx4 v28, s[88:91], s94 offen offset:3072 sc1 lds
    v_mfma_f32_16x16x32_bf16 v[40:43], a[8:11], a[32:35], v[40:43]
    ds_read_b64_tr_b16 a[6:7], v216 offset:14336
    s_waitcnt lgkmcnt(4)
    v_mfma_f32_16x16x32_bf16 v[48:51], a[16:19], a[32:35], v[48:51]
    ds_read_b64_tr_b16 a[8:9], v217 offset:2048
    ds_read_b64_tr_b16 a[10:11], v217 offset:6144
    v_mfma_f32_16x16x32_bf16 v[48:51], a[20:23], a[40:43], v[48:51]
    ds_read_b64_tr_b16 a[12:13], v217 offset:10240
    s_add_u32 s94, s94, s97
    v_mfma_f32_16x16x32_bf16 v[52:55], a[20:23], a[44:47], v[52:55]
    buffer_load_dwordx4 a[84:87], v221, s[48:51], s42 offen sc1
    v_mfma_f32_16x16x32_bf16 v[52:55], a[16:19], a[36:39], v[52:55]
    ds_read_b64_tr_b16 a[14:15], v217 offset:14336
    v_mfma_f32_16x16x32_bf16 v[60:63], a[24:27], a[36:39], v[60:63]
    ds_read_b64_tr_b16 a[16:17], v218 offset:2048
    ds_read_b64_tr_b16 a[18:19], v218 offset:6144
    v_mfma_f32_16x16x32_bf16 v[60:63], a[28:31], a[44:47], v[60:63]
    ds_read_b64_tr_b16 a[20:21], v218 offset:10240
    s_add_u32 s42, s42, 196608
    s_add_u32 m0, s46, 65536
    v_mfma_f32_16x16x32_bf16 v[56:59], a[28:31], a[40:43], v[56:59]
    buffer_load_dwordx4 v2, s[84:87], s92 offen offset:0 sc1 lds
    v_mfma_f32_16x16x32_bf16 v[56:59], a[24:27], a[32:35], v[56:59]
    ds_read_b64_tr_b16 a[22:23], v218 offset:14336
    s_waitcnt lgkmcnt(4)
    v_mfma_f32_16x16x32_bf16 v[64:67], a[0:3], a[32:35], v[64:67]
    ds_read_b64_tr_b16 a[24:25], v219 offset:2048
    ds_read_b64_tr_b16 a[26:27], v219 offset:6144
    v_mfma_f32_16x16x32_bf16 v[64:67], a[4:7], a[40:43], v[64:67]
    ds_read_b64_tr_b16 a[28:29], v219 offset:10240
    v_mfma_f32_16x16x32_bf16 v[68:71], a[4:7], a[44:47], v[68:71]
    buffer_load_dwordx4 a[88:91], v220, s[48:51], s42 offen sc1
    v_mfma_f32_16x16x32_bf16 v[68:71], a[0:3], a[36:39], v[68:71]
    ds_read_b64_tr_b16 a[30:31], v219 offset:14336
    v_mfma_f32_16x16x32_bf16 v[76:79], a[8:11], a[36:39], v[76:79]
    ds_read_b64_tr_b16 a[0:1], v216 offset:16384
    ds_read_b64_tr_b16 a[2:3], v216 offset:20480
    v_mfma_f32_16x16x32_bf16 v[76:79], a[12:15], a[44:47], v[76:79]
    ds_read_b64_tr_b16 a[4:5], v216 offset:24576
    v_mfma_f32_16x16x32_bf16 v[72:75], a[12:15], a[40:43], v[72:75]
    buffer_load_dwordx4 v3, s[84:87], s92 offen offset:1024 sc1 lds
    v_mfma_f32_16x16x32_bf16 v[72:75], a[8:11], a[32:35], v[72:75]
    ds_read_b64_tr_b16 a[6:7], v216 offset:28672
    s_waitcnt lgkmcnt(4)
    v_mfma_f32_16x16x32_bf16 v[80:83], a[16:19], a[32:35], v[80:83]
    ds_read_b64_tr_b16 a[8:9], v217 offset:16384
    ds_read_b64_tr_b16 a[10:11], v217 offset:20480
    v_mfma_f32_16x16x32_bf16 v[80:83], a[20:23], a[40:43], v[80:83]
    ds_read_b64_tr_b16 a[12:13], v217 offset:24576
    s_add_u32 s92, s92, s95
    v_mfma_f32_16x16x32_bf16 v[84:87], a[20:23], a[44:47], v[84:87]
    buffer_load_dwordx4 a[92:95], v221, s[48:51], s42 offen sc1
    v_mfma_f32_16x16x32_bf16 v[84:87], a[16:19], a[36:39], v[84:87]
    ds_read_b64_tr_b16 a[14:15], v217 offset:28672
    v_mfma_f32_16x16x32_bf16 v[92:95], a[24:27], a[36:39], v[92:95]
    ds_read_b64_tr_b16 a[16:17], v218 offset:16384
    ds_read_b64_tr_b16 a[18:19], v218 offset:20480
    v_mfma_f32_16x16x32_bf16 v[92:95], a[28:31], a[44:47], v[92:95]
    ds_read_b64_tr_b16 a[20:21], v218 offset:24576
    s_add_u32 s42, s42, 196608
    v_mfma_f32_16x16x32_bf16 v[88:91], a[28:31], a[40:43], v[88:91]
    buffer_load_dwordx4 v15, s[88:91], s94 offen offset:2048 sc1 lds
    v_mfma_f32_16x16x32_bf16 v[88:91], a[24:27], a[32:35], v[88:91]
    ds_read_b64_tr_b16 a[22:23], v218 offset:28672
    s_waitcnt vmcnt(16) lgkmcnt(4)
    v_mfma_f32_16x16x32_bf16 v[32:35], a[0:3], a[48:51], v[32:35]
    ds_read_b64_tr_b16 a[24:25], v219 offset:16384
    ds_read_b64_tr_b16 a[26:27], v219 offset:20480
    v_mfma_f32_16x16x32_bf16 v[32:35], a[4:7], a[56:59], v[32:35]
    ds_read_b64_tr_b16 a[28:29], v219 offset:24576
    v_mfma_f32_16x16x32_bf16 v[36:39], a[4:7], a[60:63], v[36:39]
    buffer_load_dwordx2 a[32:33], v222, s[48:51], s42 offen offset:512 sc1
    v_mfma_f32_16x16x32_bf16 v[36:39], a[0:3], a[52:55], v[36:39]
    ds_read_b64_tr_b16 a[30:31], v219 offset:28672
    buffer_load_dwordx2 a[34:35], v222, s[48:51], s42 offen offset:1536 sc1
    v_mfma_f32_16x16x32_bf16 v[44:47], a[8:11], a[52:55], v[44:47]
    ds_read_b64_tr_b16 a[0:1], v216 offset:18432
    ds_read_b64_tr_b16 a[2:3], v216 offset:22528
    v_mfma_f32_16x16x32_bf16 v[44:47], a[12:15], a[60:63], v[44:47]
    ds_read_b64_tr_b16 a[4:5], v216 offset:26624
    v_mfma_f32_16x16x32_bf16 v[40:43], a[12:15], a[56:59], v[40:43]
    buffer_load_dwordx4 v28, s[88:91], s94 offen offset:3072 sc1 lds
    v_mfma_f32_16x16x32_bf16 v[40:43], a[8:11], a[48:51], v[40:43]
    ds_read_b64_tr_b16 a[6:7], v216 offset:30720
    s_waitcnt lgkmcnt(4)
    v_mfma_f32_16x16x32_bf16 v[48:51], a[16:19], a[48:51], v[48:51]
    ds_read_b64_tr_b16 a[8:9], v217 offset:18432
    ds_read_b64_tr_b16 a[10:11], v217 offset:22528
    v_mfma_f32_16x16x32_bf16 v[48:51], a[20:23], a[56:59], v[48:51]
    ds_read_b64_tr_b16 a[12:13], v217 offset:26624
    s_add_u32 s94, s94, s97
    v_mfma_f32_16x16x32_bf16 v[52:55], a[20:23], a[60:63], v[52:55]
    buffer_load_dwordx2 a[36:37], v222, s[48:51], s42 offen offset:2560 sc1
    v_mfma_f32_16x16x32_bf16 v[52:55], a[16:19], a[52:55], v[52:55]
    ds_read_b64_tr_b16 a[14:15], v217 offset:30720
    buffer_load_dwordx2 a[38:39], v222, s[48:51], s42 offen offset:0 sc1
    v_mfma_f32_16x16x32_bf16 v[60:63], a[24:27], a[52:55], v[60:63]
    ds_read_b64_tr_b16 a[16:17], v218 offset:18432
    ds_read_b64_tr_b16 a[18:19], v218 offset:22528
    v_mfma_f32_16x16x32_bf16 v[60:63], a[28:31], a[60:63], v[60:63]
    ds_read_b64_tr_b16 a[20:21], v218 offset:26624
    s_add_u32 s42, s42, 196608
    s_add_u32 m0, s46, 81920
    v_mfma_f32_16x16x32_bf16 v[56:59], a[28:31], a[56:59], v[56:59]
    buffer_load_dwordx4 v2, s[84:87], s92 offen offset:0 sc1 lds
    v_mfma_f32_16x16x32_bf16 v[56:59], a[24:27], a[48:51], v[56:59]
    ds_read_b64_tr_b16 a[22:23], v218 offset:30720
    s_waitcnt lgkmcnt(4)
    v_mfma_f32_16x16x32_bf16 v[64:67], a[0:3], a[48:51], v[64:67]
    ds_read_b64_tr_b16 a[24:25], v219 offset:18432
    ds_read_b64_tr_b16 a[26:27], v219 offset:22528
    v_mfma_f32_16x16x32_bf16 v[64:67], a[4:7], a[56:59], v[64:67]
    ds_read_b64_tr_b16 a[28:29], v219 offset:26624
    v_mfma_f32_16x16x32_bf16 v[68:71], a[4:7], a[60:63], v[68:71]
    buffer_load_dwordx4 a[40:43], v220, s[48:51], s42 offen sc1
    v_mfma_f32_16x16x32_bf16 v[68:71], a[0:3], a[52:55], v[68:71]
    ds_read_b64_tr_b16 a[30:31], v219 offset:30720
    v_mfma_f32_16x16x32_bf16 v[76:79], a[8:11], a[52:55], v[76:79]
    s_waitcnt vmcnt(31)
    s_barrier
    ds_read_b64_tr_b16 a[0:1], v208 offset:0
    ds_read_b64_tr_b16 a[2:3], v208 offset:4096
    v_mfma_f32_16x16x32_bf16 v[76:79], a[12:15], a[60:63], v[76:79]
    ds_read_b64_tr_b16 a[4:5], v208 offset:8192
    v_mfma_f32_16x16x32_bf16 v[72:75], a[12:15], a[56:59], v[72:75]
    buffer_load_dwordx4 v3, s[84:87], s92 offen offset:1024 sc1 lds
    v_mfma_f32_16x16x32_bf16 v[72:75], a[8:11], a[48:51], v[72:75]
    ds_read_b64_tr_b16 a[6:7], v208 offset:12288
    s_waitcnt lgkmcnt(4)
    v_mfma_f32_16x16x32_bf16 v[80:83], a[16:19], a[48:51], v[80:83]
    ds_read_b64_tr_b16 a[8:9], v209 offset:0
    ds_read_b64_tr_b16 a[10:11], v209 offset:4096
    v_mfma_f32_16x16x32_bf16 v[80:83], a[20:23], a[56:59], v[80:83]
    ds_read_b64_tr_b16 a[12:13], v209 offset:8192
    s_add_u32 s92, s92, s95
    v_mfma_f32_16x16x32_bf16 v[84:87], a[20:23], a[60:63], v[84:87]
    buffer_load_dwordx4 a[44:47], v221, s[48:51], s42 offen sc1
    v_mfma_f32_16x16x32_bf16 v[84:87], a[16:19], a[52:55], v[84:87]
    ds_read_b64_tr_b16 a[14:15], v209 offset:12288
    v_mfma_f32_16x16x32_bf16 v[92:95], a[24:27], a[52:55], v[92:95]
    ds_read_b64_tr_b16 a[16:17], v210 offset:0
    ds_read_b64_tr_b16 a[18:19], v210 offset:4096
    v_mfma_f32_16x16x32_bf16 v[92:95], a[28:31], a[60:63], v[92:95]
    ds_read_b64_tr_b16 a[20:21], v210 offset:8192
    s_add_u32 s42, s42, 196608
    v_mfma_f32_16x16x32_bf16 v[88:91], a[28:31], a[56:59], v[88:91]
    v_mfma_f32_16x16x32_bf16 v[88:91], a[24:27], a[48:51], v[88:91]
    ds_read_b64_tr_b16 a[22:23], v210 offset:12288
    s_waitcnt vmcnt(18) lgkmcnt(4)
    v_mfma_f32_16x16x32_bf16 v[32:35], a[0:3], a[64:67], v[32:35]
    ds_read_b64_tr_b16 a[24:25], v211 offset:0
    ds_read_b64_tr_b16 a[26:27], v211 offset:4096
    v_mfma_f32_16x16x32_bf16 v[32:35], a[4:7], a[72:75], v[32:35]
    ds_read_b64_tr_b16 a[28:29], v211 offset:8192
    v_mfma_f32_16x16x32_bf16 v[36:39], a[4:7], a[76:79], v[36:39]
    buffer_load_dwordx4 v15, s[88:91], s94 offen offset:2048 sc1 lds
    v_mfma_f32_16x16x32_bf16 v[36:39], a[0:3], a[68:71], v[36:39]
    ds_read_b64_tr_b16 a[30:31], v211 offset:12288
    v_mfma_f32_16x16x32_bf16 v[44:47], a[8:11], a[68:71], v[44:47]
    ds_read_b64_tr_b16 a[0:1], v208 offset:2048
    ds_read_b64_tr_b16 a[2:3], v208 offset:6144
    v_mfma_f32_16x16x32_bf16 v[44:47], a[12:15], a[76:79], v[44:47]
    ds_read_b64_tr_b16 a[4:5], v208 offset:10240
    v_mfma_f32_16x16x32_bf16 v[40:43], a[12:15], a[72:75], v[40:43]
    buffer_load_dwordx4 a[48:51], v220, s[48:51], s42 offen sc1
    v_mfma_f32_16x16x32_bf16 v[40:43], a[8:11], a[64:67], v[40:43]
    ds_read_b64_tr_b16 a[6:7], v208 offset:14336
    s_waitcnt lgkmcnt(4)
    v_mfma_f32_16x16x32_bf16 v[48:51], a[16:19], a[64:67], v[48:51]
    ds_read_b64_tr_b16 a[8:9], v209 offset:2048
    ds_read_b64_tr_b16 a[10:11], v209 offset:6144
    v_mfma_f32_16x16x32_bf16 v[48:51], a[20:23], a[72:75], v[48:51]
    ds_read_b64_tr_b16 a[12:13], v209 offset:10240
    v_mfma_f32_16x16x32_bf16 v[52:55], a[20:23], a[76:79], v[52:55]
    buffer_load_dwordx4 v28, s[88:91], s94 offen offset:3072 sc1 lds
    v_mfma_f32_16x16x32_bf16 v[52:55], a[16:19], a[68:71], v[52:55]
    ds_read_b64_tr_b16 a[14:15], v209 offset:14336
    v_mfma_f32_16x16x32_bf16 v[60:63], a[24:27], a[68:71], v[60:63]
    ds_read_b64_tr_b16 a[16:17], v210 offset:2048
    ds_read_b64_tr_b16 a[18:19], v210 offset:6144
    v_mfma_f32_16x16x32_bf16 v[60:63], a[28:31], a[76:79], v[60:63]
    ds_read_b64_tr_b16 a[20:21], v210 offset:10240
    s_add_u32 s94, s94, s97
    v_mfma_f32_16x16x32_bf16 v[56:59], a[28:31], a[72:75], v[56:59]
    buffer_load_dwordx4 a[52:55], v221, s[48:51], s42 offen sc1
    v_mfma_f32_16x16x32_bf16 v[56:59], a[24:27], a[64:67], v[56:59]
    ds_read_b64_tr_b16 a[22:23], v210 offset:14336
    s_waitcnt lgkmcnt(4)
    v_mfma_f32_16x16x32_bf16 v[64:67], a[0:3], a[64:67], v[64:67]
    ds_read_b64_tr_b16 a[24:25], v211 offset:2048
    ds_read_b64_tr_b16 a[26:27], v211 offset:6144
    v_mfma_f32_16x16x32_bf16 v[64:67], a[4:7], a[72:75], v[64:67]
    ds_read_b64_tr_b16 a[28:29], v211 offset:10240
    s_add_u32 s42, s42, 196608
    s_add_u32 m0, s46, 98304
    v_mfma_f32_16x16x32_bf16 v[68:71], a[4:7], a[76:79], v[68:71]
    buffer_load_dwordx4 v2, s[84:87], s92 offen offset:0 sc1 lds
    v_mfma_f32_16x16x32_bf16 v[68:71], a[0:3], a[68:71], v[68:71]
    ds_read_b64_tr_b16 a[30:31], v211 offset:14336
    v_mfma_f32_16x16x32_bf16 v[76:79], a[8:11], a[68:71], v[76:79]
    ds_read_b64_tr_b16 a[0:1], v208 offset:16384
    ds_read_b64_tr_b16 a[2:3], v208 offset:20480
    v_mfma_f32_16x16x32_bf16 v[76:79], a[12:15], a[76:79], v[76:79]
    ds_read_b64_tr_b16 a[4:5], v208 offset:24576
    v_mfma_f32_16x16x32_bf16 v[72:75], a[12:15], a[72:75], v[72:75]
    buffer_load_dwordx4 a[56:59], v220, s[48:51], s42 offen sc1
    v_mfma_f32_16x16x32_bf16 v[72:75], a[8:11], a[64:67], v[72:75]
    ds_read_b64_tr_b16 a[6:7], v208 offset:28672
    s_waitcnt lgkmcnt(4)
    v_mfma_f32_16x16x32_bf16 v[80:83], a[16:19], a[64:67], v[80:83]
    ds_read_b64_tr_b16 a[8:9], v209 offset:16384
    ds_read_b64_tr_b16 a[10:11], v209 offset:20480
    v_mfma_f32_16x16x32_bf16 v[80:83], a[20:23], a[72:75], v[80:83]
    ds_read_b64_tr_b16 a[12:13], v209 offset:24576
    v_mfma_f32_16x16x32_bf16 v[84:87], a[20:23], a[76:79], v[84:87]
    buffer_load_dwordx4 a[60:63], v221, s[48:51], s42 offen sc1
    v_mfma_f32_16x16x32_bf16 v[84:87], a[16:19], a[68:71], v[84:87]
    ds_read_b64_tr_b16 a[14:15], v209 offset:28672
    v_mfma_f32_16x16x32_bf16 v[92:95], a[24:27], a[68:71], v[92:95]
    ds_read_b64_tr_b16 a[16:17], v210 offset:16384
    ds_read_b64_tr_b16 a[18:19], v210 offset:20480
    v_mfma_f32_16x16x32_bf16 v[92:95], a[28:31], a[76:79], v[92:95]
    ds_read_b64_tr_b16 a[20:21], v210 offset:24576
    s_add_u32 s42, s42, 196608
    v_mfma_f32_16x16x32_bf16 v[88:91], a[28:31], a[72:75], v[88:91]
    buffer_load_dwordx4 v3, s[84:87], s92 offen offset:1024 sc1 lds
    v_mfma_f32_16x16x32_bf16 v[88:91], a[24:27], a[64:67], v[88:91]
    ds_read_b64_tr_b16 a[22:23], v210 offset:28672
    s_waitcnt vmcnt(18) lgkmcnt(4)
    v_mfma_f32_16x16x32_bf16 v[32:35], a[0:3], a[80:83], v[32:35]
    ds_read_b64_tr_b16 a[24:25], v211 offset:16384
    ds_read_b64_tr_b16 a[26:27], v211 offset:20480
    v_mfma_f32_16x16x32_bf16 v[32:35], a[4:7], a[88:91], v[32:35]
    ds_read_b64_tr_b16 a[28:29], v211 offset:24576
    s_add_u32 s92, s92, s95
    v_mfma_f32_16x16x32_bf16 v[36:39], a[4:7], a[92:95], v[36:39]
    buffer_load_dwordx4 a[64:67], v220, s[48:51], s42 offen sc1
    v_mfma_f32_16x16x32_bf16 v[36:39], a[0:3], a[84:87], v[36:39]
    ds_read_b64_tr_b16 a[30:31], v211 offset:28672
    v_mfma_f32_16x16x32_bf16 v[44:47], a[8:11], a[84:87], v[44:47]
    ds_read_b64_tr_b16 a[0:1], v208 offset:18432
    ds_read_b64_tr_b16 a[2:3], v208 offset:22528
    v_mfma_f32_16x16x32_bf16 v[44:47], a[12:15], a[92:95], v[44:47]
    ds_read_b64_tr_b16 a[4:5], v208 offset:26624
    v_mfma_f32_16x16x32_bf16 v[40:43], a[12:15], a[88:91], v[40:43]
    buffer_load_dwordx4 v15, s[88:91], s94 offen offset:2048 sc1 lds
    v_mfma_f32_16x16x32_bf16 v[40:43], a[8:11], a[80:83], v[40:43]
    ds_read_b64_tr_b16 a[6:7], v208 offset:30720
    s_waitcnt lgkmcnt(4)
    v_mfma_f32_16x16x32_bf16 v[48:51], a[16:19], a[80:83], v[48:51]
    ds_read_b64_tr_b16 a[8:9], v209 offset:18432
    ds_read_b64_tr_b16 a[10:11], v209 offset:22528
    v_mfma_f32_16x16x32_bf16 v[48:51], a[20:23], a[88:91], v[48:51]
    ds_read_b64_tr_b16 a[12:13], v209 offset:26624
    v_mfma_f32_16x16x32_bf16 v[52:55], a[20:23], a[92:95], v[52:55]
    buffer_load_dwordx4 a[68:71], v221, s[48:51], s42 offen sc1
    v_mfma_f32_16x16x32_bf16 v[52:55], a[16:19], a[84:87], v[52:55]
    ds_read_b64_tr_b16 a[14:15], v209 offset:30720
    v_mfma_f32_16x16x32_bf16 v[60:63], a[24:27], a[84:87], v[60:63]
    ds_read_b64_tr_b16 a[16:17], v210 offset:18432
    ds_read_b64_tr_b16 a[18:19], v210 offset:22528
    v_mfma_f32_16x16x32_bf16 v[60:63], a[28:31], a[92:95], v[60:63]
    ds_read_b64_tr_b16 a[20:21], v210 offset:26624
    s_add_u32 s42, s42, 196608
    v_mfma_f32_16x16x32_bf16 v[56:59], a[28:31], a[88:91], v[56:59]
    buffer_load_dwordx4 v28, s[88:91], s94 offen offset:3072 sc1 lds
    v_mfma_f32_16x16x32_bf16 v[56:59], a[24:27], a[80:83], v[56:59]
    ds_read_b64_tr_b16 a[22:23], v210 offset:30720
    s_waitcnt lgkmcnt(4)
    v_mfma_f32_16x16x32_bf16 v[64:67], a[0:3], a[80:83], v[64:67]
    ds_read_b64_tr_b16 a[24:25], v211 offset:18432
    ds_read_b64_tr_b16 a[26:27], v211 offset:22528
    v_mfma_f32_16x16x32_bf16 v[64:67], a[4:7], a[88:91], v[64:67]
    ds_read_b64_tr_b16 a[28:29], v211 offset:26624
    s_add_u32 s94, s94, s97
    v_mfma_f32_16x16x32_bf16 v[68:71], a[4:7], a[92:95], v[68:71]
    buffer_load_dwordx4 a[72:75], v220, s[48:51], s42 offen sc1
    v_mfma_f32_16x16x32_bf16 v[68:71], a[0:3], a[84:87], v[68:71]
    ds_read_b64_tr_b16 a[30:31], v211 offset:30720
    v_mfma_f32_16x16x32_bf16 v[76:79], a[8:11], a[84:87], v[76:79]
    s_waitcnt vmcnt(28)
    s_barrier
    ds_read_b64_tr_b16 a[0:1], v208 offset:32768
    ds_read_b64_tr_b16 a[2:3], v208 offset:36864
    v_mfma_f32_16x16x32_bf16 v[76:79], a[12:15], a[92:95], v[76:79]
    ds_read_b64_tr_b16 a[4:5], v208 offset:40960
    s_add_u32 m0, s46, 114688
    v_mfma_f32_16x16x32_bf16 v[72:75], a[12:15], a[88:91], v[72:75]
    buffer_load_dwordx4 v2, s[84:87], s92 offen offset:0 sc1 lds
    v_mfma_f32_16x16x32_bf16 v[72:75], a[8:11], a[80:83], v[72:75]
    ds_read_b64_tr_b16 a[6:7], v208 offset:45056
    s_waitcnt lgkmcnt(4)
    v_mfma_f32_16x16x32_bf16 v[80:83], a[16:19], a[80:83], v[80:83]
    ds_read_b64_tr_b16 a[8:9], v209 offset:32768
    ds_read_b64_tr_b16 a[10:11], v209 offset:36864
    v_mfma_f32_16x16x32_bf16 v[80:83], a[20:23], a[88:91], v[80:83]
    ds_read_b64_tr_b16 a[12:13], v209 offset:40960
    v_mfma_f32_16x16x32_bf16 v[84:87], a[20:23], a[92:95], v[84:87]
    buffer_load_dwordx4 a[76:79], v221, s[48:51], s42 offen sc1
    v_mfma_f32_16x16x32_bf16 v[84:87], a[16:19], a[84:87], v[84:87]
    ds_read_b64_tr_b16 a[14:15], v209 offset:45056
    v_mfma_f32_16x16x32_bf16 v[92:95], a[24:27], a[84:87], v[92:95]
    ds_read_b64_tr_b16 a[16:17], v210 offset:32768
    ds_read_b64_tr_b16 a[18:19], v210 offset:36864
    v_mfma_f32_16x16x32_bf16 v[92:95], a[28:31], a[92:95], v[92:95]
    ds_read_b64_tr_b16 a[20:21], v210 offset:40960
    s_add_u32 s42, s42, 196608
    v_mfma_f32_16x16x32_bf16 v[88:91], a[28:31], a[88:91], v[88:91]
    buffer_load_dwordx4 v3, s[84:87], s92 offen offset:1024 sc1 lds
    v_mfma_f32_16x16x32_bf16 v[88:91], a[24:27], a[80:83], v[88:91]
    ds_read_b64_tr_b16 a[22:23], v210 offset:45056
    s_waitcnt vmcnt(16) lgkmcnt(4)
    v_mfma_f32_16x16x32_bf16 v[32:35], a[0:3], a[32:35], v[32:35]
    ds_read_b64_tr_b16 a[24:25], v211 offset:32768
    ds_read_b64_tr_b16 a[26:27], v211 offset:36864
    v_mfma_f32_16x16x32_bf16 v[32:35], a[4:7], a[40:43], v[32:35]
    ds_read_b64_tr_b16 a[28:29], v211 offset:40960
    s_add_u32 s92, s92, s95
    v_mfma_f32_16x16x32_bf16 v[36:39], a[4:7], a[44:47], v[36:39]
    buffer_load_dwordx4 a[80:83], v220, s[48:51], s42 offen sc1
    v_mfma_f32_16x16x32_bf16 v[36:39], a[0:3], a[36:39], v[36:39]
    ds_read_b64_tr_b16 a[30:31], v211 offset:45056
    v_mfma_f32_16x16x32_bf16 v[44:47], a[8:11], a[36:39], v[44:47]
    ds_read_b64_tr_b16 a[0:1], v208 offset:34816
    ds_read_b64_tr_b16 a[2:3], v208 offset:38912
    v_mfma_f32_16x16x32_bf16 v[44:47], a[12:15], a[44:47], v[44:47]
    ds_read_b64_tr_b16 a[4:5], v208 offset:43008
    v_mfma_f32_16x16x32_bf16 v[40:43], a[12:15], a[40:43], v[40:43]
    buffer_load_dwordx4 v15, s[88:91], s94 offen offset:2048 sc1 lds
    v_mfma_f32_16x16x32_bf16 v[40:43], a[8:11], a[32:35], v[40:43]
    ds_read_b64_tr_b16 a[6:7], v208 offset:47104
    s_waitcnt lgkmcnt(4)
    v_mfma_f32_16x16x32_bf16 v[48:51], a[16:19], a[32:35], v[48:51]
    ds_read_b64_tr_b16 a[8:9], v209 offset:34816
    ds_read_b64_tr_b16 a[10:11], v209 offset:38912
    v_mfma_f32_16x16x32_bf16 v[48:51], a[20:23], a[40:43], v[48:51]
    ds_read_b64_tr_b16 a[12:13], v209 offset:43008
    v_mfma_f32_16x16x32_bf16 v[52:55], a[20:23], a[44:47], v[52:55]
    buffer_load_dwordx4 a[84:87], v221, s[48:51], s42 offen sc1
    v_mfma_f32_16x16x32_bf16 v[52:55], a[16:19], a[36:39], v[52:55]
    ds_read_b64_tr_b16 a[14:15], v209 offset:47104
    v_mfma_f32_16x16x32_bf16 v[60:63], a[24:27], a[36:39], v[60:63]
    ds_read_b64_tr_b16 a[16:17], v210 offset:34816
    ds_read_b64_tr_b16 a[18:19], v210 offset:38912
    v_mfma_f32_16x16x32_bf16 v[60:63], a[28:31], a[44:47], v[60:63]
    ds_read_b64_tr_b16 a[20:21], v210 offset:43008
    s_add_u32 s42, s42, 196608
    v_mfma_f32_16x16x32_bf16 v[56:59], a[28:31], a[40:43], v[56:59]
    buffer_load_dwordx4 v28, s[88:91], s94 offen offset:3072 sc1 lds
    v_mfma_f32_16x16x32_bf16 v[56:59], a[24:27], a[32:35], v[56:59]
    ds_read_b64_tr_b16 a[22:23], v210 offset:47104
    s_waitcnt lgkmcnt(4)
    v_mfma_f32_16x16x32_bf16 v[64:67], a[0:3], a[32:35], v[64:67]
    ds_read_b64_tr_b16 a[24:25], v211 offset:34816
    ds_read_b64_tr_b16 a[26:27], v211 offset:38912
    v_mfma_f32_16x16x32_bf16 v[64:67], a[4:7], a[40:43], v[64:67]
    ds_read_b64_tr_b16 a[28:29], v211 offset:43008
    s_add_u32 s94, s94, s97
    v_mfma_f32_16x16x32_bf16 v[68:71], a[4:7], a[44:47], v[68:71]
    buffer_load_dwordx2 a[88:89], v222, s[48:51], s42 offen offset:512 sc1
    v_mfma_f32_16x16x32_bf16 v[68:71], a[0:3], a[36:39], v[68:71]
    ds_read_b64_tr_b16 a[30:31], v211 offset:47104
    buffer_load_dwordx2 a[90:91], v222, s[48:51], s42 offen offset:1536 sc1
    v_mfma_f32_16x16x32_bf16 v[76:79], a[8:11], a[36:39], v[76:79]
    ds_read_b64_tr_b16 a[0:1], v208 offset:49152
    ds_read_b64_tr_b16 a[2:3], v208 offset:53248
    v_mfma_f32_16x16x32_bf16 v[76:79], a[12:15], a[44:47], v[76:79]
    ds_read_b64_tr_b16 a[4:5], v208 offset:57344
    s_add_u32 m0, s46, 131072
    v_mfma_f32_16x16x32_bf16 v[72:75], a[12:15], a[40:43], v[72:75]
    buffer_load_dwordx4 v2, s[84:87], s92 offen offset:0 sc1 lds
    v_mfma_f32_16x16x32_bf16 v[72:75], a[8:11], a[32:35], v[72:75]
    ds_read_b64_tr_b16 a[6:7], v208 offset:61440
    s_waitcnt lgkmcnt(4)
    v_mfma_f32_16x16x32_bf16 v[80:83], a[16:19], a[32:35], v[80:83]
    ds_read_b64_tr_b16 a[8:9], v209 offset:49152
    ds_read_b64_tr_b16 a[10:11], v209 offset:53248
    v_mfma_f32_16x16x32_bf16 v[80:83], a[20:23], a[40:43], v[80:83]
    ds_read_b64_tr_b16 a[12:13], v209 offset:57344
    v_mfma_f32_16x16x32_bf16 v[84:87], a[20:23], a[44:47], v[84:87]
    buffer_load_dwordx2 a[92:93], v222, s[48:51], s42 offen offset:2560 sc1
    v_mfma_f32_16x16x32_bf16 v[84:87], a[16:19], a[36:39], v[84:87]
    ds_read_b64_tr_b16 a[14:15], v209 offset:61440
    buffer_load_dwordx2 a[94:95], v222, s[48:51], s42 offen offset:0 sc1
    v_mfma_f32_16x16x32_bf16 v[92:95], a[24:27], a[36:39], v[92:95]
    ds_read_b64_tr_b16 a[16:17], v210 offset:49152
    ds_read_b64_tr_b16 a[18:19], v210 offset:53248
    v_mfma_f32_16x16x32_bf16 v[92:95], a[28:31], a[44:47], v[92:95]
    ds_read_b64_tr_b16 a[20:21], v210 offset:57344
    s_add_u32 s42, s42, 196608
    v_mfma_f32_16x16x32_bf16 v[88:91], a[28:31], a[40:43], v[88:91]
    v_mfma_f32_16x16x32_bf16 v[88:91], a[24:27], a[32:35], v[88:91]
    ds_read_b64_tr_b16 a[22:23], v210 offset:61440
    s_waitcnt vmcnt(18) lgkmcnt(4)
    v_mfma_f32_16x16x32_bf16 v[32:35], a[0:3], a[48:51], v[32:35]
    ds_read_b64_tr_b16 a[24:25], v211 offset:49152
    ds_read_b64_tr_b16 a[26:27], v211 offset:53248
    v_mfma_f32_16x16x32_bf16 v[32:35], a[4:7], a[56:59], v[32:35]
    ds_read_b64_tr_b16 a[28:29], v211 offset:57344
    v_mfma_f32_16x16x32_bf16 v[36:39], a[4:7], a[60:63], v[36:39]
    buffer_load_dwordx4 v3, s[84:87], s92 offen offset:1024 sc1 lds
    v_mfma_f32_16x16x32_bf16 v[36:39], a[0:3], a[52:55], v[36:39]
    ds_read_b64_tr_b16 a[30:31], v211 offset:61440
    v_mfma_f32_16x16x32_bf16 v[44:47], a[8:11], a[52:55], v[44:47]
    ds_read_b64_tr_b16 a[0:1], v208 offset:51200
    ds_read_b64_tr_b16 a[2:3], v208 offset:55296
    v_mfma_f32_16x16x32_bf16 v[44:47], a[12:15], a[60:63], v[44:47]
    ds_read_b64_tr_b16 a[4:5], v208 offset:59392
    s_add_u32 s92, s92, s95
    v_mfma_f32_16x16x32_bf16 v[40:43], a[12:15], a[56:59], v[40:43]
    buffer_load_dwordx4 a[32:35], v220, s[48:51], s42 offen sc1
    v_mfma_f32_16x16x32_bf16 v[40:43], a[8:11], a[48:51], v[40:43]
    ds_read_b64_tr_b16 a[6:7], v208 offset:63488
    s_waitcnt lgkmcnt(4)
    v_mfma_f32_16x16x32_bf16 v[48:51], a[16:19], a[48:51], v[48:51]
    ds_read_b64_tr_b16 a[8:9], v209 offset:51200
    ds_read_b64_tr_b16 a[10:11], v209 offset:55296
    v_mfma_f32_16x16x32_bf16 v[48:51], a[20:23], a[56:59], v[48:51]
    ds_read_b64_tr_b16 a[12:13], v209 offset:59392
    v_mfma_f32_16x16x32_bf16 v[52:55], a[20:23], a[60:63], v[52:55]
    buffer_load_dwordx4 v15, s[88:91], s94 offen offset:2048 sc1 lds
    v_mfma_f32_16x16x32_bf16 v[52:55], a[16:19], a[52:55], v[52:55]
    ds_read_b64_tr_b16 a[14:15], v209 offset:63488
    v_mfma_f32_16x16x32_bf16 v[60:63], a[24:27], a[52:55], v[60:63]
    ds_read_b64_tr_b16 a[16:17], v210 offset:51200
    ds_read_b64_tr_b16 a[18:19], v210 offset:55296
    v_mfma_f32_16x16x32_bf16 v[60:63], a[28:31], a[60:63], v[60:63]
    ds_read_b64_tr_b16 a[20:21], v210 offset:59392
    v_mfma_f32_16x16x32_bf16 v[56:59], a[28:31], a[56:59], v[56:59]
    buffer_load_dwordx4 a[36:39], v221, s[48:51], s42 offen sc1
    v_mfma_f32_16x16x32_bf16 v[56:59], a[24:27], a[48:51], v[56:59]
    ds_read_b64_tr_b16 a[22:23], v210 offset:63488
    s_waitcnt lgkmcnt(4)
    v_mfma_f32_16x16x32_bf16 v[64:67], a[0:3], a[48:51], v[64:67]
    ds_read_b64_tr_b16 a[24:25], v211 offset:51200
    ds_read_b64_tr_b16 a[26:27], v211 offset:55296
    v_mfma_f32_16x16x32_bf16 v[64:67], a[4:7], a[56:59], v[64:67]
    ds_read_b64_tr_b16 a[28:29], v211 offset:59392
    s_add_u32 s42, s42, 196608
    v_mfma_f32_16x16x32_bf16 v[68:71], a[4:7], a[60:63], v[68:71]
    buffer_load_dwordx4 v28, s[88:91], s94 offen offset:3072 sc1 lds
    v_mfma_f32_16x16x32_bf16 v[68:71], a[0:3], a[52:55], v[68:71]
    ds_read_b64_tr_b16 a[30:31], v211 offset:63488
    v_mfma_f32_16x16x32_bf16 v[76:79], a[8:11], a[52:55], v[76:79]
    s_waitcnt vmcnt(27)
    s_barrier
    ds_read_b64_tr_b16 a[0:1], v212 offset:0
    ds_read_b64_tr_b16 a[2:3], v212 offset:4096
    v_mfma_f32_16x16x32_bf16 v[76:79], a[12:15], a[60:63], v[76:79]
    ds_read_b64_tr_b16 a[4:5], v212 offset:8192
    s_add_u32 s94, s94, s97
    v_mfma_f32_16x16x32_bf16 v[72:75], a[12:15], a[56:59], v[72:75]
    buffer_load_dwordx4 a[40:43], v220, s[48:51], s42 offen sc1
    v_mfma_f32_16x16x32_bf16 v[72:75], a[8:11], a[48:51], v[72:75]
    ds_read_b64_tr_b16 a[6:7], v212 offset:12288
    s_waitcnt lgkmcnt(4)
    v_mfma_f32_16x16x32_bf16 v[80:83], a[16:19], a[48:51], v[80:83]
    ds_read_b64_tr_b16 a[8:9], v213 offset:0
    ds_read_b64_tr_b16 a[10:11], v213 offset:4096
    v_mfma_f32_16x16x32_bf16 v[80:83], a[20:23], a[56:59], v[80:83]
    ds_read_b64_tr_b16 a[12:13], v213 offset:8192
    v_mfma_f32_16x16x32_bf16 v[84:87], a[20:23], a[60:63], v[84:87]
    buffer_load_dwordx4 a[44:47], v221, s[48:51], s42 offen sc1
recurrent_scan__sliding_local_dilated__swiglu_ffn__prompt_kernel_w8:
    s_cbranch_execz recurrent_scan__sliding_local_dilated__swiglu_ffn__prompt_kernel_wret0
    v_mfma_f32_16x16x32_bf16 v[84:87], a[16:19], a[52:55], v[84:87]
    ds_read_b64_tr_b16 a[14:15], v213 offset:12288
    v_mfma_f32_16x16x32_bf16 v[92:95], a[24:27], a[52:55], v[92:95]
    ds_read_b64_tr_b16 a[16:17], v214 offset:0
    ds_read_b64_tr_b16 a[18:19], v214 offset:4096
    v_mfma_f32_16x16x32_bf16 v[92:95], a[28:31], a[60:63], v[92:95]
    ds_read_b64_tr_b16 a[20:21], v214 offset:8192
    s_add_u32 s42, s42, 196608
    s_add_u32 m0, s46, 147456
    v_mfma_f32_16x16x32_bf16 v[88:91], a[28:31], a[56:59], v[88:91]
    buffer_load_dwordx4 v2, s[84:87], s92 offen offset:0 sc1 lds
    v_mfma_f32_16x16x32_bf16 v[88:91], a[24:27], a[48:51], v[88:91]
    ds_read_b64_tr_b16 a[22:23], v214 offset:12288
    s_waitcnt vmcnt(18) lgkmcnt(4)
    v_mfma_f32_16x16x32_bf16 v[32:35], a[0:3], a[64:67], v[32:35]
    ds_read_b64_tr_b16 a[24:25], v215 offset:0
    ds_read_b64_tr_b16 a[26:27], v215 offset:4096
    v_mfma_f32_16x16x32_bf16 v[32:35], a[4:7], a[72:75], v[32:35]
    ds_read_b64_tr_b16 a[28:29], v215 offset:8192
    v_mfma_f32_16x16x32_bf16 v[36:39], a[4:7], a[76:79], v[36:39]
    buffer_load_dwordx4 a[48:51], v220, s[48:51], s42 offen sc1
    v_mfma_f32_16x16x32_bf16 v[36:39], a[0:3], a[68:71], v[36:39]
    ds_read_b64_tr_b16 a[30:31], v215 offset:12288
    v_mfma_f32_16x16x32_bf16 v[44:47], a[8:11], a[68:71], v[44:47]
    ds_read_b64_tr_b16 a[0:1], v212 offset:2048
    ds_read_b64_tr_b16 a[2:3], v212 offset:6144
    v_mfma_f32_16x16x32_bf16 v[44:47], a[12:15], a[76:79], v[44:47]
    ds_read_b64_tr_b16 a[4:5], v212 offset:10240
    v_mfma_f32_16x16x32_bf16 v[40:43], a[12:15], a[72:75], v[40:43]
    buffer_load_dwordx4 v3, s[84:87], s92 offen offset:1024 sc1 lds
    v_mfma_f32_16x16x32_bf16 v[40:43], a[8:11], a[64:67], v[40:43]
    ds_read_b64_tr_b16 a[6:7], v212 offset:14336
    s_waitcnt lgkmcnt(4)
    v_mfma_f32_16x16x32_bf16 v[48:51], a[16:19], a[64:67], v[48:51]
    ds_read_b64_tr_b16 a[8:9], v213 offset:2048
    ds_read_b64_tr_b16 a[10:11], v213 offset:6144
    v_mfma_f32_16x16x32_bf16 v[48:51], a[20:23], a[72:75], v[48:51]
    ds_read_b64_tr_b16 a[12:13], v213 offset:10240
    s_add_u32 s92, s92, s95
    v_mfma_f32_16x16x32_bf16 v[52:55], a[20:23], a[76:79], v[52:55]
    buffer_load_dwordx4 a[52:55], v221, s[48:51], s42 offen sc1
    v_mfma_f32_16x16x32_bf16 v[52:55], a[16:19], a[68:71], v[52:55]
    ds_read_b64_tr_b16 a[14:15], v213 offset:14336
    v_mfma_f32_16x16x32_bf16 v[60:63], a[24:27], a[68:71], v[60:63]
    ds_read_b64_tr_b16 a[16:17], v214 offset:2048
    ds_read_b64_tr_b16 a[18:19], v214 offset:6144
    v_mfma_f32_16x16x32_bf16 v[60:63], a[28:31], a[76:79], v[60:63]
    ds_read_b64_tr_b16 a[20:21], v214 offset:10240
    s_add_u32 s42, s42, 196608
    v_mfma_f32_16x16x32_bf16 v[56:59], a[28:31], a[72:75], v[56:59]
    buffer_load_dwordx4 v15, s[88:91], s94 offen offset:2048 sc1 lds
    v_mfma_f32_16x16x32_bf16 v[56:59], a[24:27], a[64:67], v[56:59]
    ds_read_b64_tr_b16 a[22:23], v214 offset:14336
    s_waitcnt lgkmcnt(4)
    v_mfma_f32_16x16x32_bf16 v[64:67], a[0:3], a[64:67], v[64:67]
    ds_read_b64_tr_b16 a[24:25], v215 offset:2048
    ds_read_b64_tr_b16 a[26:27], v215 offset:6144
    v_mfma_f32_16x16x32_bf16 v[64:67], a[4:7], a[72:75], v[64:67]
    ds_read_b64_tr_b16 a[28:29], v215 offset:10240
    v_mfma_f32_16x16x32_bf16 v[68:71], a[4:7], a[76:79], v[68:71]
    buffer_load_dwordx4 a[56:59], v220, s[48:51], s42 offen sc1
    v_mfma_f32_16x16x32_bf16 v[68:71], a[0:3], a[68:71], v[68:71]
    ds_read_b64_tr_b16 a[30:31], v215 offset:14336
    v_mfma_f32_16x16x32_bf16 v[76:79], a[8:11], a[68:71], v[76:79]
    ds_read_b64_tr_b16 a[0:1], v212 offset:16384
    ds_read_b64_tr_b16 a[2:3], v212 offset:20480
    v_mfma_f32_16x16x32_bf16 v[76:79], a[12:15], a[76:79], v[76:79]
    ds_read_b64_tr_b16 a[4:5], v212 offset:24576
    v_mfma_f32_16x16x32_bf16 v[72:75], a[12:15], a[72:75], v[72:75]
    buffer_load_dwordx4 v28, s[88:91], s94 offen offset:3072 sc1 lds
    v_mfma_f32_16x16x32_bf16 v[72:75], a[8:11], a[64:67], v[72:75]
    ds_read_b64_tr_b16 a[6:7], v212 offset:28672
    s_waitcnt lgkmcnt(4)
    v_mfma_f32_16x16x32_bf16 v[80:83], a[16:19], a[64:67], v[80:83]
    ds_read_b64_tr_b16 a[8:9], v213 offset:16384
    ds_read_b64_tr_b16 a[10:11], v213 offset:20480
    v_mfma_f32_16x16x32_bf16 v[80:83], a[20:23], a[72:75], v[80:83]
    ds_read_b64_tr_b16 a[12:13], v213 offset:24576
    s_add_u32 s94, s94, s97
    v_mfma_f32_16x16x32_bf16 v[84:87], a[20:23], a[76:79], v[84:87]
    buffer_load_dwordx4 a[60:63], v221, s[48:51], s42 offen sc1
    v_mfma_f32_16x16x32_bf16 v[84:87], a[16:19], a[68:71], v[84:87]
    ds_read_b64_tr_b16 a[14:15], v213 offset:28672
    v_mfma_f32_16x16x32_bf16 v[92:95], a[24:27], a[68:71], v[92:95]
    ds_read_b64_tr_b16 a[16:17], v214 offset:16384
    ds_read_b64_tr_b16 a[18:19], v214 offset:20480
    v_mfma_f32_16x16x32_bf16 v[92:95], a[28:31], a[76:79], v[92:95]
    ds_read_b64_tr_b16 a[20:21], v214 offset:24576
    s_add_u32 s42, s42, 196608
    s_add_u32 m0, s46, 0
    v_mfma_f32_16x16x32_bf16 v[88:91], a[28:31], a[72:75], v[88:91]
    buffer_load_dwordx4 v2, s[84:87], s92 offen offset:0 sc1 lds
    v_mfma_f32_16x16x32_bf16 v[88:91], a[24:27], a[64:67], v[88:91]
    ds_read_b64_tr_b16 a[22:23], v214 offset:28672
    s_waitcnt vmcnt(16) lgkmcnt(4)
    v_mfma_f32_16x16x32_bf16 v[32:35], a[0:3], a[80:83], v[32:35]
    ds_read_b64_tr_b16 a[24:25], v215 offset:16384
    ds_read_b64_tr_b16 a[26:27], v215 offset:20480
    v_mfma_f32_16x16x32_bf16 v[32:35], a[4:7], a[88:91], v[32:35]
    ds_read_b64_tr_b16 a[28:29], v215 offset:24576
    v_mfma_f32_16x16x32_bf16 v[36:39], a[4:7], a[92:95], v[36:39]
    buffer_load_dwordx4 a[64:67], v220, s[48:51], s42 offen sc1
    v_mfma_f32_16x16x32_bf16 v[36:39], a[0:3], a[84:87], v[36:39]
    ds_read_b64_tr_b16 a[30:31], v215 offset:28672
    v_mfma_f32_16x16x32_bf16 v[44:47], a[8:11], a[84:87], v[44:47]
    ds_read_b64_tr_b16 a[0:1], v212 offset:18432
    ds_read_b64_tr_b16 a[2:3], v212 offset:22528
    v_mfma_f32_16x16x32_bf16 v[44:47], a[12:15], a[92:95], v[44:47]
    ds_read_b64_tr_b16 a[4:5], v212 offset:26624
    v_mfma_f32_16x16x32_bf16 v[40:43], a[12:15], a[88:91], v[40:43]
    buffer_load_dwordx4 v3, s[84:87], s92 offen offset:1024 sc1 lds
    v_mfma_f32_16x16x32_bf16 v[40:43], a[8:11], a[80:83], v[40:43]
    ds_read_b64_tr_b16 a[6:7], v212 offset:30720
    s_waitcnt lgkmcnt(4)
    v_mfma_f32_16x16x32_bf16 v[48:51], a[16:19], a[80:83], v[48:51]
    ds_read_b64_tr_b16 a[8:9], v213 offset:18432
    ds_read_b64_tr_b16 a[10:11], v213 offset:22528
    v_mfma_f32_16x16x32_bf16 v[48:51], a[20:23], a[88:91], v[48:51]
    ds_read_b64_tr_b16 a[12:13], v213 offset:26624
    s_add_u32 s92, s92, s95
    v_mfma_f32_16x16x32_bf16 v[52:55], a[20:23], a[92:95], v[52:55]
    buffer_load_dwordx4 a[68:71], v221, s[48:51], s42 offen sc1
    v_mfma_f32_16x16x32_bf16 v[52:55], a[16:19], a[84:87], v[52:55]
    ds_read_b64_tr_b16 a[14:15], v213 offset:30720
    v_mfma_f32_16x16x32_bf16 v[60:63], a[24:27], a[84:87], v[60:63]
    ds_read_b64_tr_b16 a[16:17], v214 offset:18432
    ds_read_b64_tr_b16 a[18:19], v214 offset:22528
    v_mfma_f32_16x16x32_bf16 v[60:63], a[28:31], a[92:95], v[60:63]
    ds_read_b64_tr_b16 a[20:21], v214 offset:26624
    s_add_u32 s42, s42, 196608
    v_mfma_f32_16x16x32_bf16 v[56:59], a[28:31], a[88:91], v[56:59]
    buffer_load_dwordx4 v15, s[88:91], s94 offen offset:2048 sc1 lds
    v_mfma_f32_16x16x32_bf16 v[56:59], a[24:27], a[80:83], v[56:59]
    ds_read_b64_tr_b16 a[22:23], v214 offset:30720
    s_waitcnt lgkmcnt(4)
    v_mfma_f32_16x16x32_bf16 v[64:67], a[0:3], a[80:83], v[64:67]
    ds_read_b64_tr_b16 a[24:25], v215 offset:18432
    ds_read_b64_tr_b16 a[26:27], v215 offset:22528
    v_mfma_f32_16x16x32_bf16 v[64:67], a[4:7], a[88:91], v[64:67]
    ds_read_b64_tr_b16 a[28:29], v215 offset:26624
    v_mfma_f32_16x16x32_bf16 v[68:71], a[4:7], a[92:95], v[68:71]
    buffer_load_dwordx4 a[72:75], v220, s[48:51], s42 offen sc1
    v_mfma_f32_16x16x32_bf16 v[68:71], a[0:3], a[84:87], v[68:71]
    ds_read_b64_tr_b16 a[30:31], v215 offset:30720
    v_mfma_f32_16x16x32_bf16 v[76:79], a[8:11], a[84:87], v[76:79]
    s_waitcnt vmcnt(26)
    s_barrier
    ds_read_b64_tr_b16 a[0:1], v212 offset:32768
    ds_read_b64_tr_b16 a[2:3], v212 offset:36864
    v_mfma_f32_16x16x32_bf16 v[76:79], a[12:15], a[92:95], v[76:79]
    ds_read_b64_tr_b16 a[4:5], v212 offset:40960
    v_mfma_f32_16x16x32_bf16 v[72:75], a[12:15], a[88:91], v[72:75]
    buffer_load_dwordx4 v28, s[88:91], s94 offen offset:3072 sc1 lds
    v_mfma_f32_16x16x32_bf16 v[72:75], a[8:11], a[80:83], v[72:75]
    ds_read_b64_tr_b16 a[6:7], v212 offset:45056
    s_waitcnt lgkmcnt(4)
    v_mfma_f32_16x16x32_bf16 v[80:83], a[16:19], a[80:83], v[80:83]
    ds_read_b64_tr_b16 a[8:9], v213 offset:32768
    ds_read_b64_tr_b16 a[10:11], v213 offset:36864
    v_mfma_f32_16x16x32_bf16 v[80:83], a[20:23], a[88:91], v[80:83]
    ds_read_b64_tr_b16 a[12:13], v213 offset:40960
    s_add_u32 s94, s94, s97
    v_mfma_f32_16x16x32_bf16 v[84:87], a[20:23], a[92:95], v[84:87]
    buffer_load_dwordx4 a[76:79], v221, s[48:51], s42 offen sc1
    v_mfma_f32_16x16x32_bf16 v[84:87], a[16:19], a[84:87], v[84:87]
    ds_read_b64_tr_b16 a[14:15], v213 offset:45056
    v_mfma_f32_16x16x32_bf16 v[92:95], a[24:27], a[84:87], v[92:95]
    ds_read_b64_tr_b16 a[16:17], v214 offset:32768
    ds_read_b64_tr_b16 a[18:19], v214 offset:36864
    v_mfma_f32_16x16x32_bf16 v[92:95], a[28:31], a[92:95], v[92:95]
    ds_read_b64_tr_b16 a[20:21], v214 offset:40960
    s_add_u32 s42, s42, 196608
    v_mfma_f32_16x16x32_bf16 v[88:91], a[28:31], a[88:91], v[88:91]
    v_mfma_f32_16x16x32_bf16 v[88:91], a[24:27], a[80:83], v[88:91]
    ds_read_b64_tr_b16 a[22:23], v214 offset:45056
    s_waitcnt vmcnt(16) lgkmcnt(4)
    v_mfma_f32_16x16x32_bf16 v[32:35], a[0:3], a[32:35], v[32:35]
    ds_read_b64_tr_b16 a[24:25], v215 offset:32768
    ds_read_b64_tr_b16 a[26:27], v215 offset:36864
    v_mfma_f32_16x16x32_bf16 v[32:35], a[4:7], a[40:43], v[32:35]
    ds_read_b64_tr_b16 a[28:29], v215 offset:40960
    s_add_u32 m0, s46, 16384
    v_mfma_f32_16x16x32_bf16 v[36:39], a[4:7], a[44:47], v[36:39]
    buffer_load_dwordx4 v2, s[84:87], s92 offen offset:0 sc1 lds
    v_mfma_f32_16x16x32_bf16 v[36:39], a[0:3], a[36:39], v[36:39]
    ds_read_b64_tr_b16 a[30:31], v215 offset:45056
    v_mfma_f32_16x16x32_bf16 v[44:47], a[8:11], a[36:39], v[44:47]
    ds_read_b64_tr_b16 a[0:1], v212 offset:34816
    ds_read_b64_tr_b16 a[2:3], v212 offset:38912
    v_mfma_f32_16x16x32_bf16 v[44:47], a[12:15], a[44:47], v[44:47]
    ds_read_b64_tr_b16 a[4:5], v212 offset:43008
    v_mfma_f32_16x16x32_bf16 v[40:43], a[12:15], a[40:43], v[40:43]
    buffer_load_dwordx2 a[80:81], v222, s[48:51], s42 offen offset:512 sc1
    v_mfma_f32_16x16x32_bf16 v[40:43], a[8:11], a[32:35], v[40:43]
    ds_read_b64_tr_b16 a[6:7], v212 offset:47104
    buffer_load_dwordx2 a[82:83], v222, s[48:51], s42 offen offset:1536 sc1
    s_waitcnt lgkmcnt(4)
    v_mfma_f32_16x16x32_bf16 v[48:51], a[16:19], a[32:35], v[48:51]
    ds_read_b64_tr_b16 a[8:9], v213 offset:34816
    ds_read_b64_tr_b16 a[10:11], v213 offset:38912
    v_mfma_f32_16x16x32_bf16 v[48:51], a[20:23], a[40:43], v[48:51]
    ds_read_b64_tr_b16 a[12:13], v213 offset:43008
    v_mfma_f32_16x16x32_bf16 v[52:55], a[20:23], a[44:47], v[52:55]
    buffer_load_dwordx4 v3, s[84:87], s92 offen offset:1024 sc1 lds
    v_mfma_f32_16x16x32_bf16 v[52:55], a[16:19], a[36:39], v[52:55]
    ds_read_b64_tr_b16 a[14:15], v213 offset:47104
    v_mfma_f32_16x16x32_bf16 v[60:63], a[24:27], a[36:39], v[60:63]
    ds_read_b64_tr_b16 a[16:17], v214 offset:34816
    ds_read_b64_tr_b16 a[18:19], v214 offset:38912
    v_mfma_f32_16x16x32_bf16 v[60:63], a[28:31], a[44:47], v[60:63]
    ds_read_b64_tr_b16 a[20:21], v214 offset:43008
    s_add_u32 s92, s92, s95
    v_mfma_f32_16x16x32_bf16 v[56:59], a[28:31], a[40:43], v[56:59]
    buffer_load_dwordx2 a[84:85], v222, s[48:51], s42 offen offset:2560 sc1
    v_mfma_f32_16x16x32_bf16 v[56:59], a[24:27], a[32:35], v[56:59]
    ds_read_b64_tr_b16 a[22:23], v214 offset:47104
    buffer_load_dwordx2 a[86:87], v222, s[48:51], s42 offen offset:0 sc1
    s_waitcnt lgkmcnt(4)
    v_mfma_f32_16x16x32_bf16 v[64:67], a[0:3], a[32:35], v[64:67]
    ds_read_b64_tr_b16 a[24:25], v215 offset:34816
    ds_read_b64_tr_b16 a[26:27], v215 offset:38912
    v_mfma_f32_16x16x32_bf16 v[64:67], a[4:7], a[40:43], v[64:67]
    ds_read_b64_tr_b16 a[28:29], v215 offset:43008
    s_add_u32 s42, s42, 196608
    v_mfma_f32_16x16x32_bf16 v[68:71], a[4:7], a[44:47], v[68:71]
    buffer_load_dwordx4 v15, s[88:91], s94 offen offset:2048 sc1 lds
    v_mfma_f32_16x16x32_bf16 v[68:71], a[0:3], a[36:39], v[68:71]
    ds_read_b64_tr_b16 a[30:31], v215 offset:47104
    v_mfma_f32_16x16x32_bf16 v[76:79], a[8:11], a[36:39], v[76:79]
    ds_read_b64_tr_b16 a[0:1], v212 offset:49152
    ds_read_b64_tr_b16 a[2:3], v212 offset:53248
    v_mfma_f32_16x16x32_bf16 v[76:79], a[12:15], a[44:47], v[76:79]
    ds_read_b64_tr_b16 a[4:5], v212 offset:57344
    v_mfma_f32_16x16x32_bf16 v[72:75], a[12:15], a[40:43], v[72:75]
    buffer_load_dwordx4 a[88:91], v220, s[48:51], s42 offen sc1
    v_mfma_f32_16x16x32_bf16 v[72:75], a[8:11], a[32:35], v[72:75]
    ds_read_b64_tr_b16 a[6:7], v212 offset:61440
    s_waitcnt lgkmcnt(4)
    v_mfma_f32_16x16x32_bf16 v[80:83], a[16:19], a[32:35], v[80:83]
    ds_read_b64_tr_b16 a[8:9], v213 offset:49152
    ds_read_b64_tr_b16 a[10:11], v213 offset:53248
    v_mfma_f32_16x16x32_bf16 v[80:83], a[20:23], a[40:43], v[80:83]
    ds_read_b64_tr_b16 a[12:13], v213 offset:57344
    v_mfma_f32_16x16x32_bf16 v[84:87], a[20:23], a[44:47], v[84:87]
    buffer_load_dwordx4 a[92:95], v221, s[48:51], s42 offen sc1
    v_mfma_f32_16x16x32_bf16 v[84:87], a[16:19], a[36:39], v[84:87]
    ds_read_b64_tr_b16 a[14:15], v213 offset:61440
    v_mfma_f32_16x16x32_bf16 v[92:95], a[24:27], a[36:39], v[92:95]
    ds_read_b64_tr_b16 a[16:17], v214 offset:49152
    ds_read_b64_tr_b16 a[18:19], v214 offset:53248
    v_mfma_f32_16x16x32_bf16 v[92:95], a[28:31], a[44:47], v[92:95]
    ds_read_b64_tr_b16 a[20:21], v214 offset:57344
    s_add_u32 s42, s42, 196608
    v_mfma_f32_16x16x32_bf16 v[88:91], a[28:31], a[40:43], v[88:91]
    buffer_load_dwordx4 v28, s[88:91], s94 offen offset:3072 sc1 lds
    v_mfma_f32_16x16x32_bf16 v[88:91], a[24:27], a[32:35], v[88:91]
    ds_read_b64_tr_b16 a[22:23], v214 offset:61440
    s_waitcnt vmcnt(18) lgkmcnt(4)
    v_mfma_f32_16x16x32_bf16 v[32:35], a[0:3], a[48:51], v[32:35]
    ds_read_b64_tr_b16 a[24:25], v215 offset:49152
    ds_read_b64_tr_b16 a[26:27], v215 offset:53248
    v_mfma_f32_16x16x32_bf16 v[32:35], a[4:7], a[56:59], v[32:35]
    ds_read_b64_tr_b16 a[28:29], v215 offset:57344
    s_add_u32 s94, s94, s97
    v_mfma_f32_16x16x32_bf16 v[36:39], a[4:7], a[60:63], v[36:39]
    buffer_load_dwordx4 a[32:35], v220, s[48:51], s42 offen sc1
    v_mfma_f32_16x16x32_bf16 v[36:39], a[0:3], a[52:55], v[36:39]
    ds_read_b64_tr_b16 a[30:31], v215 offset:61440
    v_mfma_f32_16x16x32_bf16 v[44:47], a[8:11], a[52:55], v[44:47]
    ds_read_b64_tr_b16 a[0:1], v212 offset:51200
    ds_read_b64_tr_b16 a[2:3], v212 offset:55296
    v_mfma_f32_16x16x32_bf16 v[44:47], a[12:15], a[60:63], v[44:47]
    ds_read_b64_tr_b16 a[4:5], v212 offset:59392
    s_add_u32 m0, s46, 32768
    v_mfma_f32_16x16x32_bf16 v[40:43], a[12:15], a[56:59], v[40:43]
    s_getpc_b64 s[16:17]
recurrent_scan__sliding_local_dilated__swiglu_ffn__prompt_kernel_pc34:
    s_mov_b32 s18, code_end - recurrent_scan__sliding_local_dilated__swiglu_ffn__prompt_kernel_pc34
    s_mov_b32 s19, 0x20000
    buffer_load_dwordx4 v2, s[84:87], s92 offen offset:0 sc1 lds
    v_mfma_f32_16x16x32_bf16 v[40:43], a[8:11], a[48:51], v[40:43]
    ds_read_b64_tr_b16 a[6:7], v212 offset:63488
    s_lshl_b32 s20, s7, 2
    s_add_u32 s20, s20, s3
    s_lshl_b32 s20, s20, 8
    v_and_b32 v6, 0x80, v25
    buffer_load_dword a210, v6, s[16:19], s20 offen
    s_waitcnt lgkmcnt(4)
    v_mfma_f32_16x16x32_bf16 v[48:51], a[16:19], a[48:51], v[48:51]
    ds_read_b64_tr_b16 a[8:9], v213 offset:51200
    ds_read_b64_tr_b16 a[10:11], v213 offset:55296
    v_mfma_f32_16x16x32_bf16 v[48:51], a[20:23], a[56:59], v[48:51]
    ds_read_b64_tr_b16 a[12:13], v213 offset:59392
    v_mfma_f32_16x16x32_bf16 v[52:55], a[20:23], a[60:63], v[52:55]
    buffer_load_dwordx4 a[36:39], v221, s[48:51], s42 offen sc1
    v_mfma_f32_16x16x32_bf16 v[52:55], a[16:19], a[52:55], v[52:55]
    ds_read_b64_tr_b16 a[14:15], v213 offset:63488
    v_mfma_f32_16x16x32_bf16 v[60:63], a[24:27], a[52:55], v[60:63]
    ds_read_b64_tr_b16 a[16:17], v214 offset:51200
    ds_read_b64_tr_b16 a[18:19], v214 offset:55296
    v_mfma_f32_16x16x32_bf16 v[60:63], a[28:31], a[60:63], v[60:63]
    ds_read_b64_tr_b16 a[20:21], v214 offset:59392
    s_add_u32 s42, s42, 196608
    v_mfma_f32_16x16x32_bf16 v[56:59], a[28:31], a[56:59], v[56:59]
    buffer_load_dwordx4 v3, s[84:87], s92 offen offset:1024 sc1 lds
    v_mfma_f32_16x16x32_bf16 v[56:59], a[24:27], a[48:51], v[56:59]
    ds_read_b64_tr_b16 a[22:23], v214 offset:63488
    s_waitcnt lgkmcnt(4)
    v_mfma_f32_16x16x32_bf16 v[64:67], a[0:3], a[48:51], v[64:67]
    ds_read_b64_tr_b16 a[24:25], v215 offset:51200
    ds_read_b64_tr_b16 a[26:27], v215 offset:55296
    v_mfma_f32_16x16x32_bf16 v[64:67], a[4:7], a[56:59], v[64:67]
    ds_read_b64_tr_b16 a[28:29], v215 offset:59392
    s_add_u32 s92, s92, s95
    v_mfma_f32_16x16x32_bf16 v[68:71], a[4:7], a[60:63], v[68:71]
    buffer_load_dwordx4 a[40:43], v220, s[48:51], s42 offen sc1
    v_mfma_f32_16x16x32_bf16 v[68:71], a[0:3], a[52:55], v[68:71]
    ds_read_b64_tr_b16 a[30:31], v215 offset:63488
    v_mfma_f32_16x16x32_bf16 v[76:79], a[8:11], a[52:55], v[76:79]
    s_waitcnt vmcnt(25)
    s_barrier
    ds_read_b64_tr_b16 a[0:1], v216 offset:0
    ds_read_b64_tr_b16 a[2:3], v216 offset:4096
    v_mfma_f32_16x16x32_bf16 v[76:79], a[12:15], a[60:63], v[76:79]
    ds_read_b64_tr_b16 a[4:5], v216 offset:8192
    v_mfma_f32_16x16x32_bf16 v[72:75], a[12:15], a[56:59], v[72:75]
    buffer_load_dwordx4 v15, s[88:91], s94 offen offset:2048 sc1 lds
    v_mfma_f32_16x16x32_bf16 v[72:75], a[8:11], a[48:51], v[72:75]
    ds_read_b64_tr_b16 a[6:7], v216 offset:12288
    s_waitcnt lgkmcnt(4)
    v_mfma_f32_16x16x32_bf16 v[80:83], a[16:19], a[48:51], v[80:83]
    ds_read_b64_tr_b16 a[8:9], v217 offset:0
    ds_read_b64_tr_b16 a[10:11], v217 offset:4096
    v_mfma_f32_16x16x32_bf16 v[80:83], a[20:23], a[56:59], v[80:83]
    ds_read_b64_tr_b16 a[12:13], v217 offset:8192
    v_mfma_f32_16x16x32_bf16 v[84:87], a[20:23], a[60:63], v[84:87]
    buffer_load_dwordx4 a[44:47], v221, s[48:51], s42 offen sc1
    v_mfma_f32_16x16x32_bf16 v[84:87], a[16:19], a[52:55], v[84:87]
    ds_read_b64_tr_b16 a[14:15], v217 offset:12288
    v_mfma_f32_16x16x32_bf16 v[92:95], a[24:27], a[52:55], v[92:95]
    ds_read_b64_tr_b16 a[16:17], v218 offset:0
    ds_read_b64_tr_b16 a[18:19], v218 offset:4096
    v_mfma_f32_16x16x32_bf16 v[92:95], a[28:31], a[60:63], v[92:95]
    ds_read_b64_tr_b16 a[20:21], v218 offset:8192
    s_add_u32 s42, s42, 196608
    v_mfma_f32_16x16x32_bf16 v[88:91], a[28:31], a[56:59], v[88:91]
    buffer_load_dwordx4 v28, s[88:91], s94 offen offset:3072 sc1 lds
    v_mfma_f32_16x16x32_bf16 v[88:91], a[24:27], a[48:51], v[88:91]
    ds_read_b64_tr_b16 a[22:23], v218 offset:12288
    s_waitcnt vmcnt(19) lgkmcnt(4)
    v_mfma_f32_16x16x32_bf16 v[32:35], a[0:3], a[64:67], v[32:35]
    ds_read_b64_tr_b16 a[24:25], v219 offset:0
    ds_read_b64_tr_b16 a[26:27], v219 offset:4096
    v_mfma_f32_16x16x32_bf16 v[32:35], a[4:7], a[72:75], v[32:35]
    ds_read_b64_tr_b16 a[28:29], v219 offset:8192
    s_add_u32 s94, s94, s97
    v_mfma_f32_16x16x32_bf16 v[36:39], a[4:7], a[76:79], v[36:39]
    buffer_load_dwordx4 a[48:51], v220, s[48:51], s42 offen sc1
    v_mfma_f32_16x16x32_bf16 v[36:39], a[0:3], a[68:71], v[36:39]
    ds_read_b64_tr_b16 a[30:31], v219 offset:12288
    v_mfma_f32_16x16x32_bf16 v[44:47], a[8:11], a[68:71], v[44:47]
    ds_read_b64_tr_b16 a[0:1], v216 offset:2048
    ds_read_b64_tr_b16 a[2:3], v216 offset:6144
    v_mfma_f32_16x16x32_bf16 v[44:47], a[12:15], a[76:79], v[44:47]
    ds_read_b64_tr_b16 a[4:5], v216 offset:10240
    s_add_u32 m0, s46, 49152
    v_mfma_f32_16x16x32_bf16 v[40:43], a[12:15], a[72:75], v[40:43]
    buffer_load_dwordx4 v2, s[84:87], s92 offen offset:0 sc1 lds
    v_mfma_f32_16x16x32_bf16 v[40:43], a[8:11], a[64:67], v[40:43]
    ds_read_b64_tr_b16 a[6:7], v216 offset:14336
    s_waitcnt lgkmcnt(4)
    v_mfma_f32_16x16x32_bf16 v[48:51], a[16:19], a[64:67], v[48:51]
    ds_read_b64_tr_b16 a[8:9], v217 offset:2048
    ds_read_b64_tr_b16 a[10:11], v217 offset:6144
    v_mfma_f32_16x16x32_bf16 v[48:51], a[20:23], a[72:75], v[48:51]
    ds_read_b64_tr_b16 a[12:13], v217 offset:10240
    v_mfma_f32_16x16x32_bf16 v[52:55], a[20:23], a[76:79], v[52:55]
    buffer_load_dwordx4 a[52:55], v221, s[48:51], s42 offen sc1
    v_mfma_f32_16x16x32_bf16 v[52:55], a[16:19], a[68:71], v[52:55]
    ds_read_b64_tr_b16 a[14:15], v217 offset:14336
    v_mfma_f32_16x16x32_bf16 v[60:63], a[24:27], a[68:71], v[60:63]
    ds_read_b64_tr_b16 a[16:17], v218 offset:2048
    ds_read_b64_tr_b16 a[18:19], v218 offset:6144
    v_mfma_f32_16x16x32_bf16 v[60:63], a[28:31], a[76:79], v[60:63]
    ds_read_b64_tr_b16 a[20:21], v218 offset:10240
    s_add_u32 s42, s42, 196608
    v_mfma_f32_16x16x32_bf16 v[56:59], a[28:31], a[72:75], v[56:59]
    buffer_load_dwordx4 v3, s[84:87], s92 offen offset:1024 sc1 lds
    v_mfma_f32_16x16x32_bf16 v[56:59], a[24:27], a[64:67], v[56:59]
    ds_read_b64_tr_b16 a[22:23], v218 offset:14336
    s_waitcnt lgkmcnt(4)
    v_mfma_f32_16x16x32_bf16 v[64:67], a[0:3], a[64:67], v[64:67]
    ds_read_b64_tr_b16 a[24:25], v219 offset:2048
    ds_read_b64_tr_b16 a[26:27], v219 offset:6144
    v_mfma_f32_16x16x32_bf16 v[64:67], a[4:7], a[72:75], v[64:67]
    ds_read_b64_tr_b16 a[28:29], v219 offset:10240
    s_add_u32 s92, s92, s95
    v_mfma_f32_16x16x32_bf16 v[68:71], a[4:7], a[76:79], v[68:71]
    buffer_load_dwordx4 a[56:59], v220, s[48:51], s42 offen sc1
    v_mfma_f32_16x16x32_bf16 v[68:71], a[0:3], a[68:71], v[68:71]
    ds_read_b64_tr_b16 a[30:31], v219 offset:14336
    v_mfma_f32_16x16x32_bf16 v[76:79], a[8:11], a[68:71], v[76:79]
    ds_read_b64_tr_b16 a[0:1], v216 offset:16384
    ds_read_b64_tr_b16 a[2:3], v216 offset:20480
    v_mfma_f32_16x16x32_bf16 v[76:79], a[12:15], a[76:79], v[76:79]
    ds_read_b64_tr_b16 a[4:5], v216 offset:24576
    v_mfma_f32_16x16x32_bf16 v[72:75], a[12:15], a[72:75], v[72:75]
    buffer_load_dwordx4 v15, s[88:91], s94 offen offset:2048 sc1 lds
    v_mfma_f32_16x16x32_bf16 v[72:75], a[8:11], a[64:67], v[72:75]
    ds_read_b64_tr_b16 a[6:7], v216 offset:28672
    s_waitcnt lgkmcnt(4)
    v_mfma_f32_16x16x32_bf16 v[80:83], a[16:19], a[64:67], v[80:83]
    ds_read_b64_tr_b16 a[8:9], v217 offset:16384
    ds_read_b64_tr_b16 a[10:11], v217 offset:20480
    v_mfma_f32_16x16x32_bf16 v[80:83], a[20:23], a[72:75], v[80:83]
    ds_read_b64_tr_b16 a[12:13], v217 offset:24576
    v_mfma_f32_16x16x32_bf16 v[84:87], a[20:23], a[76:79], v[84:87]
    buffer_load_dwordx4 a[60:63], v221, s[48:51], s42 offen sc1
    v_mfma_f32_16x16x32_bf16 v[84:87], a[16:19], a[68:71], v[84:87]
    ds_read_b64_tr_b16 a[14:15], v217 offset:28672
    v_mfma_f32_16x16x32_bf16 v[92:95], a[24:27], a[68:71], v[92:95]
    ds_read_b64_tr_b16 a[16:17], v218 offset:16384
    ds_read_b64_tr_b16 a[18:19], v218 offset:20480
    v_mfma_f32_16x16x32_bf16 v[92:95], a[28:31], a[76:79], v[92:95]
    ds_read_b64_tr_b16 a[20:21], v218 offset:24576
    s_add_u32 s42, s42, 196608
    v_mfma_f32_16x16x32_bf16 v[88:91], a[28:31], a[72:75], v[88:91]
    buffer_load_dwordx4 v28, s[88:91], s94 offen offset:3072 sc1 lds
    v_mfma_f32_16x16x32_bf16 v[88:91], a[24:27], a[64:67], v[88:91]
    ds_read_b64_tr_b16 a[22:23], v218 offset:28672
    s_waitcnt vmcnt(18) lgkmcnt(4)
    v_mfma_f32_16x16x32_bf16 v[32:35], a[0:3], a[80:83], v[32:35]
    ds_read_b64_tr_b16 a[24:25], v219 offset:16384
    ds_read_b64_tr_b16 a[26:27], v219 offset:20480
    v_mfma_f32_16x16x32_bf16 v[32:35], a[4:7], a[88:91], v[32:35]
    ds_read_b64_tr_b16 a[28:29], v219 offset:24576
    s_add_u32 s94, s94, s97
    v_mfma_f32_16x16x32_bf16 v[36:39], a[4:7], a[92:95], v[36:39]
    buffer_load_dwordx4 a[64:67], v220, s[48:51], s42 offen sc1
    v_mfma_f32_16x16x32_bf16 v[36:39], a[0:3], a[84:87], v[36:39]
    ds_read_b64_tr_b16 a[30:31], v219 offset:28672
    v_mfma_f32_16x16x32_bf16 v[44:47], a[8:11], a[84:87], v[44:47]
    ds_read_b64_tr_b16 a[0:1], v216 offset:18432
    ds_read_b64_tr_b16 a[2:3], v216 offset:22528
    v_mfma_f32_16x16x32_bf16 v[44:47], a[12:15], a[92:95], v[44:47]
    ds_read_b64_tr_b16 a[4:5], v216 offset:26624
    v_mfma_f32_16x16x32_bf16 v[40:43], a[12:15], a[88:91], v[40:43]
    v_mfma_f32_16x16x32_bf16 v[40:43], a[8:11], a[80:83], v[40:43]
    ds_read_b64_tr_b16 a[6:7], v216 offset:30720
    s_waitcnt lgkmcnt(4)
    v_mfma_f32_16x16x32_bf16 v[48:51], a[16:19], a[80:83], v[48:51]
    ds_read_b64_tr_b16 a[8:9], v217 offset:18432
    ds_read_b64_tr_b16 a[10:11], v217 offset:22528
    v_mfma_f32_16x16x32_bf16 v[48:51], a[20:23], a[88:91], v[48:51]
    ds_read_b64_tr_b16 a[12:13], v217 offset:26624
    s_add_u32 m0, s46, 65536
    v_mfma_f32_16x16x32_bf16 v[52:55], a[20:23], a[92:95], v[52:55]
    buffer_load_dwordx4 v2, s[84:87], s92 offen offset:0 sc1 lds
    v_mfma_f32_16x16x32_bf16 v[52:55], a[16:19], a[84:87], v[52:55]
    ds_read_b64_tr_b16 a[14:15], v217 offset:30720
    v_mfma_f32_16x16x32_bf16 v[60:63], a[24:27], a[84:87], v[60:63]
    ds_read_b64_tr_b16 a[16:17], v218 offset:18432
    ds_read_b64_tr_b16 a[18:19], v218 offset:22528
    v_mfma_f32_16x16x32_bf16 v[60:63], a[28:31], a[92:95], v[60:63]
    ds_read_b64_tr_b16 a[20:21], v218 offset:26624
    v_mfma_f32_16x16x32_bf16 v[56:59], a[28:31], a[88:91], v[56:59]
    buffer_load_dwordx4 a[68:71], v221, s[48:51], s42 offen sc1
    v_mfma_f32_16x16x32_bf16 v[56:59], a[24:27], a[80:83], v[56:59]
    ds_read_b64_tr_b16 a[22:23], v218 offset:30720
    s_waitcnt lgkmcnt(4)
    v_mfma_f32_16x16x32_bf16 v[64:67], a[0:3], a[80:83], v[64:67]
    ds_read_b64_tr_b16 a[24:25], v219 offset:18432
    ds_read_b64_tr_b16 a[26:27], v219 offset:22528
    v_mfma_f32_16x16x32_bf16 v[64:67], a[4:7], a[88:91], v[64:67]
    ds_read_b64_tr_b16 a[28:29], v219 offset:26624
    s_add_u32 s42, s42, 196608
    v_mfma_f32_16x16x32_bf16 v[68:71], a[4:7], a[92:95], v[68:71]
    buffer_load_dwordx4 v3, s[84:87], s92 offen offset:1024 sc1 lds
    v_mfma_f32_16x16x32_bf16 v[68:71], a[0:3], a[84:87], v[68:71]
    ds_read_b64_tr_b16 a[30:31], v219 offset:30720
    v_mfma_f32_16x16x32_bf16 v[76:79], a[8:11], a[84:87], v[76:79]
    s_waitcnt vmcnt(21)
    s_barrier
    ds_read_b64_tr_b16 a[0:1], v208 offset:0
    ds_read_b64_tr_b16 a[2:3], v208 offset:4096
    v_mfma_f32_16x16x32_bf16 v[76:79], a[12:15], a[92:95], v[76:79]
    ds_read_b64_tr_b16 a[4:5], v208 offset:8192
    s_add_u32 s92, s92, s95
    v_mfma_f32_16x16x32_bf16 v[72:75], a[12:15], a[88:91], v[72:75]
    buffer_load_dwordx2 a[72:73], v222, s[48:51], s42 offen offset:512 sc1
    v_mfma_f32_16x16x32_bf16 v[72:75], a[8:11], a[80:83], v[72:75]
    ds_read_b64_tr_b16 a[6:7], v208 offset:12288
    buffer_load_dwordx2 a[74:75], v222, s[48:51], s42 offen offset:1536 sc1
    s_waitcnt lgkmcnt(4)
    v_mfma_f32_16x16x32_bf16 v[80:83], a[16:19], a[80:83], v[80:83]
    ds_read_b64_tr_b16 a[8:9], v209 offset:0
    ds_read_b64_tr_b16 a[10:11], v209 offset:4096
    v_mfma_f32_16x16x32_bf16 v[80:83], a[20:23], a[88:91], v[80:83]
    ds_read_b64_tr_b16 a[12:13], v209 offset:8192
    v_mfma_f32_16x16x32_bf16 v[84:87], a[20:23], a[92:95], v[84:87]
    buffer_load_dwordx2 a[76:77], v222, s[48:51], s42 offen offset:2560 sc1
    v_mfma_f32_16x16x32_bf16 v[84:87], a[16:19], a[84:87], v[84:87]
    ds_read_b64_tr_b16 a[14:15], v209 offset:12288
    buffer_load_dwordx2 a[78:79], v222, s[48:51], s42 offen offset:0 sc1
    v_mfma_f32_16x16x32_bf16 v[92:95], a[24:27], a[84:87], v[92:95]
    ds_read_b64_tr_b16 a[16:17], v210 offset:0
    ds_read_b64_tr_b16 a[18:19], v210 offset:4096
    v_mfma_f32_16x16x32_bf16 v[92:95], a[28:31], a[92:95], v[92:95]
    ds_read_b64_tr_b16 a[20:21], v210 offset:8192
    s_add_u32 s42, s42, 196608
    v_mfma_f32_16x16x32_bf16 v[88:91], a[28:31], a[88:91], v[88:91]
    buffer_load_dwordx4 v15, s[88:91], s94 offen offset:2048 sc1 lds
    v_mfma_f32_16x16x32_bf16 v[88:91], a[24:27], a[80:83], v[88:91]
    ds_read_b64_tr_b16 a[22:23], v210 offset:12288
    s_waitcnt vmcnt(18) lgkmcnt(4)
    v_mfma_f32_16x16x32_bf16 v[32:35], a[0:3], a[32:35], v[32:35]
    ds_read_b64_tr_b16 a[24:25], v211 offset:0
    ds_read_b64_tr_b16 a[26:27], v211 offset:4096
    v_mfma_f32_16x16x32_bf16 v[32:35], a[4:7], a[40:43], v[32:35]
    ds_read_b64_tr_b16 a[28:29], v211 offset:8192
    v_mfma_f32_16x16x32_bf16 v[36:39], a[4:7], a[44:47], v[36:39]
    buffer_load_dwordx4 a[80:83], v220, s[48:51], s42 offen sc1
    v_mfma_f32_16x16x32_bf16 v[36:39], a[0:3], a[36:39], v[36:39]
    ds_read_b64_tr_b16 a[30:31], v211 offset:12288
    v_mfma_f32_16x16x32_bf16 v[44:47], a[8:11], a[36:39], v[44:47]
    ds_read_b64_tr_b16 a[0:1], v208 offset:2048
    ds_read_b64_tr_b16 a[2:3], v208 offset:6144
    v_mfma_f32_16x16x32_bf16 v[44:47], a[12:15], a[44:47], v[44:47]
    ds_read_b64_tr_b16 a[4:5], v208 offset:10240
    v_mfma_f32_16x16x32_bf16 v[40:43], a[12:15], a[40:43], v[40:43]
    buffer_load_dwordx4 v28, s[88:91], s94 offen offset:3072 sc1 lds
    v_mfma_f32_16x16x32_bf16 v[40:43], a[8:11], a[32:35], v[40:43]
    ds_read_b64_tr_b16 a[6:7], v208 offset:14336
    s_waitcnt lgkmcnt(4)
    v_mfma_f32_16x16x32_bf16 v[48:51], a[16:19], a[32:35], v[48:51]
    ds_read_b64_tr_b16 a[8:9], v209 offset:2048
recurrent_scan__sliding_local_dilated__swiglu_ffn__prompt_kernel_w9:
    s_cbranch_execz recurrent_scan__sliding_local_dilated__swiglu_ffn__prompt_kernel_wret0
    ds_read_b64_tr_b16 a[10:11], v209 offset:6144
    v_mfma_f32_16x16x32_bf16 v[48:51], a[20:23], a[40:43], v[48:51]
    ds_read_b64_tr_b16 a[12:13], v209 offset:10240
    s_add_u32 s94, s94, s97
    v_mfma_f32_16x16x32_bf16 v[52:55], a[20:23], a[44:47], v[52:55]
    buffer_load_dwordx4 a[84:87], v221, s[48:51], s42 offen sc1
    v_mfma_f32_16x16x32_bf16 v[52:55], a[16:19], a[36:39], v[52:55]
    ds_read_b64_tr_b16 a[14:15], v209 offset:14336
    v_mfma_f32_16x16x32_bf16 v[60:63], a[24:27], a[36:39], v[60:63]
    ds_read_b64_tr_b16 a[16:17], v210 offset:2048
    ds_read_b64_tr_b16 a[18:19], v210 offset:6144
    v_mfma_f32_16x16x32_bf16 v[60:63], a[28:31], a[44:47], v[60:63]
    ds_read_b64_tr_b16 a[20:21], v210 offset:10240
    s_add_u32 s42, s42, 196608
    s_add_u32 m0, s46, 81920
    v_mfma_f32_16x16x32_bf16 v[56:59], a[28:31], a[40:43], v[56:59]
    buffer_load_dwordx4 v2, s[84:87], s92 offen offset:0 sc1 lds
    v_mfma_f32_16x16x32_bf16 v[56:59], a[24:27], a[32:35], v[56:59]
    ds_read_b64_tr_b16 a[22:23], v210 offset:14336
    s_waitcnt lgkmcnt(4)
    v_mfma_f32_16x16x32_bf16 v[64:67], a[0:3], a[32:35], v[64:67]
    ds_read_b64_tr_b16 a[24:25], v211 offset:2048
    ds_read_b64_tr_b16 a[26:27], v211 offset:6144
    v_mfma_f32_16x16x32_bf16 v[64:67], a[4:7], a[40:43], v[64:67]
    ds_read_b64_tr_b16 a[28:29], v211 offset:10240
    v_mfma_f32_16x16x32_bf16 v[68:71], a[4:7], a[44:47], v[68:71]
    buffer_load_dwordx4 a[88:91], v220, s[48:51], s42 offen sc1
    v_mfma_f32_16x16x32_bf16 v[68:71], a[0:3], a[36:39], v[68:71]
    ds_read_b64_tr_b16 a[30:31], v211 offset:14336
    v_mfma_f32_16x16x32_bf16 v[76:79], a[8:11], a[36:39], v[76:79]
    ds_read_b64_tr_b16 a[0:1], v208 offset:16384
    ds_read_b64_tr_b16 a[2:3], v208 offset:20480
    v_mfma_f32_16x16x32_bf16 v[76:79], a[12:15], a[44:47], v[76:79]
    ds_read_b64_tr_b16 a[4:5], v208 offset:24576
    v_mfma_f32_16x16x32_bf16 v[72:75], a[12:15], a[40:43], v[72:75]
    buffer_load_dwordx4 v3, s[84:87], s92 offen offset:1024 sc1 lds
    v_mfma_f32_16x16x32_bf16 v[72:75], a[8:11], a[32:35], v[72:75]
    ds_read_b64_tr_b16 a[6:7], v208 offset:28672
    s_waitcnt lgkmcnt(4)
    v_mfma_f32_16x16x32_bf16 v[80:83], a[16:19], a[32:35], v[80:83]
    ds_read_b64_tr_b16 a[8:9], v209 offset:16384
    ds_read_b64_tr_b16 a[10:11], v209 offset:20480
    v_mfma_f32_16x16x32_bf16 v[80:83], a[20:23], a[40:43], v[80:83]
    ds_read_b64_tr_b16 a[12:13], v209 offset:24576
    s_add_u32 s92, s92, s95
    v_mfma_f32_16x16x32_bf16 v[84:87], a[20:23], a[44:47], v[84:87]
    buffer_load_dwordx4 a[92:95], v221, s[48:51], s42 offen sc1
    v_mfma_f32_16x16x32_bf16 v[84:87], a[16:19], a[36:39], v[84:87]
    ds_read_b64_tr_b16 a[14:15], v209 offset:28672
    v_mfma_f32_16x16x32_bf16 v[92:95], a[24:27], a[36:39], v[92:95]
    ds_read_b64_tr_b16 a[16:17], v210 offset:16384
    ds_read_b64_tr_b16 a[18:19], v210 offset:20480
    v_mfma_f32_16x16x32_bf16 v[92:95], a[28:31], a[44:47], v[92:95]
    ds_read_b64_tr_b16 a[20:21], v210 offset:24576
    s_add_u32 s42, s42, 196608
    v_mfma_f32_16x16x32_bf16 v[88:91], a[28:31], a[40:43], v[88:91]
    buffer_load_dwordx4 v15, s[88:91], s94 offen offset:2048 sc1 lds
    v_mfma_f32_16x16x32_bf16 v[88:91], a[24:27], a[32:35], v[88:91]
    ds_read_b64_tr_b16 a[22:23], v210 offset:28672
    s_waitcnt vmcnt(18) lgkmcnt(4)
    v_mfma_f32_16x16x32_bf16 v[32:35], a[0:3], a[48:51], v[32:35]
    ds_read_b64_tr_b16 a[24:25], v211 offset:16384
    ds_read_b64_tr_b16 a[26:27], v211 offset:20480
    v_mfma_f32_16x16x32_bf16 v[32:35], a[4:7], a[56:59], v[32:35]
    ds_read_b64_tr_b16 a[28:29], v211 offset:24576
    v_mfma_f32_16x16x32_bf16 v[36:39], a[4:7], a[60:63], v[36:39]
    buffer_load_dwordx4 a[32:35], v220, s[48:51], s42 offen sc1
    v_mfma_f32_16x16x32_bf16 v[36:39], a[0:3], a[52:55], v[36:39]
    ds_read_b64_tr_b16 a[30:31], v211 offset:28672
    v_mfma_f32_16x16x32_bf16 v[44:47], a[8:11], a[52:55], v[44:47]
    ds_read_b64_tr_b16 a[0:1], v208 offset:18432
    ds_read_b64_tr_b16 a[2:3], v208 offset:22528
    v_mfma_f32_16x16x32_bf16 v[44:47], a[12:15], a[60:63], v[44:47]
    ds_read_b64_tr_b16 a[4:5], v208 offset:26624
    v_mfma_f32_16x16x32_bf16 v[40:43], a[12:15], a[56:59], v[40:43]
    buffer_load_dwordx4 v28, s[88:91], s94 offen offset:3072 sc1 lds
    v_mfma_f32_16x16x32_bf16 v[40:43], a[8:11], a[48:51], v[40:43]
    ds_read_b64_tr_b16 a[6:7], v208 offset:30720
    s_waitcnt lgkmcnt(4)
    v_mfma_f32_16x16x32_bf16 v[48:51], a[16:19], a[48:51], v[48:51]
    ds_read_b64_tr_b16 a[8:9], v209 offset:18432
    ds_read_b64_tr_b16 a[10:11], v209 offset:22528
    v_mfma_f32_16x16x32_bf16 v[48:51], a[20:23], a[56:59], v[48:51]
    ds_read_b64_tr_b16 a[12:13], v209 offset:26624
    s_add_u32 s94, s94, s97
    v_mfma_f32_16x16x32_bf16 v[52:55], a[20:23], a[60:63], v[52:55]
    buffer_load_dwordx4 a[36:39], v221, s[48:51], s42 offen sc1
    v_mfma_f32_16x16x32_bf16 v[52:55], a[16:19], a[52:55], v[52:55]
    ds_read_b64_tr_b16 a[14:15], v209 offset:30720
    buffer_load_dword v27, v24, s[80:83], s30 offen sc1
    v_mfma_f32_16x16x32_bf16 v[60:63], a[24:27], a[52:55], v[60:63]
    ds_read_b64_tr_b16 a[16:17], v210 offset:18432
    ds_read_b64_tr_b16 a[18:19], v210 offset:22528
    v_mfma_f32_16x16x32_bf16 v[60:63], a[28:31], a[60:63], v[60:63]
    ds_read_b64_tr_b16 a[20:21], v210 offset:26624
    s_add_u32 s42, s42, 196608
    s_add_u32 m0, s46, 98304
    v_mfma_f32_16x16x32_bf16 v[56:59], a[28:31], a[56:59], v[56:59]
    buffer_load_dwordx4 v2, s[84:87], s92 offen offset:0 sc1 lds
    v_mfma_f32_16x16x32_bf16 v[56:59], a[24:27], a[48:51], v[56:59]
    ds_read_b64_tr_b16 a[22:23], v210 offset:30720
    s_waitcnt lgkmcnt(4)
    v_mfma_f32_16x16x32_bf16 v[64:67], a[0:3], a[48:51], v[64:67]
    ds_read_b64_tr_b16 a[24:25], v211 offset:18432
    ds_read_b64_tr_b16 a[26:27], v211 offset:22528
    v_mfma_f32_16x16x32_bf16 v[64:67], a[4:7], a[56:59], v[64:67]
    ds_read_b64_tr_b16 a[28:29], v211 offset:26624
    v_mfma_f32_16x16x32_bf16 v[68:71], a[4:7], a[60:63], v[68:71]
    buffer_load_dwordx4 a[40:43], v220, s[48:51], s42 offen sc1
    v_mfma_f32_16x16x32_bf16 v[68:71], a[0:3], a[52:55], v[68:71]
    ds_read_b64_tr_b16 a[30:31], v211 offset:30720
    v_mfma_f32_16x16x32_bf16 v[76:79], a[8:11], a[52:55], v[76:79]
    s_waitcnt vmcnt(23)
    s_barrier
    ds_read_b64_tr_b16 a[0:1], v208 offset:32768
    ds_read_b64_tr_b16 a[2:3], v208 offset:36864
    v_mfma_f32_16x16x32_bf16 v[76:79], a[12:15], a[60:63], v[76:79]
    ds_read_b64_tr_b16 a[4:5], v208 offset:40960
    v_mfma_f32_16x16x32_bf16 v[72:75], a[12:15], a[56:59], v[72:75]
    buffer_load_dwordx4 v3, s[84:87], s92 offen offset:1024 sc1 lds
    v_mfma_f32_16x16x32_bf16 v[72:75], a[8:11], a[48:51], v[72:75]
    ds_read_b64_tr_b16 a[6:7], v208 offset:45056
    s_waitcnt lgkmcnt(4)
    v_mfma_f32_16x16x32_bf16 v[80:83], a[16:19], a[48:51], v[80:83]
    ds_read_b64_tr_b16 a[8:9], v209 offset:32768
    ds_read_b64_tr_b16 a[10:11], v209 offset:36864
    v_mfma_f32_16x16x32_bf16 v[80:83], a[20:23], a[56:59], v[80:83]
    ds_read_b64_tr_b16 a[12:13], v209 offset:40960
    s_add_u32 s92, s92, s95
    v_mfma_f32_16x16x32_bf16 v[84:87], a[20:23], a[60:63], v[84:87]
    buffer_load_dwordx4 a[44:47], v221, s[48:51], s42 offen sc1
    v_mfma_f32_16x16x32_bf16 v[84:87], a[16:19], a[52:55], v[84:87]
    ds_read_b64_tr_b16 a[14:15], v209 offset:45056
    v_mfma_f32_16x16x32_bf16 v[92:95], a[24:27], a[52:55], v[92:95]
    ds_read_b64_tr_b16 a[16:17], v210 offset:32768
    ds_read_b64_tr_b16 a[18:19], v210 offset:36864
    v_mfma_f32_16x16x32_bf16 v[92:95], a[28:31], a[60:63], v[92:95]
    ds_read_b64_tr_b16 a[20:21], v210 offset:40960
    s_add_u32 s42, s42, 196608
    v_mfma_f32_16x16x32_bf16 v[88:91], a[28:31], a[56:59], v[88:91]
    buffer_load_dwordx4 v15, s[88:91], s94 offen offset:2048 sc1 lds
    v_mfma_f32_16x16x32_bf16 v[88:91], a[24:27], a[48:51], v[88:91]
    ds_read_b64_tr_b16 a[22:23], v210 offset:45056
    s_waitcnt vmcnt(18) lgkmcnt(4)
    v_mfma_f32_16x16x32_bf16 v[32:35], a[0:3], a[64:67], v[32:35]
    ds_read_b64_tr_b16 a[24:25], v211 offset:32768
    ds_read_b64_tr_b16 a[26:27], v211 offset:36864
    v_mfma_f32_16x16x32_bf16 v[32:35], a[4:7], a[72:75], v[32:35]
    ds_read_b64_tr_b16 a[28:29], v211 offset:40960
    v_mfma_f32_16x16x32_bf16 v[36:39], a[4:7], a[76:79], v[36:39]
    buffer_load_dwordx4 a[48:51], v220, s[48:51], s42 offen sc1
    v_mfma_f32_16x16x32_bf16 v[36:39], a[0:3], a[68:71], v[36:39]
    ds_read_b64_tr_b16 a[30:31], v211 offset:45056
    v_mfma_f32_16x16x32_bf16 v[44:47], a[8:11], a[68:71], v[44:47]
    ds_read_b64_tr_b16 a[0:1], v208 offset:34816
    ds_read_b64_tr_b16 a[2:3], v208 offset:38912
    v_mfma_f32_16x16x32_bf16 v[44:47], a[12:15], a[76:79], v[44:47]
    ds_read_b64_tr_b16 a[4:5], v208 offset:43008
    v_mfma_f32_16x16x32_bf16 v[40:43], a[12:15], a[72:75], v[40:43]
    v_mfma_f32_16x16x32_bf16 v[40:43], a[8:11], a[64:67], v[40:43]
    ds_read_b64_tr_b16 a[6:7], v208 offset:47104
    s_waitcnt lgkmcnt(4)
    v_mfma_f32_16x16x32_bf16 v[48:51], a[16:19], a[64:67], v[48:51]
    ds_read_b64_tr_b16 a[8:9], v209 offset:34816
    ds_read_b64_tr_b16 a[10:11], v209 offset:38912
    v_mfma_f32_16x16x32_bf16 v[48:51], a[20:23], a[72:75], v[48:51]
    ds_read_b64_tr_b16 a[12:13], v209 offset:43008
    v_mfma_f32_16x16x32_bf16 v[52:55], a[20:23], a[76:79], v[52:55]
    buffer_load_dwordx4 v28, s[88:91], s94 offen offset:3072 sc1 lds
    v_mfma_f32_16x16x32_bf16 v[52:55], a[16:19], a[68:71], v[52:55]
    ds_read_b64_tr_b16 a[14:15], v209 offset:47104
    v_mfma_f32_16x16x32_bf16 v[60:63], a[24:27], a[68:71], v[60:63]
    ds_read_b64_tr_b16 a[16:17], v210 offset:34816
    ds_read_b64_tr_b16 a[18:19], v210 offset:38912
    v_mfma_f32_16x16x32_bf16 v[60:63], a[28:31], a[76:79], v[60:63]
    ds_read_b64_tr_b16 a[20:21], v210 offset:43008
    s_add_u32 s94, s94, s97
    v_mfma_f32_16x16x32_bf16 v[56:59], a[28:31], a[72:75], v[56:59]
    buffer_load_dwordx4 a[52:55], v221, s[48:51], s42 offen sc1
    v_mfma_f32_16x16x32_bf16 v[56:59], a[24:27], a[64:67], v[56:59]
    ds_read_b64_tr_b16 a[22:23], v210 offset:47104
    s_waitcnt lgkmcnt(4)
    v_mfma_f32_16x16x32_bf16 v[64:67], a[0:3], a[64:67], v[64:67]
    ds_read_b64_tr_b16 a[24:25], v211 offset:34816
    ds_read_b64_tr_b16 a[26:27], v211 offset:38912
    v_mfma_f32_16x16x32_bf16 v[64:67], a[4:7], a[72:75], v[64:67]
    ds_read_b64_tr_b16 a[28:29], v211 offset:43008
    s_add_u32 s42, s42, 196608
    s_add_u32 m0, s46, 114688
    v_mfma_f32_16x16x32_bf16 v[68:71], a[4:7], a[76:79], v[68:71]
    buffer_load_dwordx4 v2, s[84:87], s92 offen offset:0 sc1 lds
    v_mfma_f32_16x16x32_bf16 v[68:71], a[0:3], a[68:71], v[68:71]
    ds_read_b64_tr_b16 a[30:31], v211 offset:47104
    v_mfma_f32_16x16x32_bf16 v[76:79], a[8:11], a[68:71], v[76:79]
    ds_read_b64_tr_b16 a[0:1], v208 offset:49152
    ds_read_b64_tr_b16 a[2:3], v208 offset:53248
    v_mfma_f32_16x16x32_bf16 v[76:79], a[12:15], a[76:79], v[76:79]
    ds_read_b64_tr_b16 a[4:5], v208 offset:57344
    v_mfma_f32_16x16x32_bf16 v[72:75], a[12:15], a[72:75], v[72:75]
    buffer_load_dwordx4 a[56:59], v220, s[48:51], s42 offen sc1
    v_mfma_f32_16x16x32_bf16 v[72:75], a[8:11], a[64:67], v[72:75]
    ds_read_b64_tr_b16 a[6:7], v208 offset:61440
    s_waitcnt lgkmcnt(4)
    v_mfma_f32_16x16x32_bf16 v[80:83], a[16:19], a[64:67], v[80:83]
    ds_read_b64_tr_b16 a[8:9], v209 offset:49152
    ds_read_b64_tr_b16 a[10:11], v209 offset:53248
    v_mfma_f32_16x16x32_bf16 v[80:83], a[20:23], a[72:75], v[80:83]
    ds_read_b64_tr_b16 a[12:13], v209 offset:57344
    v_mfma_f32_16x16x32_bf16 v[84:87], a[20:23], a[76:79], v[84:87]
    buffer_load_dwordx4 v3, s[84:87], s92 offen offset:1024 sc1 lds
    v_mfma_f32_16x16x32_bf16 v[84:87], a[16:19], a[68:71], v[84:87]
    ds_read_b64_tr_b16 a[14:15], v209 offset:61440
    v_mfma_f32_16x16x32_bf16 v[92:95], a[24:27], a[68:71], v[92:95]
    ds_read_b64_tr_b16 a[16:17], v210 offset:49152
    ds_read_b64_tr_b16 a[18:19], v210 offset:53248
    v_mfma_f32_16x16x32_bf16 v[92:95], a[28:31], a[76:79], v[92:95]
    ds_read_b64_tr_b16 a[20:21], v210 offset:57344
    s_add_u32 s92, s92, s95
    v_mfma_f32_16x16x32_bf16 v[88:91], a[28:31], a[72:75], v[88:91]
    buffer_load_dwordx4 a[60:63], v221, s[48:51], s42 offen sc1
    v_mfma_f32_16x16x32_bf16 v[88:91], a[24:27], a[64:67], v[88:91]
    ds_read_b64_tr_b16 a[22:23], v210 offset:61440
    s_waitcnt vmcnt(17) lgkmcnt(4)
    v_mfma_f32_16x16x32_bf16 v[32:35], a[0:3], a[80:83], v[32:35]
    ds_read_b64_tr_b16 a[24:25], v211 offset:49152
    ds_read_b64_tr_b16 a[26:27], v211 offset:53248
    v_mfma_f32_16x16x32_bf16 v[32:35], a[4:7], a[88:91], v[32:35]
    ds_read_b64_tr_b16 a[28:29], v211 offset:57344
    s_add_u32 s42, s42, 196608
    v_mfma_f32_16x16x32_bf16 v[36:39], a[4:7], a[92:95], v[36:39]
    buffer_load_dwordx2 a[64:65], v222, s[48:51], s42 offen offset:512 sc1
    v_mfma_f32_16x16x32_bf16 v[36:39], a[0:3], a[84:87], v[36:39]
    ds_read_b64_tr_b16 a[30:31], v211 offset:61440
    buffer_load_dwordx2 a[66:67], v222, s[48:51], s42 offen offset:1536 sc1
    v_mfma_f32_16x16x32_bf16 v[44:47], a[8:11], a[84:87], v[44:47]
    ds_read_b64_tr_b16 a[0:1], v208 offset:51200
    ds_read_b64_tr_b16 a[2:3], v208 offset:55296
    v_mfma_f32_16x16x32_bf16 v[44:47], a[12:15], a[92:95], v[44:47]
    ds_read_b64_tr_b16 a[4:5], v208 offset:59392
    v_mfma_f32_16x16x32_bf16 v[40:43], a[12:15], a[88:91], v[40:43]
    buffer_load_dwordx4 v15, s[88:91], s94 offen offset:2048 sc1 lds
    v_mfma_f32_16x16x32_bf16 v[40:43], a[8:11], a[80:83], v[40:43]
    ds_read_b64_tr_b16 a[6:7], v208 offset:63488
    s_waitcnt lgkmcnt(4)
    v_mfma_f32_16x16x32_bf16 v[48:51], a[16:19], a[80:83], v[48:51]
    ds_read_b64_tr_b16 a[8:9], v209 offset:51200
    ds_read_b64_tr_b16 a[10:11], v209 offset:55296
    v_mfma_f32_16x16x32_bf16 v[48:51], a[20:23], a[88:91], v[48:51]
    ds_read_b64_tr_b16 a[12:13], v209 offset:59392
    v_mfma_f32_16x16x32_bf16 v[52:55], a[20:23], a[92:95], v[52:55]
    buffer_load_dwordx2 a[68:69], v222, s[48:51], s42 offen offset:2560 sc1
    v_mfma_f32_16x16x32_bf16 v[52:55], a[16:19], a[84:87], v[52:55]
    ds_read_b64_tr_b16 a[14:15], v209 offset:63488
    buffer_load_dwordx2 a[70:71], v222, s[48:51], s42 offen offset:0 sc1
    v_mfma_f32_16x16x32_bf16 v[60:63], a[24:27], a[84:87], v[60:63]
    ds_read_b64_tr_b16 a[16:17], v210 offset:51200
    ds_read_b64_tr_b16 a[18:19], v210 offset:55296
    v_mfma_f32_16x16x32_bf16 v[60:63], a[28:31], a[92:95], v[60:63]
    ds_read_b64_tr_b16 a[20:21], v210 offset:59392
    s_add_u32 s42, s42, 196608
    v_mfma_f32_16x16x32_bf16 v[56:59], a[28:31], a[88:91], v[56:59]
    buffer_load_dwordx4 v28, s[88:91], s94 offen offset:3072 sc1 lds
    v_mfma_f32_16x16x32_bf16 v[56:59], a[24:27], a[80:83], v[56:59]
    ds_read_b64_tr_b16 a[22:23], v210 offset:63488
    s_waitcnt lgkmcnt(4)
    v_mfma_f32_16x16x32_bf16 v[64:67], a[0:3], a[80:83], v[64:67]
    ds_read_b64_tr_b16 a[24:25], v211 offset:51200
    ds_read_b64_tr_b16 a[26:27], v211 offset:55296
    v_mfma_f32_16x16x32_bf16 v[64:67], a[4:7], a[88:91], v[64:67]
    ds_read_b64_tr_b16 a[28:29], v211 offset:59392
    s_add_u32 s94, s94, s97
    v_mfma_f32_16x16x32_bf16 v[68:71], a[4:7], a[92:95], v[68:71]
    buffer_load_dwordx4 a[72:75], v220, s[48:51], s42 offen sc1
    v_mfma_f32_16x16x32_bf16 v[68:71], a[0:3], a[84:87], v[68:71]
    ds_read_b64_tr_b16 a[30:31], v211 offset:63488
    v_mfma_f32_16x16x32_bf16 v[76:79], a[8:11], a[84:87], v[76:79]
    s_waitcnt vmcnt(21)
    s_barrier
    ds_read_b64_tr_b16 a[0:1], v212 offset:0
    ds_read_b64_tr_b16 a[2:3], v212 offset:4096
    v_mfma_f32_16x16x32_bf16 v[76:79], a[12:15], a[92:95], v[76:79]
    ds_read_b64_tr_b16 a[4:5], v212 offset:8192
    s_add_u32 m0, s46, 131072
    s_mov_b32 s92, s93
    s_mov_b64 s[84:85], s[64:65]
    s_mov_b32 s86, s66
    v_mfma_f32_16x16x32_bf16 v[72:75], a[12:15], a[88:91], v[72:75]
    buffer_load_dwordx4 v2, s[84:87], s92 offen offset:0 sc1 lds
    v_mfma_f32_16x16x32_bf16 v[72:75], a[8:11], a[80:83], v[72:75]
    ds_read_b64_tr_b16 a[6:7], v212 offset:12288
    s_waitcnt lgkmcnt(4)
    v_mfma_f32_16x16x32_bf16 v[80:83], a[16:19], a[80:83], v[80:83]
    ds_read_b64_tr_b16 a[8:9], v213 offset:0
    ds_read_b64_tr_b16 a[10:11], v213 offset:4096
    v_mfma_f32_16x16x32_bf16 v[80:83], a[20:23], a[88:91], v[80:83]
    ds_read_b64_tr_b16 a[12:13], v213 offset:8192
    v_mfma_f32_16x16x32_bf16 v[84:87], a[20:23], a[92:95], v[84:87]
    buffer_load_dwordx4 a[76:79], v221, s[48:51], s42 offen sc1
    v_mfma_f32_16x16x32_bf16 v[84:87], a[16:19], a[84:87], v[84:87]
    ds_read_b64_tr_b16 a[14:15], v213 offset:12288
    v_mfma_f32_16x16x32_bf16 v[92:95], a[24:27], a[84:87], v[92:95]
    ds_read_b64_tr_b16 a[16:17], v214 offset:0
    ds_read_b64_tr_b16 a[18:19], v214 offset:4096
    v_mfma_f32_16x16x32_bf16 v[92:95], a[28:31], a[92:95], v[92:95]
    ds_read_b64_tr_b16 a[20:21], v214 offset:8192
    s_add_u32 s42, s42, 196608
    v_mfma_f32_16x16x32_bf16 v[88:91], a[28:31], a[88:91], v[88:91]
    v_mfma_f32_16x16x32_bf16 v[88:91], a[24:27], a[80:83], v[88:91]
    ds_read_b64_tr_b16 a[22:23], v214 offset:12288
    s_waitcnt vmcnt(17) lgkmcnt(4)
    v_mfma_f32_16x16x32_bf16 v[32:35], a[0:3], a[32:35], v[32:35]
    ds_read_b64_tr_b16 a[24:25], v215 offset:0
    ds_read_b64_tr_b16 a[26:27], v215 offset:4096
    v_mfma_f32_16x16x32_bf16 v[32:35], a[4:7], a[40:43], v[32:35]
    ds_read_b64_tr_b16 a[28:29], v215 offset:8192
    v_mfma_f32_16x16x32_bf16 v[36:39], a[4:7], a[44:47], v[36:39]
    buffer_load_dwordx4 a[80:83], v220, s[48:51], s42 offen sc1
    v_mfma_f32_16x16x32_bf16 v[36:39], a[0:3], a[36:39], v[36:39]
    ds_read_b64_tr_b16 a[30:31], v215 offset:12288
    v_mfma_f32_16x16x32_bf16 v[44:47], a[8:11], a[36:39], v[44:47]
    ds_read_b64_tr_b16 a[0:1], v212 offset:2048
    ds_read_b64_tr_b16 a[2:3], v212 offset:6144
    v_mfma_f32_16x16x32_bf16 v[44:47], a[12:15], a[44:47], v[44:47]
    ds_read_b64_tr_b16 a[4:5], v212 offset:10240
    v_mfma_f32_16x16x32_bf16 v[40:43], a[12:15], a[40:43], v[40:43]
    buffer_load_dwordx4 v3, s[84:87], s92 offen offset:1024 sc1 lds
    v_mfma_f32_16x16x32_bf16 v[40:43], a[8:11], a[32:35], v[40:43]
    ds_read_b64_tr_b16 a[6:7], v212 offset:14336
    s_waitcnt lgkmcnt(4)
    v_mfma_f32_16x16x32_bf16 v[48:51], a[16:19], a[32:35], v[48:51]
    ds_read_b64_tr_b16 a[8:9], v213 offset:2048
    ds_read_b64_tr_b16 a[10:11], v213 offset:6144
    v_mfma_f32_16x16x32_bf16 v[48:51], a[20:23], a[40:43], v[48:51]
    ds_read_b64_tr_b16 a[12:13], v213 offset:10240
    s_add_u32 s92, s92, s95
    v_mfma_f32_16x16x32_bf16 v[52:55], a[20:23], a[44:47], v[52:55]
    buffer_load_dwordx4 a[84:87], v221, s[48:51], s42 offen sc1
    v_mfma_f32_16x16x32_bf16 v[52:55], a[16:19], a[36:39], v[52:55]
    ds_read_b64_tr_b16 a[14:15], v213 offset:14336
    s_waitcnt vmcnt(24)
recurrent_scan__sliding_local_dilated__swiglu_ffn__prompt_kernel_o_back:
    v_cmp_eq_u32 vcc, v27, v22
    s_cmp_eq_u64 vcc, exec
    s_cbranch_scc0 recurrent_scan__sliding_local_dilated__swiglu_ffn__prompt_kernel_o_spin
recurrent_scan__sliding_local_dilated__swiglu_ffn__prompt_kernel_o_out:
    v_mfma_f32_16x16x32_bf16 v[60:63], a[24:27], a[36:39], v[60:63]
    ds_read_b64_tr_b16 a[16:17], v214 offset:2048
    ds_read_b64_tr_b16 a[18:19], v214 offset:6144
    v_mfma_f32_16x16x32_bf16 v[60:63], a[28:31], a[44:47], v[60:63]
    ds_read_b64_tr_b16 a[20:21], v214 offset:10240
    s_add_u32 s42, s42, 196608
    v_mfma_f32_16x16x32_bf16 v[56:59], a[28:31], a[40:43], v[56:59]
    v_mfma_f32_16x16x32_bf16 v[56:59], a[24:27], a[32:35], v[56:59]
    ds_read_b64_tr_b16 a[22:23], v214 offset:14336
    s_waitcnt lgkmcnt(4)
    v_mfma_f32_16x16x32_bf16 v[64:67], a[0:3], a[32:35], v[64:67]
    ds_read_b64_tr_b16 a[24:25], v215 offset:2048
    ds_read_b64_tr_b16 a[26:27], v215 offset:6144
    v_mfma_f32_16x16x32_bf16 v[64:67], a[4:7], a[40:43], v[64:67]
    ds_read_b64_tr_b16 a[28:29], v215 offset:10240
    v_mfma_f32_16x16x32_bf16 v[68:71], a[4:7], a[44:47], v[68:71]
    buffer_load_dwordx4 a[88:91], v220, s[48:51], s42 offen sc1
    v_mfma_f32_16x16x32_bf16 v[68:71], a[0:3], a[36:39], v[68:71]
    ds_read_b64_tr_b16 a[30:31], v215 offset:14336
    v_mfma_f32_16x16x32_bf16 v[76:79], a[8:11], a[36:39], v[76:79]
    ds_read_b64_tr_b16 a[0:1], v212 offset:16384
    ds_read_b64_tr_b16 a[2:3], v212 offset:20480
    v_mfma_f32_16x16x32_bf16 v[76:79], a[12:15], a[44:47], v[76:79]
    ds_read_b64_tr_b16 a[4:5], v212 offset:24576
    s_add_u32 m0, s46, 147456
    v_mfma_f32_16x16x32_bf16 v[72:75], a[12:15], a[40:43], v[72:75]
    buffer_load_dwordx4 v2, s[84:87], s92 offen offset:0 sc1 lds
    v_mfma_f32_16x16x32_bf16 v[72:75], a[8:11], a[32:35], v[72:75]
    ds_read_b64_tr_b16 a[6:7], v212 offset:28672
    s_waitcnt lgkmcnt(4)
    v_mfma_f32_16x16x32_bf16 v[80:83], a[16:19], a[32:35], v[80:83]
    ds_read_b64_tr_b16 a[8:9], v213 offset:16384
    ds_read_b64_tr_b16 a[10:11], v213 offset:20480
    v_mfma_f32_16x16x32_bf16 v[80:83], a[20:23], a[40:43], v[80:83]
    ds_read_b64_tr_b16 a[12:13], v213 offset:24576
    v_mfma_f32_16x16x32_bf16 v[84:87], a[20:23], a[44:47], v[84:87]
    buffer_load_dwordx4 a[92:95], v221, s[48:51], s42 offen sc1
    v_mfma_f32_16x16x32_bf16 v[84:87], a[16:19], a[36:39], v[84:87]
    ds_read_b64_tr_b16 a[14:15], v213 offset:28672
    v_mfma_f32_16x16x32_bf16 v[92:95], a[24:27], a[36:39], v[92:95]
    ds_read_b64_tr_b16 a[16:17], v214 offset:16384
    ds_read_b64_tr_b16 a[18:19], v214 offset:20480
    v_mfma_f32_16x16x32_bf16 v[92:95], a[28:31], a[44:47], v[92:95]
    ds_read_b64_tr_b16 a[20:21], v214 offset:24576
    s_mov_b32 s42, 22020096
    v_mfma_f32_16x16x32_bf16 v[88:91], a[28:31], a[40:43], v[88:91]
    v_mfma_f32_16x16x32_bf16 v[88:91], a[24:27], a[32:35], v[88:91]
    ds_read_b64_tr_b16 a[22:23], v214 offset:28672
    s_waitcnt vmcnt(15) lgkmcnt(4)
    v_mfma_f32_16x16x32_bf16 v[32:35], a[0:3], a[48:51], v[32:35]
    ds_read_b64_tr_b16 a[24:25], v215 offset:16384
    ds_read_b64_tr_b16 a[26:27], v215 offset:20480
    v_mfma_f32_16x16x32_bf16 v[32:35], a[4:7], a[56:59], v[32:35]
    ds_read_b64_tr_b16 a[28:29], v215 offset:24576
    v_mfma_f32_16x16x32_bf16 v[36:39], a[4:7], a[60:63], v[36:39]
    buffer_load_dwordx4 a[32:35], v220, s[48:51], s42 offen sc1
    v_mfma_f32_16x16x32_bf16 v[36:39], a[0:3], a[52:55], v[36:39]
    ds_read_b64_tr_b16 a[30:31], v215 offset:28672
    v_mfma_f32_16x16x32_bf16 v[44:47], a[8:11], a[52:55], v[44:47]
    ds_read_b64_tr_b16 a[0:1], v212 offset:18432
    ds_read_b64_tr_b16 a[2:3], v212 offset:22528
    v_mfma_f32_16x16x32_bf16 v[44:47], a[12:15], a[60:63], v[44:47]
    ds_read_b64_tr_b16 a[4:5], v212 offset:26624
    v_mfma_f32_16x16x32_bf16 v[40:43], a[12:15], a[56:59], v[40:43]
    buffer_load_dwordx4 v3, s[84:87], s92 offen offset:1024 sc1 lds
    v_mfma_f32_16x16x32_bf16 v[40:43], a[8:11], a[48:51], v[40:43]
    ds_read_b64_tr_b16 a[6:7], v212 offset:30720
    s_waitcnt lgkmcnt(4)
    v_mfma_f32_16x16x32_bf16 v[48:51], a[16:19], a[48:51], v[48:51]
    ds_read_b64_tr_b16 a[8:9], v213 offset:18432
    ds_read_b64_tr_b16 a[10:11], v213 offset:22528
    v_mfma_f32_16x16x32_bf16 v[48:51], a[20:23], a[56:59], v[48:51]
    ds_read_b64_tr_b16 a[12:13], v213 offset:26624
    s_add_u32 s92, s92, s95
    v_mfma_f32_16x16x32_bf16 v[52:55], a[20:23], a[60:63], v[52:55]
    buffer_load_dwordx4 a[36:39], v221, s[48:51], s42 offen sc1
    v_mfma_f32_16x16x32_bf16 v[52:55], a[16:19], a[52:55], v[52:55]
    ds_read_b64_tr_b16 a[14:15], v213 offset:30720
    v_mfma_f32_16x16x32_bf16 v[60:63], a[24:27], a[52:55], v[60:63]
    ds_read_b64_tr_b16 a[16:17], v214 offset:18432
    ds_read_b64_tr_b16 a[18:19], v214 offset:22528
    v_mfma_f32_16x16x32_bf16 v[60:63], a[28:31], a[60:63], v[60:63]
    ds_read_b64_tr_b16 a[20:21], v214 offset:26624
    s_add_u32 s42, s42, 196608
    v_mfma_f32_16x16x32_bf16 v[56:59], a[28:31], a[56:59], v[56:59]
    v_mfma_f32_16x16x32_bf16 v[56:59], a[24:27], a[48:51], v[56:59]
    ds_read_b64_tr_b16 a[22:23], v214 offset:30720
    s_waitcnt lgkmcnt(4)
    v_mfma_f32_16x16x32_bf16 v[64:67], a[0:3], a[48:51], v[64:67]
    ds_read_b64_tr_b16 a[24:25], v215 offset:18432
    ds_read_b64_tr_b16 a[26:27], v215 offset:22528
    v_mfma_f32_16x16x32_bf16 v[64:67], a[4:7], a[56:59], v[64:67]
    ds_read_b64_tr_b16 a[28:29], v215 offset:26624
    v_mfma_f32_16x16x32_bf16 v[68:71], a[4:7], a[60:63], v[68:71]
    buffer_load_dwordx4 a[40:43], v220, s[48:51], s42 offen sc1
    v_mfma_f32_16x16x32_bf16 v[68:71], a[0:3], a[52:55], v[68:71]
    ds_read_b64_tr_b16 a[30:31], v215 offset:30720
    v_mfma_f32_16x16x32_bf16 v[76:79], a[8:11], a[52:55], v[76:79]
    s_waitcnt vmcnt(13)
    s_barrier
    ds_read_b64_tr_b16 a[0:1], v212 offset:32768
    ds_read_b64_tr_b16 a[2:3], v212 offset:36864
    v_mfma_f32_16x16x32_bf16 v[76:79], a[12:15], a[60:63], v[76:79]
    ds_read_b64_tr_b16 a[4:5], v212 offset:40960
    s_add_u32 m0, s46, 0
    v_mfma_f32_16x16x32_bf16 v[72:75], a[12:15], a[56:59], v[72:75]
    buffer_load_dwordx4 v2, s[84:87], s92 offen offset:0 sc1 lds
    v_mfma_f32_16x16x32_bf16 v[72:75], a[8:11], a[48:51], v[72:75]
    ds_read_b64_tr_b16 a[6:7], v212 offset:45056
    s_waitcnt lgkmcnt(4)
    v_mfma_f32_16x16x32_bf16 v[80:83], a[16:19], a[48:51], v[80:83]
    ds_read_b64_tr_b16 a[8:9], v213 offset:32768
    ds_read_b64_tr_b16 a[10:11], v213 offset:36864
    v_mfma_f32_16x16x32_bf16 v[80:83], a[20:23], a[56:59], v[80:83]
    ds_read_b64_tr_b16 a[12:13], v213 offset:40960
    v_mfma_f32_16x16x32_bf16 v[84:87], a[20:23], a[60:63], v[84:87]
    buffer_load_dwordx4 a[44:47], v221, s[48:51], s42 offen sc1
    v_mfma_f32_16x16x32_bf16 v[84:87], a[16:19], a[52:55], v[84:87]
    ds_read_b64_tr_b16 a[14:15], v213 offset:45056
    v_mfma_f32_16x16x32_bf16 v[92:95], a[24:27], a[52:55], v[92:95]
    ds_read_b64_tr_b16 a[16:17], v214 offset:32768
    ds_read_b64_tr_b16 a[18:19], v214 offset:36864
    v_mfma_f32_16x16x32_bf16 v[92:95], a[28:31], a[60:63], v[92:95]
    ds_read_b64_tr_b16 a[20:21], v214 offset:40960
    s_add_u32 s42, s42, 196608
    v_mfma_f32_16x16x32_bf16 v[88:91], a[28:31], a[56:59], v[88:91]
    v_mfma_f32_16x16x32_bf16 v[88:91], a[24:27], a[48:51], v[88:91]
    ds_read_b64_tr_b16 a[22:23], v214 offset:45056
    s_waitcnt vmcnt(12) lgkmcnt(4)
    v_mfma_f32_16x16x32_bf16 v[32:35], a[0:3], a[64:67], v[32:35]
    ds_read_b64_tr_b16 a[24:25], v215 offset:32768
    ds_read_b64_tr_b16 a[26:27], v215 offset:36864
    v_mfma_f32_16x16x32_bf16 v[32:35], a[4:7], a[72:75], v[32:35]
    ds_read_b64_tr_b16 a[28:29], v215 offset:40960
    v_mfma_f32_16x16x32_bf16 v[36:39], a[4:7], a[76:79], v[36:39]
    buffer_load_dwordx4 a[48:51], v220, s[48:51], s42 offen sc1
    v_mfma_f32_16x16x32_bf16 v[36:39], a[0:3], a[68:71], v[36:39]
    ds_read_b64_tr_b16 a[30:31], v215 offset:45056
    v_mfma_f32_16x16x32_bf16 v[44:47], a[8:11], a[68:71], v[44:47]
    ds_read_b64_tr_b16 a[0:1], v212 offset:34816
    ds_read_b64_tr_b16 a[2:3], v212 offset:38912
    v_mfma_f32_16x16x32_bf16 v[44:47], a[12:15], a[76:79], v[44:47]
    ds_read_b64_tr_b16 a[4:5], v212 offset:43008
    v_mfma_f32_16x16x32_bf16 v[40:43], a[12:15], a[72:75], v[40:43]
    buffer_load_dwordx4 v3, s[84:87], s92 offen offset:1024 sc1 lds
    v_mfma_f32_16x16x32_bf16 v[40:43], a[8:11], a[64:67], v[40:43]
    ds_read_b64_tr_b16 a[6:7], v212 offset:47104
    s_waitcnt lgkmcnt(4)
    v_mfma_f32_16x16x32_bf16 v[48:51], a[16:19], a[64:67], v[48:51]
    ds_read_b64_tr_b16 a[8:9], v213 offset:34816
    ds_read_b64_tr_b16 a[10:11], v213 offset:38912
    v_mfma_f32_16x16x32_bf16 v[48:51], a[20:23], a[72:75], v[48:51]
    ds_read_b64_tr_b16 a[12:13], v213 offset:43008
    s_add_u32 s92, s92, s95
    v_mfma_f32_16x16x32_bf16 v[52:55], a[20:23], a[76:79], v[52:55]
    buffer_load_dwordx4 a[52:55], v221, s[48:51], s42 offen sc1
    v_mfma_f32_16x16x32_bf16 v[52:55], a[16:19], a[68:71], v[52:55]
    ds_read_b64_tr_b16 a[14:15], v213 offset:47104
    v_mfma_f32_16x16x32_bf16 v[60:63], a[24:27], a[68:71], v[60:63]
    ds_read_b64_tr_b16 a[16:17], v214 offset:34816
    ds_read_b64_tr_b16 a[18:19], v214 offset:38912
    v_mfma_f32_16x16x32_bf16 v[60:63], a[28:31], a[76:79], v[60:63]
    ds_read_b64_tr_b16 a[20:21], v214 offset:43008
    s_add_u32 s42, s42, 196608
    v_mfma_f32_16x16x32_bf16 v[56:59], a[28:31], a[72:75], v[56:59]
    v_mfma_f32_16x16x32_bf16 v[56:59], a[24:27], a[64:67], v[56:59]
    ds_read_b64_tr_b16 a[22:23], v214 offset:47104
    s_waitcnt lgkmcnt(4)
    v_mfma_f32_16x16x32_bf16 v[64:67], a[0:3], a[64:67], v[64:67]
    ds_read_b64_tr_b16 a[24:25], v215 offset:34816
    ds_read_b64_tr_b16 a[26:27], v215 offset:38912
    v_mfma_f32_16x16x32_bf16 v[64:67], a[4:7], a[72:75], v[64:67]
    ds_read_b64_tr_b16 a[28:29], v215 offset:43008
    v_mfma_f32_16x16x32_bf16 v[68:71], a[4:7], a[76:79], v[68:71]
    buffer_load_dwordx4 a[56:59], v220, s[48:51], s42 offen sc1
    v_mfma_f32_16x16x32_bf16 v[68:71], a[0:3], a[68:71], v[68:71]
    ds_read_b64_tr_b16 a[30:31], v215 offset:47104
    v_mfma_f32_16x16x32_bf16 v[76:79], a[8:11], a[68:71], v[76:79]
    ds_read_b64_tr_b16 a[0:1], v212 offset:49152
    ds_read_b64_tr_b16 a[2:3], v212 offset:53248
    v_mfma_f32_16x16x32_bf16 v[76:79], a[12:15], a[76:79], v[76:79]
    ds_read_b64_tr_b16 a[4:5], v212 offset:57344
    s_add_u32 m0, s46, 16384
    v_mfma_f32_16x16x32_bf16 v[72:75], a[12:15], a[72:75], v[72:75]
    buffer_load_dwordx4 v2, s[84:87], s92 offen offset:0 sc1 lds
    v_mfma_f32_16x16x32_bf16 v[72:75], a[8:11], a[64:67], v[72:75]
    ds_read_b64_tr_b16 a[6:7], v212 offset:61440
    s_waitcnt lgkmcnt(4)
    v_mfma_f32_16x16x32_bf16 v[80:83], a[16:19], a[64:67], v[80:83]
    ds_read_b64_tr_b16 a[8:9], v213 offset:49152
    ds_read_b64_tr_b16 a[10:11], v213 offset:53248
    v_mfma_f32_16x16x32_bf16 v[80:83], a[20:23], a[72:75], v[80:83]
    ds_read_b64_tr_b16 a[12:13], v213 offset:57344
    v_mfma_f32_16x16x32_bf16 v[84:87], a[20:23], a[76:79], v[84:87]
recurrent_scan__sliding_local_dilated__swiglu_ffn__prompt_kernel_w10:
    s_cbranch_execz recurrent_scan__sliding_local_dilated__swiglu_ffn__prompt_kernel_wret0
    buffer_load_dwordx4 a[60:63], v221, s[48:51], s42 offen sc1
    v_mfma_f32_16x16x32_bf16 v[84:87], a[16:19], a[68:71], v[84:87]
    ds_read_b64_tr_b16 a[14:15], v213 offset:61440
    v_mfma_f32_16x16x32_bf16 v[92:95], a[24:27], a[68:71], v[92:95]
    ds_read_b64_tr_b16 a[16:17], v214 offset:49152
    ds_read_b64_tr_b16 a[18:19], v214 offset:53248
    v_mfma_f32_16x16x32_bf16 v[92:95], a[28:31], a[76:79], v[92:95]
    ds_read_b64_tr_b16 a[20:21], v214 offset:57344
    s_add_u32 s42, s42, 196608
    v_mfma_f32_16x16x32_bf16 v[88:91], a[28:31], a[72:75], v[88:91]
    v_mfma_f32_16x16x32_bf16 v[88:91], a[24:27], a[64:67], v[88:91]
    ds_read_b64_tr_b16 a[22:23], v214 offset:61440
    s_waitcnt vmcnt(12) lgkmcnt(4)
    v_mfma_f32_16x16x32_bf16 v[32:35], a[0:3], a[80:83], v[32:35]
    ds_read_b64_tr_b16 a[24:25], v215 offset:49152
    ds_read_b64_tr_b16 a[26:27], v215 offset:53248
    v_mfma_f32_16x16x32_bf16 v[32:35], a[4:7], a[88:91], v[32:35]
    ds_read_b64_tr_b16 a[28:29], v215 offset:57344
    v_mfma_f32_16x16x32_bf16 v[36:39], a[4:7], a[92:95], v[36:39]
    buffer_load_dwordx4 a[64:67], v220, s[48:51], s42 offen sc1
    v_mfma_f32_16x16x32_bf16 v[36:39], a[0:3], a[84:87], v[36:39]
    ds_read_b64_tr_b16 a[30:31], v215 offset:61440
    v_mfma_f32_16x16x32_bf16 v[44:47], a[8:11], a[84:87], v[44:47]
    ds_read_b64_tr_b16 a[0:1], v212 offset:51200
    ds_read_b64_tr_b16 a[2:3], v212 offset:55296
    v_mfma_f32_16x16x32_bf16 v[44:47], a[12:15], a[92:95], v[44:47]
    ds_read_b64_tr_b16 a[4:5], v212 offset:59392
    v_mfma_f32_16x16x32_bf16 v[40:43], a[12:15], a[88:91], v[40:43]
    buffer_load_dwordx4 v3, s[84:87], s92 offen offset:1024 sc1 lds
    v_mfma_f32_16x16x32_bf16 v[40:43], a[8:11], a[80:83], v[40:43]
    ds_read_b64_tr_b16 a[6:7], v212 offset:63488
    s_waitcnt lgkmcnt(4)
    v_mfma_f32_16x16x32_bf16 v[48:51], a[16:19], a[80:83], v[48:51]
    ds_read_b64_tr_b16 a[8:9], v213 offset:51200
    ds_read_b64_tr_b16 a[10:11], v213 offset:55296
    v_mfma_f32_16x16x32_bf16 v[48:51], a[20:23], a[88:91], v[48:51]
    ds_read_b64_tr_b16 a[12:13], v213 offset:59392
    s_add_u32 s92, s92, s95
    v_mfma_f32_16x16x32_bf16 v[52:55], a[20:23], a[92:95], v[52:55]
    buffer_load_dwordx4 a[68:71], v221, s[48:51], s42 offen sc1
    v_mfma_f32_16x16x32_bf16 v[52:55], a[16:19], a[84:87], v[52:55]
    ds_read_b64_tr_b16 a[14:15], v213 offset:63488
    v_mfma_f32_16x16x32_bf16 v[60:63], a[24:27], a[84:87], v[60:63]
    ds_read_b64_tr_b16 a[16:17], v214 offset:51200
    ds_read_b64_tr_b16 a[18:19], v214 offset:55296
    v_mfma_f32_16x16x32_bf16 v[60:63], a[28:31], a[92:95], v[60:63]
    ds_read_b64_tr_b16 a[20:21], v214 offset:59392
    s_add_u32 s42, s42, 196608
    v_mfma_f32_16x16x32_bf16 v[56:59], a[28:31], a[88:91], v[56:59]
    v_mfma_f32_16x16x32_bf16 v[56:59], a[24:27], a[80:83], v[56:59]
    ds_read_b64_tr_b16 a[22:23], v214 offset:63488
    s_waitcnt lgkmcnt(4)
    v_mfma_f32_16x16x32_bf16 v[64:67], a[0:3], a[80:83], v[64:67]
    ds_read_b64_tr_b16 a[24:25], v215 offset:51200
    ds_read_b64_tr_b16 a[26:27], v215 offset:55296
    v_mfma_f32_16x16x32_bf16 v[64:67], a[4:7], a[88:91], v[64:67]
    ds_read_b64_tr_b16 a[28:29], v215 offset:59392
    v_mfma_f32_16x16x32_bf16 v[68:71], a[4:7], a[92:95], v[68:71]
    buffer_load_dwordx4 a[72:75], v220, s[48:51], s42 offen sc1
    v_mfma_f32_16x16x32_bf16 v[68:71], a[0:3], a[84:87], v[68:71]
    ds_read_b64_tr_b16 a[30:31], v215 offset:63488
    v_mfma_f32_16x16x32_bf16 v[76:79], a[8:11], a[84:87], v[76:79]
    s_waitcnt vmcnt(14)
    s_barrier
    ds_read_b64_tr_b16 a[0:1], v216 offset:0
    ds_read_b64_tr_b16 a[2:3], v216 offset:4096
    v_mfma_f32_16x16x32_bf16 v[76:79], a[12:15], a[92:95], v[76:79]
    ds_read_b64_tr_b16 a[4:5], v216 offset:8192
    s_add_u32 m0, s46, 32768
    v_mfma_f32_16x16x32_bf16 v[72:75], a[12:15], a[88:91], v[72:75]
    buffer_load_dwordx4 v2, s[84:87], s92 offen offset:0 sc1 lds
    v_mfma_f32_16x16x32_bf16 v[72:75], a[8:11], a[80:83], v[72:75]
    ds_read_b64_tr_b16 a[6:7], v216 offset:12288
    s_waitcnt lgkmcnt(4)
    v_mfma_f32_16x16x32_bf16 v[80:83], a[16:19], a[80:83], v[80:83]
    ds_read_b64_tr_b16 a[8:9], v217 offset:0
    ds_read_b64_tr_b16 a[10:11], v217 offset:4096
    v_mfma_f32_16x16x32_bf16 v[80:83], a[20:23], a[88:91], v[80:83]
    ds_read_b64_tr_b16 a[12:13], v217 offset:8192
    v_mfma_f32_16x16x32_bf16 v[84:87], a[20:23], a[92:95], v[84:87]
    buffer_load_dwordx4 a[76:79], v221, s[48:51], s42 offen sc1
    v_mfma_f32_16x16x32_bf16 v[84:87], a[16:19], a[84:87], v[84:87]
    ds_read_b64_tr_b16 a[14:15], v217 offset:12288
    v_mfma_f32_16x16x32_bf16 v[92:95], a[24:27], a[84:87], v[92:95]
    ds_read_b64_tr_b16 a[16:17], v218 offset:0
    ds_read_b64_tr_b16 a[18:19], v218 offset:4096
    v_mfma_f32_16x16x32_bf16 v[92:95], a[28:31], a[92:95], v[92:95]
    ds_read_b64_tr_b16 a[20:21], v218 offset:8192
    s_add_u32 s42, s42, 196608
    v_mfma_f32_16x16x32_bf16 v[88:91], a[28:31], a[88:91], v[88:91]
    buffer_load_dwordx4 v3, s[84:87], s92 offen offset:1024 sc1 lds
    v_mfma_f32_16x16x32_bf16 v[88:91], a[24:27], a[80:83], v[88:91]
    ds_read_b64_tr_b16 a[22:23], v218 offset:12288
    s_waitcnt vmcnt(13) lgkmcnt(4)
    v_mfma_f32_16x16x32_bf16 v[96:99], a[0:3], a[32:35], 0
    ds_read_b64_tr_b16 a[24:25], v219 offset:0
    ds_read_b64_tr_b16 a[26:27], v219 offset:4096
    v_mfma_f32_16x16x32_bf16 v[96:99], a[4:7], a[40:43], v[96:99]
    ds_read_b64_tr_b16 a[28:29], v219 offset:8192
    s_add_u32 s92, s92, s95
    v_mfma_f32_16x16x32_bf16 v[100:103], a[4:7], a[44:47], 0
    buffer_load_dwordx4 a[80:83], v220, s[48:51], s42 offen sc1
    v_mfma_f32_16x16x32_bf16 v[100:103], a[0:3], a[36:39], v[100:103]
    ds_read_b64_tr_b16 a[30:31], v219 offset:12288
    v_mfma_f32_16x16x32_bf16 v[108:111], a[8:11], a[36:39], 0
    ds_read_b64_tr_b16 a[0:1], v216 offset:16384
    ds_read_b64_tr_b16 a[2:3], v216 offset:20480
    v_mfma_f32_16x16x32_bf16 v[108:111], a[12:15], a[44:47], v[108:111]
    ds_read_b64_tr_b16 a[4:5], v216 offset:24576
    v_mfma_f32_16x16x32_bf16 v[104:107], a[12:15], a[40:43], 0
    buffer_load_dwordx4 a[84:87], v221, s[48:51], s42 offen sc1
    s_add_u32 m0, s46, 49152
    v_mfma_f32_16x16x32_bf16 v[104:107], a[8:11], a[32:35], v[104:107]
    ds_read_b64_tr_b16 a[6:7], v216 offset:28672
    s_add_u32 s42, s42, 196608
    buffer_load_dwordx4 v2, s[84:87], s92 offen offset:0 sc1 lds
    s_waitcnt lgkmcnt(4)
    v_mfma_f32_16x16x32_bf16 v[112:115], a[16:19], a[32:35], 0
    ds_read_b64_tr_b16 a[8:9], v217 offset:16384
    ds_read_b64_tr_b16 a[10:11], v217 offset:20480
    v_max3_f32 v21, |v64|, |v65|, |v66|
    v_max3_f32 v26, |v67|, |v68|, |v69|
    v_mfma_f32_16x16x32_bf16 v[112:115], a[20:23], a[40:43], v[112:115]
    ds_read_b64_tr_b16 a[12:13], v217 offset:24576
    v_max3_f32 v21, |v70|, |v71|, v21
    v_max3_f32 v26, |v72|, |v73|, v26
    v_mfma_f32_16x16x32_bf16 v[116:119], a[20:23], a[44:47], 0
    buffer_load_dwordx4 a[88:91], v220, s[48:51], s42 offen sc1
    v_max3_f32 v21, |v74|, |v75|, v21
    v_max3_f32 v26, |v76|, |v77|, v26
    v_mfma_f32_16x16x32_bf16 v[116:119], a[16:19], a[36:39], v[116:119]
    ds_read_b64_tr_b16 a[14:15], v217 offset:28672
    v_max3_f32 v21, |v78|, |v79|, v21
    v_max3_f32 v26, |v80|, |v81|, v26
    v_mfma_f32_16x16x32_bf16 v[124:127], a[24:27], a[36:39], 0
    ds_read_b64_tr_b16 a[16:17], v218 offset:16384
    ds_read_b64_tr_b16 a[18:19], v218 offset:20480
    v_max3_f32 v21, |v82|, |v83|, v21
    v_max3_f32 v26, |v84|, |v85|, v26
    v_mfma_f32_16x16x32_bf16 v[124:127], a[28:31], a[44:47], v[124:127]
    ds_read_b64_tr_b16 a[20:21], v218 offset:24576
    v_max3_f32 v21, |v86|, |v87|, v21
    v_max3_f32 v26, |v88|, |v89|, v26
    v_mfma_f32_16x16x32_bf16 v[120:123], a[28:31], a[40:43], 0
    buffer_load_dwordx4 a[92:95], v221, s[48:51], s42 offen sc1
    v_max3_f32 v21, |v90|, |v91|, v21
    v_max3_f32 v26, |v92|, |v93|, v26
    v_mfma_f32_16x16x32_bf16 v[120:123], a[24:27], a[32:35], v[120:123]
    ds_read_b64_tr_b16 a[22:23], v218 offset:28672
    s_add_u32 s42, s42, 196608
    buffer_load_dwordx4 v3, s[84:87], s92 offen offset:1024 sc1 lds
    v_max3_f32 v21, |v94|, |v95|, v21
    v_max_f32 v21, v21, v26
    s_waitcnt vmcnt(13) lgkmcnt(4)
    v_mfma_f32_16x16x32_bf16 v[96:99], a[0:3], a[48:51], v[96:99]
    ds_read_b64_tr_b16 a[24:25], v219 offset:16384
    ds_read_b64_tr_b16 a[26:27], v219 offset:20480
    v_frexp_exp_i32_f32 v21, v21
    v_max_i32 v21, 0xffffff9c, v21
    v_mfma_f32_16x16x32_bf16 v[96:99], a[4:7], a[56:59], v[96:99]
    ds_read_b64_tr_b16 a[28:29], v219 offset:24576
    s_add_u32 s92, s92, s95
    v_sub_u32 v26, 15, v21
    v_ldexp_f32 v26, 1.0, v26
    v_mfma_f32_16x16x32_bf16 v[100:103], a[4:7], a[60:63], v[100:103]
    buffer_load_dwordx4 a[32:35], v220, s[48:51], s42 offen sc1
    v_subrev_u32 v21, 15, v21
    v_ldexp_f32 v21, 1.0, v21
    v_mfma_f32_16x16x32_bf16 v[100:103], a[0:3], a[52:55], v[100:103]
    ds_read_b64_tr_b16 a[30:31], v219 offset:28672
    v_fma_mixlo_f16 v176, v64, v26, 0
    v_fma_mixlo_f16 v177, v66, v26, 0
    v_mfma_f32_16x16x32_bf16 v[108:111], a[8:11], a[52:55], v[108:111]
    s_waitcnt vmcnt(12)
    s_barrier
    ds_read_b64_tr_b16 a[0:1], v208 offset:0
    ds_read_b64_tr_b16 a[2:3], v208 offset:4096
    v_fma_mixlo_f16 v178, v68, v26, 0
    v_fma_mixlo_f16 v179, v70, v26, 0
    v_mfma_f32_16x16x32_bf16 v[108:111], a[12:15], a[60:63], v[108:111]
    ds_read_b64_tr_b16 a[4:5], v208 offset:8192
    v_fma_mixhi_f16 v176, v65, v26, 0
    v_fma_mixhi_f16 v177, v67, v26, 0
    v_mfma_f32_16x16x32_bf16 v[104:107], a[12:15], a[56:59], v[104:107]
    buffer_load_dwordx4 a[36:39], v221, s[48:51], s42 offen sc1
    s_add_u32 m0, s46, 65536
    v_fma_mixhi_f16 v178, v69, v26, 0
    v_fma_mixhi_f16 v179, v71, v26, 0
    v_mfma_f32_16x16x32_bf16 v[104:107], a[8:11], a[48:51], v[104:107]
    ds_read_b64_tr_b16 a[6:7], v208 offset:12288
    s_add_u32 s42, s42, 196608
    buffer_load_dwordx4 v2, s[84:87], s92 offen offset:0 sc1 lds
    s_nop 0
    buffer_store_dwordx4 v[176:179], v224, s[8:11], s70 offen offset:0 sc0 sc1
    s_waitcnt lgkmcnt(4)
    v_mfma_f32_16x16x32_bf16 v[112:115], a[16:19], a[48:51], v[112:115]
    ds_read_b64_tr_b16 a[8:9], v209 offset:0
    ds_read_b64_tr_b16 a[10:11], v209 offset:4096
    v_fma_mixlo_f16 v180, v72, v26, 0
    v_fma_mixlo_f16 v181, v74, v26, 0
    v_mfma_f32_16x16x32_bf16 v[112:115], a[20:23], a[56:59], v[112:115]
    ds_read_b64_tr_b16 a[12:13], v209 offset:8192
    v_fma_mixlo_f16 v182, v76, v26, 0
    v_fma_mixlo_f16 v183, v78, v26, 0
    v_mfma_f32_16x16x32_bf16 v[116:119], a[20:23], a[60:63], v[116:119]
    buffer_load_dwordx4 a[40:43], v220, s[48:51], s42 offen sc1
    v_fma_mixhi_f16 v180, v73, v26, 0
    v_fma_mixhi_f16 v181, v75, v26, 0
    v_mfma_f32_16x16x32_bf16 v[116:119], a[16:19], a[52:55], v[116:119]
    ds_read_b64_tr_b16 a[14:15], v209 offset:12288
    v_fma_mixhi_f16 v182, v77, v26, 0
    v_fma_mixhi_f16 v183, v79, v26, 0
    v_mfma_f32_16x16x32_bf16 v[124:127], a[24:27], a[52:55], v[124:127]
    ds_read_b64_tr_b16 a[16:17], v210 offset:0
    ds_read_b64_tr_b16 a[18:19], v210 offset:4096
    s_nop 0
    buffer_store_dwordx4 v[180:183], v225, s[8:11], s70 offen offset:0 sc0 sc1
    v_mfma_f32_16x16x32_bf16 v[124:127], a[28:31], a[60:63], v[124:127]
    ds_read_b64_tr_b16 a[20:21], v210 offset:8192
    v_fma_mixlo_f16 v184, v80, v26, 0
    v_fma_mixlo_f16 v185, v82, v26, 0
    v_mfma_f32_16x16x32_bf16 v[120:123], a[28:31], a[56:59], v[120:123]
    buffer_load_dwordx4 a[44:47], v221, s[48:51], s42 offen sc1
    v_fma_mixlo_f16 v186, v84, v26, 0
    v_fma_mixlo_f16 v187, v86, v26, 0
    v_mfma_f32_16x16x32_bf16 v[120:123], a[24:27], a[48:51], v[120:123]
    ds_read_b64_tr_b16 a[22:23], v210 offset:12288
    s_add_u32 s42, s42, 196608
    buffer_load_dwordx4 v3, s[84:87], s92 offen offset:1024 sc1 lds
    v_fma_mixhi_f16 v184, v81, v26, 0
    v_fma_mixhi_f16 v185, v83, v26, 0
    s_waitcnt vmcnt(15) lgkmcnt(4)
    v_mfma_f32_16x16x32_bf16 v[96:99], a[0:3], a[64:67], v[96:99]
    ds_read_b64_tr_b16 a[24:25], v211 offset:0
    ds_read_b64_tr_b16 a[26:27], v211 offset:4096
    v_fma_mixhi_f16 v186, v85, v26, 0
    v_fma_mixhi_f16 v187, v87, v26, 0
    v_mfma_f32_16x16x32_bf16 v[96:99], a[4:7], a[72:75], v[96:99]
    ds_read_b64_tr_b16 a[28:29], v211 offset:8192
    s_add_u32 s92, s92, s95
    s_nop 0
    buffer_store_dwordx4 v[184:187], v224, s[8:11], s70 offen offset:3072 sc0 sc1
    v_mfma_f32_16x16x32_bf16 v[100:103], a[4:7], a[76:79], v[100:103]
    buffer_load_dwordx4 a[48:51], v220, s[48:51], s42 offen sc1
    v_fma_mixlo_f16 v188, v88, v26, 0
    v_fma_mixlo_f16 v189, v90, v26, 0
    v_mfma_f32_16x16x32_bf16 v[100:103], a[0:3], a[68:71], v[100:103]
    ds_read_b64_tr_b16 a[30:31], v211 offset:12288
    v_fma_mixlo_f16 v190, v92, v26, 0
    v_fma_mixlo_f16 v191, v94, v26, 0
    v_mfma_f32_16x16x32_bf16 v[108:111], a[8:11], a[68:71], v[108:111]
    ds_read_b64_tr_b16 a[0:1], v208 offset:16384
    ds_read_b64_tr_b16 a[2:3], v208 offset:20480
    v_fma_mixhi_f16 v188, v89, v26, 0
    v_fma_mixhi_f16 v189, v91, v26, 0
    v_mfma_f32_16x16x32_bf16 v[108:111], a[12:15], a[76:79], v[108:111]
    ds_read_b64_tr_b16 a[4:5], v208 offset:24576
    v_fma_mixhi_f16 v190, v93, v26, 0
    v_fma_mixhi_f16 v191, v95, v26, 0
    v_mfma_f32_16x16x32_bf16 v[104:107], a[12:15], a[72:75], v[104:107]
    buffer_load_dwordx4 a[52:55], v221, s[48:51], s42 offen sc1
    s_add_u32 m0, s46, 81920
    s_nop 0
    buffer_store_dwordx4 v[188:191], v225, s[8:11], s70 offen offset:3072 sc0 sc1
    v_mfma_f32_16x16x32_bf16 v[104:107], a[8:11], a[64:67], v[104:107]
    ds_read_b64_tr_b16 a[6:7], v208 offset:28672
    s_add_u32 s42, s42, 196608
    buffer_load_dwordx4 v2, s[84:87], s92 offen offset:0 sc1 lds
    s_waitcnt lgkmcnt(4)
    v_mfma_f32_16x16x32_bf16 v[112:115], a[16:19], a[64:67], v[112:115]
    ds_read_b64_tr_b16 a[8:9], v209 offset:16384
    ds_read_b64_tr_b16 a[10:11], v209 offset:20480
    v_mfma_f32_16x16x32_bf16 v[112:115], a[20:23], a[72:75], v[112:115]
    ds_read_b64_tr_b16 a[12:13], v209 offset:24576
    v_mfma_f32_16x16x32_bf16 v[116:119], a[20:23], a[76:79], v[116:119]
    buffer_load_dwordx4 a[56:59], v220, s[48:51], s42 offen sc1
    v_mfma_f32_16x16x32_bf16 v[116:119], a[16:19], a[68:71], v[116:119]
    ds_read_b64_tr_b16 a[14:15], v209 offset:28672
    v_mfma_f32_16x16x32_bf16 v[124:127], a[24:27], a[68:71], v[124:127]
    ds_read_b64_tr_b16 a[16:17], v210 offset:16384
    ds_read_b64_tr_b16 a[18:19], v210 offset:20480
    v_mfma_f32_16x16x32_bf16 v[124:127], a[28:31], a[76:79], v[124:127]
    ds_read_b64_tr_b16 a[20:21], v210 offset:24576
    v_mfma_f32_16x16x32_bf16 v[120:123], a[28:31], a[72:75], v[120:123]
    buffer_load_dwordx4 a[60:63], v221, s[48:51], s42 offen sc1
    v_mfma_f32_16x16x32_bf16 v[120:123], a[24:27], a[64:67], v[120:123]
    ds_read_b64_tr_b16 a[22:23], v210 offset:28672
    s_add_u32 s42, s42, 196608
    buffer_load_dwordx4 v3, s[84:87], s92 offen offset:1024 sc1 lds
    s_waitcnt vmcnt(17) lgkmcnt(4)
    v_mfma_f32_16x16x32_bf16 v[96:99], a[0:3], a[80:83], v[96:99]
    ds_read_b64_tr_b16 a[24:25], v211 offset:16384
    ds_read_b64_tr_b16 a[26:27], v211 offset:20480
    v_mfma_f32_16x16x32_bf16 v[96:99], a[4:7], a[88:91], v[96:99]
    ds_read_b64_tr_b16 a[28:29], v211 offset:24576
    s_add_u32 s92, s92, s95
    v_mfma_f32_16x16x32_bf16 v[100:103], a[4:7], a[92:95], v[100:103]
    buffer_load_dwordx4 a[64:67], v220, s[48:51], s42 offen sc1
    v_mfma_f32_16x16x32_bf16 v[100:103], a[0:3], a[84:87], v[100:103]
    ds_read_b64_tr_b16 a[30:31], v211 offset:28672
    v_mfma_f32_16x16x32_bf16 v[108:111], a[8:11], a[84:87], v[108:111]
    s_waitcnt vmcnt(17)
    s_barrier
    ds_read_b64_tr_b16 a[0:1], v208 offset:32768
    ds_read_b64_tr_b16 a[2:3], v208 offset:36864
    v_mfma_f32_16x16x32_bf16 v[108:111], a[12:15], a[92:95], v[108:111]
    ds_read_b64_tr_b16 a[4:5], v208 offset:40960
    v_mfma_f32_16x16x32_bf16 v[104:107], a[12:15], a[88:91], v[104:107]
    buffer_load_dwordx4 a[68:71], v221, s[48:51], s42 offen sc1
    s_add_u32 m0, s46, 98304
    v_mfma_f32_16x16x32_bf16 v[104:107], a[8:11], a[80:83], v[104:107]
    ds_read_b64_tr_b16 a[6:7], v208 offset:45056
    s_add_u32 s42, s42, 196608
    buffer_load_dwordx4 v2, s[84:87], s92 offen offset:0 sc1 lds
    s_waitcnt lgkmcnt(4)
    v_mfma_f32_16x16x32_bf16 v[112:115], a[16:19], a[80:83], v[112:115]
    ds_read_b64_tr_b16 a[8:9], v209 offset:32768
    ds_read_b64_tr_b16 a[10:11], v209 offset:36864
    v_mfma_f32_16x16x32_bf16 v[112:115], a[20:23], a[88:91], v[112:115]
    ds_read_b64_tr_b16 a[12:13], v209 offset:40960
    v_mfma_f32_16x16x32_bf16 v[116:119], a[20:23], a[92:95], v[116:119]
    buffer_load_dwordx4 a[72:75], v220, s[48:51], s42 offen sc1
    v_mfma_f32_16x16x32_bf16 v[116:119], a[16:19], a[84:87], v[116:119]
    ds_read_b64_tr_b16 a[14:15], v209 offset:45056
    v_mfma_f32_16x16x32_bf16 v[124:127], a[24:27], a[84:87], v[124:127]
    ds_read_b64_tr_b16 a[16:17], v210 offset:32768
    ds_read_b64_tr_b16 a[18:19], v210 offset:36864
    v_mfma_f32_16x16x32_bf16 v[124:127], a[28:31], a[92:95], v[124:127]
    ds_read_b64_tr_b16 a[20:21], v210 offset:40960
    v_mfma_f32_16x16x32_bf16 v[120:123], a[28:31], a[88:91], v[120:123]
    buffer_load_dwordx4 a[76:79], v221, s[48:51], s42 offen sc1
    v_mfma_f32_16x16x32_bf16 v[120:123], a[24:27], a[80:83], v[120:123]
    ds_read_b64_tr_b16 a[22:23], v210 offset:45056
    s_add_u32 s42, s42, 196608
    buffer_load_dwordx4 v3, s[84:87], s92 offen offset:1024 sc1 lds
    s_waitcnt vmcnt(15) lgkmcnt(4)
    v_mfma_f32_16x16x32_bf16 v[96:99], a[0:3], a[32:35], v[96:99]
    ds_read_b64_tr_b16 a[24:25], v211 offset:32768
    ds_read_b64_tr_b16 a[26:27], v211 offset:36864
    v_mfma_f32_16x16x32_bf16 v[96:99], a[4:7], a[40:43], v[96:99]
    ds_read_b64_tr_b16 a[28:29], v211 offset:40960
    s_add_u32 s92, s92, s95
    v_mfma_f32_16x16x32_bf16 v[100:103], a[4:7], a[44:47], v[100:103]
    buffer_load_dwordx4 a[80:83], v220, s[48:51], s42 offen sc1
    v_mfma_f32_16x16x32_bf16 v[100:103], a[0:3], a[36:39], v[100:103]
    ds_read_b64_tr_b16 a[30:31], v211 offset:45056
    v_mfma_f32_16x16x32_bf16 v[108:111], a[8:11], a[36:39], v[108:111]
    ds_read_b64_tr_b16 a[0:1], v208 offset:49152
    ds_read_b64_tr_b16 a[2:3], v208 offset:53248
    v_mfma_f32_16x16x32_bf16 v[108:111], a[12:15], a[44:47], v[108:111]
    ds_read_b64_tr_b16 a[4:5], v208 offset:57344
    v_mfma_f32_16x16x32_bf16 v[104:107], a[12:15], a[40:43], v[104:107]
    buffer_load_dwordx4 a[84:87], v221, s[48:51], s42 offen sc1
    s_add_u32 m0, s46, 114688
    v_mfma_f32_16x16x32_bf16 v[104:107], a[8:11], a[32:35], v[104:107]
    ds_read_b64_tr_b16 a[6:7], v208 offset:61440
    s_add_u32 s42, s42, 196608
    buffer_load_dwordx4 v2, s[84:87], s92 offen offset:0 sc1 lds
    s_waitcnt lgkmcnt(4)
    v_mfma_f32_16x16x32_bf16 v[112:115], a[16:19], a[32:35], v[112:115]
    ds_read_b64_tr_b16 a[8:9], v209 offset:49152
    ds_read_b64_tr_b16 a[10:11], v209 offset:53248
    v_mfma_f32_16x16x32_bf16 v[112:115], a[20:23], a[40:43], v[112:115]
    ds_read_b64_tr_b16 a[12:13], v209 offset:57344
    v_mfma_f32_16x16x32_bf16 v[116:119], a[20:23], a[44:47], v[116:119]
    buffer_load_dwordx4 a[88:91], v220, s[48:51], s42 offen sc1
    v_mfma_f32_16x16x32_bf16 v[116:119], a[16:19], a[36:39], v[116:119]
    ds_read_b64_tr_b16 a[14:15], v209 offset:61440
    v_mfma_f32_16x16x32_bf16 v[124:127], a[24:27], a[36:39], v[124:127]
    ds_read_b64_tr_b16 a[16:17], v210 offset:49152
    ds_read_b64_tr_b16 a[18:19], v210 offset:53248
    v_mfma_f32_16x16x32_bf16 v[124:127], a[28:31], a[44:47], v[124:127]
    ds_read_b64_tr_b16 a[20:21], v210 offset:57344
    v_mfma_f32_16x16x32_bf16 v[120:123], a[28:31], a[40:43], v[120:123]
    buffer_load_dwordx4 a[92:95], v221, s[48:51], s42 offen sc1
    v_mfma_f32_16x16x32_bf16 v[120:123], a[24:27], a[32:35], v[120:123]
    ds_read_b64_tr_b16 a[22:23], v210 offset:61440
    s_add_u32 s42, s42, 196608
    buffer_load_dwordx4 v3, s[84:87], s92 offen offset:1024 sc1 lds
    s_waitcnt vmcnt(13) lgkmcnt(4)
    v_mfma_f32_16x16x32_bf16 v[96:99], a[0:3], a[48:51], v[96:99]
    ds_read_b64_tr_b16 a[24:25], v211 offset:49152
    ds_read_b64_tr_b16 a[26:27], v211 offset:53248
    v_mfma_f32_16x16x32_bf16 v[96:99], a[4:7], a[56:59], v[96:99]
    ds_read_b64_tr_b16 a[28:29], v211 offset:57344
    s_add_u32 s92, s92, s95
    v_mfma_f32_16x16x32_bf16 v[100:103], a[4:7], a[60:63], v[100:103]
    buffer_load_dwordx4 a[32:35], v220, s[48:51], s42 offen sc1
    v_mfma_f32_16x16x32_bf16 v[100:103], a[0:3], a[52:55], v[100:103]
    ds_read_b64_tr_b16 a[30:31], v211 offset:61440
    s_waitcnt vmcnt(17)
    buffer_store_dword v21, v20, s[80:83], s68 offen sc0 sc1
    v_mfma_f32_16x16x32_bf16 v[108:111], a[8:11], a[52:55], v[108:111]
    s_waitcnt vmcnt(14)
    s_barrier
    ds_read_b64_tr_b16 a[0:1], v212 offset:0
    ds_read_b64_tr_b16 a[2:3], v212 offset:4096
    v_mfma_f32_16x16x32_bf16 v[108:111], a[12:15], a[60:63], v[108:111]
    ds_read_b64_tr_b16 a[4:5], v212 offset:8192
    v_mfma_f32_16x16x32_bf16 v[104:107], a[12:15], a[56:59], v[104:107]
    buffer_load_dwordx4 a[36:39], v221, s[48:51], s42 offen sc1
    s_add_u32 m0, s46, 131072
    v_mfma_f32_16x16x32_bf16 v[104:107], a[8:11], a[48:51], v[104:107]
    ds_read_b64_tr_b16 a[6:7], v212 offset:12288
    s_add_u32 s42, s42, 196608
    buffer_load_dwordx4 v2, s[84:87], s92 offen offset:0 sc1 lds
    s_waitcnt lgkmcnt(4)
    v_mfma_f32_16x16x32_bf16 v[112:115], a[16:19], a[48:51], v[112:115]
    ds_read_b64_tr_b16 a[8:9], v213 offset:0
    ds_read_b64_tr_b16 a[10:11], v213 offset:4096
    v_mfma_f32_16x16x32_bf16 v[112:115], a[20:23], a[56:59], v[112:115]
    ds_read_b64_tr_b16 a[12:13], v213 offset:8192
    s_mul_i32 s21, s3, 4608
    v_mfma_f32_16x16x32_bf16 v[116:119], a[20:23], a[60:63], v[116:119]
    buffer_load_dwordx4 a[40:43], v220, s[48:51], s42 offen sc1
    v_mfma_f32_16x16x32_bf16 v[116:119], a[16:19], a[52:55], v[116:119]
    ds_read_b64_tr_b16 a[14:15], v213 offset:12288
    s_add_u32 s21, s21, 114688
    v_mfma_f32_16x16x32_bf16 v[124:127], a[24:27], a[52:55], v[124:127]
    ds_read_b64_tr_b16 a[16:17], v214 offset:0
    ds_read_b64_tr_b16 a[18:19], v214 offset:4096
    v_mfma_f32_16x16x32_bf16 v[124:127], a[28:31], a[60:63], v[124:127]
    ds_read_b64_tr_b16 a[20:21], v214 offset:8192
    v_and_b32 v4, 15, v1
    v_mfma_f32_16x16x32_bf16 v[120:123], a[28:31], a[56:59], v[120:123]
    buffer_load_dwordx4 a[44:47], v221, s[48:51], s42 offen sc1
    v_mfma_f32_16x16x32_bf16 v[120:123], a[24:27], a[48:51], v[120:123]
    ds_read_b64_tr_b16 a[22:23], v214 offset:12288
    s_add_u32 s42, s42, 196608
    buffer_load_dwordx4 v3, s[84:87], s92 offen offset:1024 sc1 lds
    v_mul_u32_u24 v4, 144, v4
    s_waitcnt vmcnt(14) lgkmcnt(4)
    v_mfma_f32_16x16x32_bf16 v[96:99], a[0:3], a[64:67], v[96:99]
    ds_read_b64_tr_b16 a[24:25], v215 offset:0
    ds_read_b64_tr_b16 a[26:27], v215 offset:4096
    v_mfma_f32_16x16x32_bf16 v[96:99], a[4:7], a[72:75], v[96:99]
    ds_read_b64_tr_b16 a[28:29], v215 offset:8192
    s_add_u32 s92, s92, s95
    v_lshrrev_b32 v5, 4, v1
    v_mfma_f32_16x16x32_bf16 v[100:103], a[4:7], a[76:79], v[100:103]
    buffer_load_dwordx4 a[48:51], v220, s[48:51], s42 offen sc1
    v_mfma_f32_16x16x32_bf16 v[100:103], a[0:3], a[68:71], v[100:103]
    ds_read_b64_tr_b16 a[30:31], v215 offset:12288
    v_lshl_add_u32 v4, v5, 3, v4
    v_mfma_f32_16x16x32_bf16 v[108:111], a[8:11], a[68:71], v[108:111]
    ds_read_b64_tr_b16 a[0:1], v212 offset:16384
    ds_read_b64_tr_b16 a[2:3], v212 offset:20480
    v_mfma_f32_16x16x32_bf16 v[108:111], a[12:15], a[76:79], v[108:111]
    ds_read_b64_tr_b16 a[4:5], v212 offset:24576
    v_add_u32 v4, s21, v4
    v_mfma_f32_16x16x32_bf16 v[104:107], a[12:15], a[72:75], v[104:107]
    buffer_load_dwordx4 a[52:55], v221, s[48:51], s42 offen sc1
    s_add_u32 m0, s46, 147456
    v_mfma_f32_16x16x32_bf16 v[104:107], a[8:11], a[64:67], v[104:107]
    ds_read_b64_tr_b16 a[6:7], v212 offset:28672
    s_add_u32 s42, s42, 196608
    buffer_load_dwordx4 v2, s[84:87], s92 offen offset:0 sc1 lds
    v_lshrrev_b32 v8, 3, v1
    s_waitcnt lgkmcnt(4)
    v_mfma_f32_16x16x32_bf16 v[112:115], a[16:19], a[64:67], v[112:115]
    ds_read_b64_tr_b16 a[8:9], v213 offset:16384
    ds_read_b64_tr_b16 a[10:11], v213 offset:20480
    v_mfma_f32_16x16x32_bf16 v[112:115], a[20:23], a[72:75], v[112:115]
    ds_read_b64_tr_b16 a[12:13], v213 offset:24576
    v_and_b32 v9, 7, v1
    v_mfma_f32_16x16x32_bf16 v[116:119], a[20:23], a[76:79], v[116:119]
    buffer_load_dwordx4 a[56:59], v220, s[48:51], s42 offen sc1
    v_mfma_f32_16x16x32_bf16 v[116:119], a[16:19], a[68:71], v[116:119]
    ds_read_b64_tr_b16 a[14:15], v213 offset:28672
    v_mul_u32_u24 v5, 144, v8
    v_mfma_f32_16x16x32_bf16 v[124:127], a[24:27], a[68:71], v[124:127]
    ds_read_b64_tr_b16 a[16:17], v214 offset:16384
    ds_read_b64_tr_b16 a[18:19], v214 offset:20480
    v_mfma_f32_16x16x32_bf16 v[124:127], a[28:31], a[76:79], v[124:127]
    ds_read_b64_tr_b16 a[20:21], v214 offset:24576
    v_lshl_add_u32 v5, v9, 4, v5
    v_mfma_f32_16x16x32_bf16 v[120:123], a[28:31], a[72:75], v[120:123]
    buffer_load_dwordx4 a[60:63], v221, s[48:51], s42 offen sc1
    v_mfma_f32_16x16x32_bf16 v[120:123], a[24:27], a[64:67], v[120:123]
    ds_read_b64_tr_b16 a[22:23], v214 offset:28672
    s_add_u32 s42, s42, 196608
    buffer_load_dwordx4 v3, s[84:87], s92 offen offset:1024 sc1 lds
    v_add_u32 v5, s21, v5
    s_waitcnt vmcnt(14) lgkmcnt(4)
    v_mfma_f32_16x16x32_bf16 v[96:99], a[0:3], a[80:83], v[96:99]
    ds_read_b64_tr_b16 a[24:25], v215 offset:16384
    ds_read_b64_tr_b16 a[26:27], v215 offset:20480
    v_mfma_f32_16x16x32_bf16 v[96:99], a[4:7], a[88:91], v[96:99]
    ds_read_b64_tr_b16 a[28:29], v215 offset:24576
    s_add_u32 s92, s92, s95
    v_lshlrev_b32 v6, 11, v8
    v_mfma_f32_16x16x32_bf16 v[100:103], a[4:7], a[92:95], v[100:103]
    buffer_load_dwordx4 a[64:67], v220, s[48:51], s42 offen sc1
    v_mfma_f32_16x16x32_bf16 v[100:103], a[0:3], a[84:87], v[100:103]
    ds_read_b64_tr_b16 a[30:31], v215 offset:28672
    v_lshl_add_u32 v6, v9, 4, v6
    v_mfma_f32_16x16x32_bf16 v[108:111], a[8:11], a[84:87], v[108:111]
    s_waitcnt vmcnt(14)
    s_barrier
    ds_read_b64_tr_b16 a[0:1], v212 offset:32768
    ds_read_b64_tr_b16 a[2:3], v212 offset:36864
    v_mfma_f32_16x16x32_bf16 v[108:111], a[12:15], a[92:95], v[108:111]
    ds_read_b64_tr_b16 a[4:5], v212 offset:40960
    v_add_u32 v8, 0x4000, v6
    v_mfma_f32_16x16x32_bf16 v[104:107], a[12:15], a[88:91], v[104:107]
    buffer_load_dwordx4 a[68:71], v221, s[48:51], s42 offen sc1
    s_add_u32 m0, s46, 0
    v_mfma_f32_16x16x32_bf16 v[104:107], a[8:11], a[80:83], v[104:107]
    ds_read_b64_tr_b16 a[6:7], v212 offset:45056
    s_add_u32 s42, s42, 196608
    buffer_load_dwordx4 v2, s[84:87], s92 offen offset:0 sc1 lds
    s_waitcnt lgkmcnt(4)
    v_mfma_f32_16x16x32_bf16 v[112:115], a[16:19], a[80:83], v[112:115]
    ds_read_b64_tr_b16 a[8:9], v213 offset:32768
    ds_read_b64_tr_b16 a[10:11], v213 offset:36864
    v_mfma_f32_16x16x32_bf16 v[112:115], a[20:23], a[88:91], v[112:115]
    ds_read_b64_tr_b16 a[12:13], v213 offset:40960
    v_mfma_f32_16x16x32_bf16 v[116:119], a[20:23], a[92:95], v[116:119]
    buffer_load_dwordx4 a[72:75], v220, s[48:51], s42 offen sc1
    v_mfma_f32_16x16x32_bf16 v[116:119], a[16:19], a[84:87], v[116:119]
    ds_read_b64_tr_b16 a[14:15], v213 offset:45056
    buffer_load_dword v26, v20, s[80:83], s69 offen sc0 sc1
    v_mfma_f32_16x16x32_bf16 v[124:127], a[24:27], a[84:87], v[124:127]
    ds_read_b64_tr_b16 a[16:17], v214 offset:32768
    ds_read_b64_tr_b16 a[18:19], v214 offset:36864
    v_mfma_f32_16x16x32_bf16 v[124:127], a[28:31], a[92:95], v[124:127]
    ds_read_b64_tr_b16 a[20:21], v214 offset:40960
    v_mfma_f32_16x16x32_bf16 v[120:123], a[28:31], a[88:91], v[120:123]
    buffer_load_dwordx4 a[76:79], v221, s[48:51], s42 offen sc1
    v_mfma_f32_16x16x32_bf16 v[120:123], a[24:27], a[80:83], v[120:123]
    ds_read_b64_tr_b16 a[22:23], v214 offset:45056
    s_add_u32 s42, s42, 196608
    buffer_load_dwordx4 v3, s[84:87], s92 offen offset:1024 sc1 lds
    s_waitcnt vmcnt(14) lgkmcnt(4)
    v_mfma_f32_16x16x32_bf16 v[96:99], a[0:3], a[32:35], v[96:99]
    ds_read_b64_tr_b16 a[24:25], v215 offset:32768
    ds_read_b64_tr_b16 a[26:27], v215 offset:36864
    v_mfma_f32_16x16x32_bf16 v[96:99], a[4:7], a[40:43], v[96:99]
    ds_read_b64_tr_b16 a[28:29], v215 offset:40960
    s_add_u32 s92, s92, s95
recurrent_scan__sliding_local_dilated__swiglu_ffn__prompt_kernel_w11:
    s_cbranch_execz recurrent_scan__sliding_local_dilated__swiglu_ffn__prompt_kernel_wret0
    v_mfma_f32_16x16x32_bf16 v[100:103], a[4:7], a[44:47], v[100:103]
    buffer_load_dwordx4 a[80:83], v220, s[48:51], s42 offen sc1
    v_mfma_f32_16x16x32_bf16 v[100:103], a[0:3], a[36:39], v[100:103]
    ds_read_b64_tr_b16 a[30:31], v215 offset:45056
    v_mfma_f32_16x16x32_bf16 v[108:111], a[8:11], a[36:39], v[108:111]
    ds_read_b64_tr_b16 a[0:1], v212 offset:49152
    ds_read_b64_tr_b16 a[2:3], v212 offset:53248
    v_mfma_f32_16x16x32_bf16 v[108:111], a[12:15], a[44:47], v[108:111]
    ds_read_b64_tr_b16 a[4:5], v212 offset:57344
    v_mfma_f32_16x16x32_bf16 v[104:107], a[12:15], a[40:43], v[104:107]
    buffer_load_dwordx4 a[84:87], v221, s[48:51], s42 offen sc1
    s_add_u32 m0, s46, 16384
    v_mfma_f32_16x16x32_bf16 v[104:107], a[8:11], a[32:35], v[104:107]
    ds_read_b64_tr_b16 a[6:7], v212 offset:61440
    s_add_u32 s42, s42, 196608
    buffer_load_dwordx4 v2, s[84:87], s92 offen offset:0 sc1 lds
    s_waitcnt lgkmcnt(4)
    v_mfma_f32_16x16x32_bf16 v[112:115], a[16:19], a[32:35], v[112:115]
    ds_read_b64_tr_b16 a[8:9], v213 offset:49152
    ds_read_b64_tr_b16 a[10:11], v213 offset:53248
    v_mfma_f32_16x16x32_bf16 v[112:115], a[20:23], a[40:43], v[112:115]
    ds_read_b64_tr_b16 a[12:13], v213 offset:57344
    v_mfma_f32_16x16x32_bf16 v[116:119], a[20:23], a[44:47], v[116:119]
    buffer_load_dwordx4 a[88:91], v220, s[48:51], s42 offen sc1
    v_mfma_f32_16x16x32_bf16 v[116:119], a[16:19], a[36:39], v[116:119]
    ds_read_b64_tr_b16 a[14:15], v213 offset:61440
    v_mfma_f32_16x16x32_bf16 v[124:127], a[24:27], a[36:39], v[124:127]
    ds_read_b64_tr_b16 a[16:17], v214 offset:49152
    ds_read_b64_tr_b16 a[18:19], v214 offset:53248
    v_mfma_f32_16x16x32_bf16 v[124:127], a[28:31], a[44:47], v[124:127]
    ds_read_b64_tr_b16 a[20:21], v214 offset:57344
    v_mfma_f32_16x16x32_bf16 v[120:123], a[28:31], a[40:43], v[120:123]
    buffer_load_dwordx4 a[92:95], v221, s[48:51], s42 offen sc1
    v_mfma_f32_16x16x32_bf16 v[120:123], a[24:27], a[32:35], v[120:123]
    ds_read_b64_tr_b16 a[22:23], v214 offset:61440
    s_add_u32 s42, s42, 196608
    buffer_load_dwordx4 v3, s[84:87], s92 offen offset:1024 sc1 lds
    s_waitcnt vmcnt(14) lgkmcnt(4)
    v_mfma_f32_16x16x32_bf16 v[96:99], a[0:3], a[48:51], v[96:99]
    ds_read_b64_tr_b16 a[24:25], v215 offset:49152
    ds_read_b64_tr_b16 a[26:27], v215 offset:53248
    v_mfma_f32_16x16x32_bf16 v[96:99], a[4:7], a[56:59], v[96:99]
    ds_read_b64_tr_b16 a[28:29], v215 offset:57344
    s_add_u32 s92, s92, s95
    v_mfma_f32_16x16x32_bf16 v[100:103], a[4:7], a[60:63], v[100:103]
    buffer_load_dwordx4 a[32:35], v220, s[48:51], s42 offen sc1
    v_mfma_f32_16x16x32_bf16 v[100:103], a[0:3], a[52:55], v[100:103]
    ds_read_b64_tr_b16 a[30:31], v215 offset:61440
    s_waitcnt vmcnt(9)
recurrent_scan__sliding_local_dilated__swiglu_ffn__prompt_kernel_e_back:
    v_cmp_ne_u32 vcc, 0, v26
    s_cmp_eq_u64 vcc, exec
    s_cbranch_scc0 recurrent_scan__sliding_local_dilated__swiglu_ffn__prompt_kernel_e_spin
recurrent_scan__sliding_local_dilated__swiglu_ffn__prompt_kernel_e_out:
    v_mfma_f32_16x16x32_bf16 v[108:111], a[8:11], a[52:55], v[108:111]
    s_waitcnt vmcnt(14)
    s_barrier
    ds_read_b64_tr_b16 a[0:1], v216 offset:0
    ds_read_b64_tr_b16 a[2:3], v216 offset:4096
    v_mfma_f32_16x16x32_bf16 v[108:111], a[12:15], a[60:63], v[108:111]
    ds_read_b64_tr_b16 a[4:5], v216 offset:8192
    v_mfma_f32_16x16x32_bf16 v[104:107], a[12:15], a[56:59], v[104:107]
    buffer_load_dwordx4 a[36:39], v221, s[48:51], s42 offen sc1
    s_add_u32 m0, s46, 32768
    buffer_load_dwordx4 v[144:147], v224, s[8:11], s71 offen offset:0 sc0 sc1
    v_mfma_f32_16x16x32_bf16 v[104:107], a[8:11], a[48:51], v[104:107]
    ds_read_b64_tr_b16 a[6:7], v216 offset:12288
    s_add_u32 s42, s42, 196608
    buffer_load_dwordx4 v2, s[84:87], s92 offen offset:0 sc1 lds
    s_waitcnt lgkmcnt(4)
    v_mfma_f32_16x16x32_bf16 v[112:115], a[16:19], a[48:51], v[112:115]
    ds_read_b64_tr_b16 a[8:9], v217 offset:0
    ds_read_b64_tr_b16 a[10:11], v217 offset:4096
    v_mfma_f32_16x16x32_bf16 v[112:115], a[20:23], a[56:59], v[112:115]
    ds_read_b64_tr_b16 a[12:13], v217 offset:8192
    v_mfma_f32_16x16x32_bf16 v[116:119], a[20:23], a[60:63], v[116:119]
    buffer_load_dwordx4 a[40:43], v220, s[48:51], s42 offen sc1
    v_mfma_f32_16x16x32_bf16 v[116:119], a[16:19], a[52:55], v[116:119]
    ds_read_b64_tr_b16 a[14:15], v217 offset:12288
    v_mfma_f32_16x16x32_bf16 v[124:127], a[24:27], a[52:55], v[124:127]
    ds_read_b64_tr_b16 a[16:17], v218 offset:0
    ds_read_b64_tr_b16 a[18:19], v218 offset:4096
    v_mfma_f32_16x16x32_bf16 v[124:127], a[28:31], a[60:63], v[124:127]
    ds_read_b64_tr_b16 a[20:21], v218 offset:8192
    v_mfma_f32_16x16x32_bf16 v[120:123], a[28:31], a[56:59], v[120:123]
    buffer_load_dwordx4 a[44:47], v221, s[48:51], s42 offen sc1
    buffer_load_dwordx4 v[148:151], v225, s[8:11], s71 offen offset:0 sc0 sc1
    v_mfma_f32_16x16x32_bf16 v[120:123], a[24:27], a[48:51], v[120:123]
    ds_read_b64_tr_b16 a[22:23], v218 offset:12288
    s_add_u32 s42, s42, 196608
    buffer_load_dwordx4 v3, s[84:87], s92 offen offset:1024 sc1 lds
    s_waitcnt vmcnt(15) lgkmcnt(4)
    v_mfma_f32_16x16x32_bf16 v[96:99], a[0:3], a[64:67], v[96:99]
    ds_read_b64_tr_b16 a[24:25], v219 offset:0
    ds_read_b64_tr_b16 a[26:27], v219 offset:4096
    v_mfma_f32_16x16x32_bf16 v[96:99], a[4:7], a[72:75], v[96:99]
    ds_read_b64_tr_b16 a[28:29], v219 offset:8192
    s_add_u32 s92, s92, s95
    v_mfma_f32_16x16x32_bf16 v[100:103], a[4:7], a[76:79], v[100:103]
    buffer_load_dwordx4 a[48:51], v220, s[48:51], s42 offen sc1
    v_mfma_f32_16x16x32_bf16 v[100:103], a[0:3], a[68:71], v[100:103]
    ds_read_b64_tr_b16 a[30:31], v219 offset:12288
    v_mfma_f32_16x16x32_bf16 v[108:111], a[8:11], a[68:71], v[108:111]
    ds_read_b64_tr_b16 a[0:1], v216 offset:16384
    ds_read_b64_tr_b16 a[2:3], v216 offset:20480
    v_mfma_f32_16x16x32_bf16 v[108:111], a[12:15], a[76:79], v[108:111]
    ds_read_b64_tr_b16 a[4:5], v216 offset:24576
    v_mfma_f32_16x16x32_bf16 v[104:107], a[12:15], a[72:75], v[104:107]
    buffer_load_dwordx4 a[52:55], v221, s[48:51], s42 offen sc1
    s_add_u32 m0, s46, 49152
    buffer_load_dwordx4 v[152:155], v224, s[8:11], s71 offen offset:3072 sc0 sc1
    v_mfma_f32_16x16x32_bf16 v[104:107], a[8:11], a[64:67], v[104:107]
    ds_read_b64_tr_b16 a[6:7], v216 offset:28672
    s_add_u32 s42, s42, 196608
    buffer_load_dwordx4 v2, s[84:87], s92 offen offset:0 sc1 lds
    s_waitcnt lgkmcnt(4)
    v_mfma_f32_16x16x32_bf16 v[112:115], a[16:19], a[64:67], v[112:115]
    ds_read_b64_tr_b16 a[8:9], v217 offset:16384
    ds_read_b64_tr_b16 a[10:11], v217 offset:20480
    v_mfma_f32_16x16x32_bf16 v[112:115], a[20:23], a[72:75], v[112:115]
    ds_read_b64_tr_b16 a[12:13], v217 offset:24576
    v_mfma_f32_16x16x32_bf16 v[116:119], a[20:23], a[76:79], v[116:119]
    buffer_load_dwordx4 a[56:59], v220, s[48:51], s42 offen sc1
    v_mfma_f32_16x16x32_bf16 v[116:119], a[16:19], a[68:71], v[116:119]
    ds_read_b64_tr_b16 a[14:15], v217 offset:28672
    v_mfma_f32_16x16x32_bf16 v[124:127], a[24:27], a[68:71], v[124:127]
    ds_read_b64_tr_b16 a[16:17], v218 offset:16384
    ds_read_b64_tr_b16 a[18:19], v218 offset:20480
    v_mfma_f32_16x16x32_bf16 v[124:127], a[28:31], a[76:79], v[124:127]
    ds_read_b64_tr_b16 a[20:21], v218 offset:24576
    v_mfma_f32_16x16x32_bf16 v[120:123], a[28:31], a[72:75], v[120:123]
    buffer_load_dwordx4 a[60:63], v221, s[48:51], s42 offen sc1
    buffer_load_dwordx4 v[156:159], v225, s[8:11], s71 offen offset:3072 sc0 sc1
    v_mfma_f32_16x16x32_bf16 v[120:123], a[24:27], a[64:67], v[120:123]
    ds_read_b64_tr_b16 a[22:23], v218 offset:28672
    s_add_u32 s42, s42, 196608
    buffer_load_dwordx4 v3, s[84:87], s92 offen offset:1024 sc1 lds
    s_waitcnt vmcnt(17) lgkmcnt(4)
    v_mfma_f32_16x16x32_bf16 v[96:99], a[0:3], a[80:83], v[96:99]
    ds_read_b64_tr_b16 a[24:25], v219 offset:16384
    ds_read_b64_tr_b16 a[26:27], v219 offset:20480
    v_mfma_f32_16x16x32_bf16 v[96:99], a[4:7], a[88:91], v[96:99]
    ds_read_b64_tr_b16 a[28:29], v219 offset:24576
    s_add_u32 s92, s92, s95
    v_mfma_f32_16x16x32_bf16 v[100:103], a[4:7], a[92:95], v[100:103]
    buffer_load_dwordx4 a[64:67], v220, s[48:51], s42 offen sc1
    v_mfma_f32_16x16x32_bf16 v[100:103], a[0:3], a[84:87], v[100:103]
    ds_read_b64_tr_b16 a[30:31], v219 offset:28672
    v_mfma_f32_16x16x32_bf16 v[108:111], a[8:11], a[84:87], v[108:111]
    s_waitcnt vmcnt(17)
    s_barrier
    ds_read_b64_tr_b16 a[0:1], v208 offset:0
    ds_read_b64_tr_b16 a[2:3], v208 offset:4096
    v_mfma_f32_16x16x32_bf16 v[108:111], a[12:15], a[92:95], v[108:111]
    ds_read_b64_tr_b16 a[4:5], v208 offset:8192
    v_mfma_f32_16x16x32_bf16 v[104:107], a[12:15], a[88:91], v[104:107]
    buffer_load_dwordx4 a[68:71], v221, s[48:51], s42 offen sc1
    v_mfma_f32_16x16x32_bf16 v[104:107], a[8:11], a[80:83], v[104:107]
    ds_read_b64_tr_b16 a[6:7], v208 offset:12288
    s_waitcnt lgkmcnt(4)
    v_mfma_f32_16x16x32_bf16 v[112:115], a[16:19], a[80:83], v[112:115]
    ds_read_b64_tr_b16 a[8:9], v209 offset:0
    ds_read_b64_tr_b16 a[10:11], v209 offset:4096
    v_mfma_f32_16x16x32_bf16 v[112:115], a[20:23], a[88:91], v[112:115]
    ds_read_b64_tr_b16 a[12:13], v209 offset:8192
    s_add_u32 s42, s42, 196608
    v_mfma_f32_16x16x32_bf16 v[116:119], a[20:23], a[92:95], v[116:119]
    buffer_load_dwordx4 a[72:75], v220, s[48:51], s42 offen sc1
    v_mfma_f32_16x16x32_bf16 v[116:119], a[16:19], a[84:87], v[116:119]
    ds_read_b64_tr_b16 a[14:15], v209 offset:12288
    v_mfma_f32_16x16x32_bf16 v[124:127], a[24:27], a[84:87], v[124:127]
    ds_read_b64_tr_b16 a[16:17], v210 offset:0
    ds_read_b64_tr_b16 a[18:19], v210 offset:4096
    v_mfma_f32_16x16x32_bf16 v[124:127], a[28:31], a[92:95], v[124:127]
    ds_read_b64_tr_b16 a[20:21], v210 offset:8192
    v_mfma_f32_16x16x32_bf16 v[120:123], a[28:31], a[88:91], v[120:123]
    buffer_load_dwordx4 a[76:79], v221, s[48:51], s42 offen sc1
    v_mfma_f32_16x16x32_bf16 v[120:123], a[24:27], a[80:83], v[120:123]
    ds_read_b64_tr_b16 a[22:23], v210 offset:12288
    s_waitcnt vmcnt(14) lgkmcnt(4)
    v_mfma_f32_16x16x32_bf16 v[96:99], a[0:3], a[32:35], v[96:99]
    ds_read_b64_tr_b16 a[24:25], v211 offset:0
    ds_read_b64_tr_b16 a[26:27], v211 offset:4096
    s_waitcnt vmcnt(13)
    v_fma_mix_f32 v32, v144, v26, v32 op_sel:[0,0,0] op_sel_hi:[1,0,0]
    v_fma_mix_f32 v33, v144, v26, v33 op_sel:[1,0,0] op_sel_hi:[1,0,0]
    v_fma_mix_f32 v34, v145, v26, v34 op_sel:[0,0,0] op_sel_hi:[1,0,0]
    v_mfma_f32_16x16x32_bf16 v[96:99], a[4:7], a[40:43], v[96:99]
    ds_read_b64_tr_b16 a[28:29], v211 offset:8192
    s_add_u32 s42, s42, 196608
    v_fma_mix_f32 v35, v145, v26, v35 op_sel:[1,0,0] op_sel_hi:[1,0,0]
    v_fma_mix_f32 v36, v146, v26, v36 op_sel:[0,0,0] op_sel_hi:[1,0,0]
    v_fma_mix_f32 v37, v146, v26, v37 op_sel:[1,0,0] op_sel_hi:[1,0,0]
    v_fma_mix_f32 v38, v147, v26, v38 op_sel:[0,0,0] op_sel_hi:[1,0,0]
    v_mfma_f32_16x16x32_bf16 v[100:103], a[4:7], a[44:47], v[100:103]
    buffer_load_dwordx4 a[80:83], v220, s[48:51], s42 offen sc1
    v_fma_mix_f32 v39, v147, v26, v39 op_sel:[1,0,0] op_sel_hi:[1,0,0]
    v_fma_mix_f32 v40, v148, v26, v40 op_sel:[0,0,0] op_sel_hi:[1,0,0]
    v_fma_mix_f32 v41, v148, v26, v41 op_sel:[1,0,0] op_sel_hi:[1,0,0]
    v_fma_mix_f32 v42, v149, v26, v42 op_sel:[0,0,0] op_sel_hi:[1,0,0]
    v_mfma_f32_16x16x32_bf16 v[100:103], a[0:3], a[36:39], v[100:103]
    ds_read_b64_tr_b16 a[30:31], v211 offset:12288
    v_fma_mix_f32 v43, v149, v26, v43 op_sel:[1,0,0] op_sel_hi:[1,0,0]
    v_fma_mix_f32 v44, v150, v26, v44 op_sel:[0,0,0] op_sel_hi:[1,0,0]
    v_fma_mix_f32 v45, v150, v26, v45 op_sel:[1,0,0] op_sel_hi:[1,0,0]
    v_fma_mix_f32 v46, v151, v26, v46 op_sel:[0,0,0] op_sel_hi:[1,0,0]
    v_mfma_f32_16x16x32_bf16 v[108:111], a[8:11], a[36:39], v[108:111]
    ds_read_b64_tr_b16 a[0:1], v208 offset:16384
    ds_read_b64_tr_b16 a[2:3], v208 offset:20480
    v_fma_mix_f32 v47, v151, v26, v47 op_sel:[1,0,0] op_sel_hi:[1,0,0]
    v_mul_f32 v176, s12, v32
    v_mul_f32 v177, s12, v33
    v_mul_f32 v178, s12, v34
    v_mfma_f32_16x16x32_bf16 v[108:111], a[12:15], a[44:47], v[108:111]
    ds_read_b64_tr_b16 a[4:5], v208 offset:24576
    v_mul_f32 v179, s12, v35
    v_mul_f32 v180, s12, v36
    v_mul_f32 v181, s12, v37
    v_mul_f32 v182, s12, v38
    v_mfma_f32_16x16x32_bf16 v[104:107], a[12:15], a[40:43], v[104:107]
    buffer_load_dwordx4 a[84:87], v221, s[48:51], s42 offen sc1
    v_mul_f32 v183, s12, v39
    v_mul_f32 v184, s12, v40
    v_mul_f32 v185, s12, v41
    v_mul_f32 v186, s12, v42
    v_mfma_f32_16x16x32_bf16 v[104:107], a[8:11], a[32:35], v[104:107]
    ds_read_b64_tr_b16 a[6:7], v208 offset:28672
    v_mul_f32 v187, s12, v43
    v_mul_f32 v188, s12, v44
    v_mul_f32 v189, s12, v45
    v_mul_f32 v190, s12, v46
    s_waitcnt lgkmcnt(4)
    v_mfma_f32_16x16x32_bf16 v[112:115], a[16:19], a[32:35], v[112:115]
    ds_read_b64_tr_b16 a[8:9], v209 offset:16384
    ds_read_b64_tr_b16 a[10:11], v209 offset:20480
    v_mul_f32 v191, s12, v47
    v_exp_f32 v176, v176
    v_exp_f32 v177, v177
    v_exp_f32 v178, v178
    v_mfma_f32_16x16x32_bf16 v[112:115], a[20:23], a[40:43], v[112:115]
    ds_read_b64_tr_b16 a[12:13], v209 offset:24576
    s_add_u32 s42, s42, 196608
    v_exp_f32 v179, v179
    v_exp_f32 v180, v180
    v_exp_f32 v181, v181
    v_exp_f32 v182, v182
    v_mfma_f32_16x16x32_bf16 v[116:119], a[20:23], a[44:47], v[116:119]
    buffer_load_dwordx4 a[88:91], v220, s[48:51], s42 offen sc1
    v_exp_f32 v183, v183
    v_exp_f32 v184, v184
    v_exp_f32 v185, v185
    v_exp_f32 v186, v186
    v_mfma_f32_16x16x32_bf16 v[116:119], a[16:19], a[36:39], v[116:119]
    ds_read_b64_tr_b16 a[14:15], v209 offset:28672
    v_exp_f32 v187, v187
    v_exp_f32 v188, v188
    v_exp_f32 v189, v189
    v_exp_f32 v190, v190
    v_mfma_f32_16x16x32_bf16 v[124:127], a[24:27], a[36:39], v[124:127]
    ds_read_b64_tr_b16 a[16:17], v210 offset:16384
    ds_read_b64_tr_b16 a[18:19], v210 offset:20480
    v_exp_f32 v191, v191
    v_add_f32 v176, 1.0, v176
    v_add_f32 v177, 1.0, v177
    v_add_f32 v178, 1.0, v178
    v_mfma_f32_16x16x32_bf16 v[124:127], a[28:31], a[44:47], v[124:127]
    ds_read_b64_tr_b16 a[20:21], v210 offset:24576
    v_add_f32 v179, 1.0, v179
    v_add_f32 v180, 1.0, v180
    v_add_f32 v181, 1.0, v181
    v_add_f32 v182, 1.0, v182
    v_mfma_f32_16x16x32_bf16 v[120:123], a[28:31], a[40:43], v[120:123]
    buffer_load_dwordx4 a[92:95], v221, s[48:51], s42 offen sc1
    v_add_f32 v183, 1.0, v183
    v_add_f32 v184, 1.0, v184
    v_add_f32 v185, 1.0, v185
    v_add_f32 v186, 1.0, v186
    v_mfma_f32_16x16x32_bf16 v[120:123], a[24:27], a[32:35], v[120:123]
    ds_read_b64_tr_b16 a[22:23], v210 offset:28672
    v_add_f32 v187, 1.0, v187
    v_add_f32 v188, 1.0, v188
    v_add_f32 v189, 1.0, v189
    v_add_f32 v190, 1.0, v190
    s_waitcnt vmcnt(10) lgkmcnt(4)
    v_mfma_f32_16x16x32_bf16 v[96:99], a[0:3], a[48:51], v[96:99]
    ds_read_b64_tr_b16 a[24:25], v211 offset:16384
    ds_read_b64_tr_b16 a[26:27], v211 offset:20480
    v_add_f32 v191, 1.0, v191
    v_rcp_f32 v176, v176
    v_rcp_f32 v177, v177
    v_rcp_f32 v178, v178
    v_mfma_f32_16x16x32_bf16 v[96:99], a[4:7], a[56:59], v[96:99]
    ds_read_b64_tr_b16 a[28:29], v211 offset:24576
    s_add_u32 s42, s42, 196608
    v_rcp_f32 v179, v179
    v_rcp_f32 v180, v180
    v_rcp_f32 v181, v181
    v_rcp_f32 v182, v182
    v_mfma_f32_16x16x32_bf16 v[100:103], a[4:7], a[60:63], v[100:103]
    v_rcp_f32 v183, v183
    v_rcp_f32 v184, v184
    v_rcp_f32 v185, v185
    v_rcp_f32 v186, v186
    v_mfma_f32_16x16x32_bf16 v[100:103], a[0:3], a[52:55], v[100:103]
    ds_read_b64_tr_b16 a[30:31], v211 offset:28672
    v_rcp_f32 v187, v187
    v_rcp_f32 v188, v188
    v_rcp_f32 v189, v189
    v_rcp_f32 v190, v190
    v_mfma_f32_16x16x32_bf16 v[108:111], a[8:11], a[52:55], v[108:111]
    s_waitcnt vmcnt(8)
    s_barrier
    ds_read_b64_tr_b16 a[0:1], v208 offset:32768
    ds_read_b64_tr_b16 a[2:3], v208 offset:36864
    v_rcp_f32 v191, v191
    v_mul_f32 v32, v32, v176
    v_mul_f32 v33, v33, v177
    v_mul_f32 v34, v34, v178
    v_mfma_f32_16x16x32_bf16 v[108:111], a[12:15], a[60:63], v[108:111]
    ds_read_b64_tr_b16 a[4:5], v208 offset:40960
    v_mul_f32 v35, v35, v179
    v_mul_f32 v36, v36, v180
    v_mul_f32 v37, v37, v181
    v_mul_f32 v38, v38, v182
    v_mfma_f32_16x16x32_bf16 v[104:107], a[12:15], a[56:59], v[104:107]
    v_mul_f32 v39, v39, v183
    v_mul_f32 v40, v40, v184
    v_mul_f32 v41, v41, v185
    v_mul_f32 v42, v42, v186
    v_mfma_f32_16x16x32_bf16 v[104:107], a[8:11], a[48:51], v[104:107]
    ds_read_b64_tr_b16 a[6:7], v208 offset:45056
    v_mul_f32 v43, v43, v187
    v_mul_f32 v44, v44, v188
    v_mul_f32 v45, v45, v189
    v_mul_f32 v46, v46, v190
    s_waitcnt lgkmcnt(4)
    v_mfma_f32_16x16x32_bf16 v[112:115], a[16:19], a[48:51], v[112:115]
    ds_read_b64_tr_b16 a[8:9], v209 offset:32768
    ds_read_b64_tr_b16 a[10:11], v209 offset:36864
    v_mul_f32 v47, v47, v191
    s_waitcnt vmcnt(9)
    v_fma_mix_f32 v48, v152, v26, v48 op_sel:[0,0,0] op_sel_hi:[1,0,0]
    v_fma_mix_f32 v49, v152, v26, v49 op_sel:[1,0,0] op_sel_hi:[1,0,0]
    v_mfma_f32_16x16x32_bf16 v[112:115], a[20:23], a[56:59], v[112:115]
    ds_read_b64_tr_b16 a[12:13], v209 offset:40960
    v_fma_mix_f32 v50, v153, v26, v50 op_sel:[0,0,0] op_sel_hi:[1,0,0]
    v_fma_mix_f32 v51, v153, v26, v51 op_sel:[1,0,0] op_sel_hi:[1,0,0]
    v_fma_mix_f32 v52, v154, v26, v52 op_sel:[0,0,0] op_sel_hi:[1,0,0]
    v_fma_mix_f32 v53, v154, v26, v53 op_sel:[1,0,0] op_sel_hi:[1,0,0]
    v_mfma_f32_16x16x32_bf16 v[116:119], a[20:23], a[60:63], v[116:119]
    v_fma_mix_f32 v54, v155, v26, v54 op_sel:[0,0,0] op_sel_hi:[1,0,0]
    v_fma_mix_f32 v55, v155, v26, v55 op_sel:[1,0,0] op_sel_hi:[1,0,0]
    v_fma_mix_f32 v56, v156, v26, v56 op_sel:[0,0,0] op_sel_hi:[1,0,0]
    v_fma_mix_f32 v57, v156, v26, v57 op_sel:[1,0,0] op_sel_hi:[1,0,0]
    v_mfma_f32_16x16x32_bf16 v[116:119], a[16:19], a[52:55], v[116:119]
    ds_read_b64_tr_b16 a[14:15], v209 offset:45056
    v_fma_mix_f32 v58, v157, v26, v58 op_sel:[0,0,0] op_sel_hi:[1,0,0]
    v_fma_mix_f32 v59, v157, v26, v59 op_sel:[1,0,0] op_sel_hi:[1,0,0]
    v_fma_mix_f32 v60, v158, v26, v60 op_sel:[0,0,0] op_sel_hi:[1,0,0]
    v_fma_mix_f32 v61, v158, v26, v61 op_sel:[1,0,0] op_sel_hi:[1,0,0]
    v_mfma_f32_16x16x32_bf16 v[124:127], a[24:27], a[52:55], v[124:127]
    ds_read_b64_tr_b16 a[16:17], v210 offset:32768
    ds_read_b64_tr_b16 a[18:19], v210 offset:36864
    v_fma_mix_f32 v62, v159, v26, v62 op_sel:[0,0,0] op_sel_hi:[1,0,0]
    v_fma_mix_f32 v63, v159, v26, v63 op_sel:[1,0,0] op_sel_hi:[1,0,0]
    v_mul_f32 v192, s12, v48
    v_mul_f32 v193, s12, v49
    v_mfma_f32_16x16x32_bf16 v[124:127], a[28:31], a[60:63], v[124:127]
    ds_read_b64_tr_b16 a[20:21], v210 offset:40960
    v_mul_f32 v194, s12, v50
    v_mul_f32 v195, s12, v51
    v_mul_f32 v196, s12, v52
    v_mul_f32 v197, s12, v53
    v_mfma_f32_16x16x32_bf16 v[120:123], a[28:31], a[56:59], v[120:123]
    v_mul_f32 v198, s12, v54
    v_mul_f32 v199, s12, v55
    v_mul_f32 v200, s12, v56
    v_mul_f32 v201, s12, v57
    v_mfma_f32_16x16x32_bf16 v[120:123], a[24:27], a[48:51], v[120:123]
    ds_read_b64_tr_b16 a[22:23], v210 offset:45056
    v_mul_f32 v202, s12, v58
    v_mul_f32 v203, s12, v59
    v_mul_f32 v204, s12, v60
    v_mul_f32 v205, s12, v61
    s_waitcnt vmcnt(4) lgkmcnt(4)
    v_mfma_f32_16x16x32_bf16 v[96:99], a[0:3], a[64:67], v[96:99]
    ds_read_b64_tr_b16 a[24:25], v211 offset:32768
    ds_read_b64_tr_b16 a[26:27], v211 offset:36864
    v_mul_f32 v206, s12, v62
    v_mul_f32 v207, s12, v63
    v_exp_f32 v192, v192
    v_exp_f32 v193, v193
    v_mfma_f32_16x16x32_bf16 v[96:99], a[4:7], a[72:75], v[96:99]
    ds_read_b64_tr_b16 a[28:29], v211 offset:40960
    v_exp_f32 v194, v194
    v_exp_f32 v195, v195
    v_exp_f32 v196, v196
    v_exp_f32 v197, v197
    v_mfma_f32_16x16x32_bf16 v[100:103], a[4:7], a[76:79], v[100:103]
    v_exp_f32 v198, v198
    v_exp_f32 v199, v199
    v_exp_f32 v200, v200
    v_exp_f32 v201, v201
    v_mfma_f32_16x16x32_bf16 v[100:103], a[0:3], a[68:71], v[100:103]
    ds_read_b64_tr_b16 a[30:31], v211 offset:45056
    v_exp_f32 v202, v202
    v_exp_f32 v203, v203
    v_exp_f32 v204, v204
    v_exp_f32 v205, v205
    v_mfma_f32_16x16x32_bf16 v[108:111], a[8:11], a[68:71], v[108:111]
    ds_read_b64_tr_b16 a[0:1], v208 offset:49152
    ds_read_b64_tr_b16 a[2:3], v208 offset:53248
    v_exp_f32 v206, v206
    v_exp_f32 v207, v207
    v_add_f32 v192, 1.0, v192
    v_add_f32 v193, 1.0, v193
    v_mfma_f32_16x16x32_bf16 v[108:111], a[12:15], a[76:79], v[108:111]
    ds_read_b64_tr_b16 a[4:5], v208 offset:57344
    v_add_f32 v194, 1.0, v194
    v_add_f32 v195, 1.0, v195
    v_add_f32 v196, 1.0, v196
    v_add_f32 v197, 1.0, v197
    v_mfma_f32_16x16x32_bf16 v[104:107], a[12:15], a[72:75], v[104:107]
    v_add_f32 v198, 1.0, v198
    v_add_f32 v199, 1.0, v199
    v_add_f32 v200, 1.0, v200
    v_add_f32 v201, 1.0, v201
    v_mfma_f32_16x16x32_bf16 v[104:107], a[8:11], a[64:67], v[104:107]
    ds_read_b64_tr_b16 a[6:7], v208 offset:61440
    v_add_f32 v202, 1.0, v202
    v_add_f32 v203, 1.0, v203
    v_add_f32 v204, 1.0, v204
    v_add_f32 v205, 1.0, v205
    s_waitcnt lgkmcnt(4)
    v_mfma_f32_16x16x32_bf16 v[112:115], a[16:19], a[64:67], v[112:115]
    ds_read_b64_tr_b16 a[8:9], v209 offset:49152
    ds_read_b64_tr_b16 a[10:11], v209 offset:53248
    v_add_f32 v206, 1.0, v206
    v_add_f32 v207, 1.0, v207
    v_rcp_f32 v192, v192
    v_rcp_f32 v193, v193
    v_mfma_f32_16x16x32_bf16 v[112:115], a[20:23], a[72:75], v[112:115]
    ds_read_b64_tr_b16 a[12:13], v209 offset:57344
    v_rcp_f32 v194, v194
    v_rcp_f32 v195, v195
    v_rcp_f32 v196, v196
    v_rcp_f32 v197, v197
    v_mfma_f32_16x16x32_bf16 v[116:119], a[20:23], a[76:79], v[116:119]
    v_rcp_f32 v198, v198
    v_rcp_f32 v199, v199
    v_rcp_f32 v200, v200
    v_rcp_f32 v201, v201
    v_mfma_f32_16x16x32_bf16 v[116:119], a[16:19], a[68:71], v[116:119]
    ds_read_b64_tr_b16 a[14:15], v209 offset:61440
    v_rcp_f32 v202, v202
    v_rcp_f32 v203, v203
    v_rcp_f32 v204, v204
    v_rcp_f32 v205, v205
    v_mfma_f32_16x16x32_bf16 v[124:127], a[24:27], a[68:71], v[124:127]
    ds_read_b64_tr_b16 a[16:17], v210 offset:49152
    ds_read_b64_tr_b16 a[18:19], v210 offset:53248
    v_rcp_f32 v206, v206
    v_rcp_f32 v207, v207
    v_mul_f32 v48, v48, v192
    v_mul_f32 v49, v49, v193
    v_mfma_f32_16x16x32_bf16 v[124:127], a[28:31], a[76:79], v[124:127]
    ds_read_b64_tr_b16 a[20:21], v210 offset:57344
    v_mul_f32 v50, v50, v194
    v_mul_f32 v51, v51, v195
    v_mul_f32 v52, v52, v196
    v_mul_f32 v53, v53, v197
    v_mfma_f32_16x16x32_bf16 v[120:123], a[28:31], a[72:75], v[120:123]
    v_mul_f32 v54, v54, v198
    v_mul_f32 v55, v55, v199
    v_mul_f32 v56, v56, v200
    v_mul_f32 v57, v57, v201
    v_mfma_f32_16x16x32_bf16 v[120:123], a[24:27], a[64:67], v[120:123]
    ds_read_b64_tr_b16 a[22:23], v210 offset:61440
    v_mul_f32 v58, v58, v202
    v_mul_f32 v59, v59, v203
    v_mul_f32 v60, v60, v204
    v_mul_f32 v61, v61, v205
    s_waitcnt vmcnt(0) lgkmcnt(4)
    v_mfma_f32_16x16x32_bf16 v[96:99], a[0:3], a[80:83], v[96:99]
    ds_read_b64_tr_b16 a[24:25], v211 offset:49152
    ds_read_b64_tr_b16 a[26:27], v211 offset:53248
    v_mul_f32 v62, v62, v206
    v_mul_f32 v63, v63, v207
    v_mfma_f32_16x16x32_bf16 v[96:99], a[4:7], a[88:91], v[96:99]
    ds_read_b64_tr_b16 a[28:29], v211 offset:57344
    v_mfma_f32_16x16x32_bf16 v[100:103], a[4:7], a[92:95], v[100:103]
    v_mfma_f32_16x16x32_bf16 v[100:103], a[0:3], a[84:87], v[100:103]
    ds_read_b64_tr_b16 a[30:31], v211 offset:61440
    v_mfma_f32_16x16x32_bf16 v[108:111], a[8:11], a[84:87], v[108:111]
    v_mfma_f32_16x16x32_bf16 v[108:111], a[12:15], a[92:95], v[108:111]
    v_mfma_f32_16x16x32_bf16 v[104:107], a[12:15], a[88:91], v[104:107]
    v_mfma_f32_16x16x32_bf16 v[104:107], a[8:11], a[80:83], v[104:107]
    s_waitcnt lgkmcnt(0)
    v_mfma_f32_16x16x32_bf16 v[112:115], a[16:19], a[80:83], v[112:115]
    v_mfma_f32_16x16x32_bf16 v[112:115], a[20:23], a[88:91], v[112:115]
    v_mfma_f32_16x16x32_bf16 v[116:119], a[20:23], a[92:95], v[116:119]
    v_mfma_f32_16x16x32_bf16 v[116:119], a[16:19], a[84:87], v[116:119]
    v_mfma_f32_16x16x32_bf16 v[124:127], a[24:27], a[84:87], v[124:127]
    v_mfma_f32_16x16x32_bf16 v[124:127], a[28:31], a[92:95], v[124:127]
    v_mfma_f32_16x16x32_bf16 v[120:123], a[28:31], a[88:91], v[120:123]
    v_mfma_f32_16x16x32_bf16 v[120:123], a[24:27], a[80:83], v[120:123]
    v_pk_fma_f32 v[32:33], v[32:33], v[96:97], v[160:161]
    v_pk_fma_f32 v[34:35], v[34:35], v[98:99], v[162:163]
    v_cvt_pk_bf16_f32 v128, v32, v33
    v_cvt_pk_bf16_f32 v129, v34, v35
    ds_write_b64 v4, v[128:129] offset:0
    v_pk_fma_f32 v[40:41], v[40:41], v[104:105], v[168:169]
    v_pk_fma_f32 v[42:43], v[42:43], v[106:107], v[170:171]
    v_cvt_pk_bf16_f32 v130, v40, v41
    v_cvt_pk_bf16_f32 v131, v42, v43
    ds_write_b64 v4, v[130:131] offset:32
    v_pk_fma_f32 v[48:49], v[48:49], v[112:113], v[232:233]
    v_pk_fma_f32 v[50:51], v[50:51], v[114:115], v[234:235]
    v_cvt_pk_bf16_f32 v132, v48, v49
    v_cvt_pk_bf16_f32 v133, v50, v51
    ds_write_b64 v4, v[132:133] offset:64
    v_pk_fma_f32 v[56:57], v[56:57], v[120:121], v[240:241]
    v_pk_fma_f32 v[58:59], v[58:59], v[122:123], v[242:243]
    v_cvt_pk_bf16_f32 v134, v56, v57
    v_cvt_pk_bf16_f32 v135, v58, v59
    ds_write_b64 v4, v[134:135] offset:96
    ds_read_b128 v[176:179], v5 offset:0
    ds_read_b128 v[180:183], v5 offset:1152
    v_pk_fma_f32 v[36:37], v[36:37], v[100:101], v[164:165]
    v_pk_fma_f32 v[38:39], v[38:39], v[102:103], v[166:167]
    v_cvt_pk_bf16_f32 v136, v36, v37
    v_cvt_pk_bf16_f32 v137, v38, v39
    ds_write_b64 v4, v[136:137] offset:2304
    v_pk_fma_f32 v[44:45], v[44:45], v[108:109], v[172:173]
    v_pk_fma_f32 v[46:47], v[46:47], v[110:111], v[174:175]
    v_cvt_pk_bf16_f32 v138, v44, v45
    v_cvt_pk_bf16_f32 v139, v46, v47
    ds_write_b64 v4, v[138:139] offset:2336
    v_pk_fma_f32 v[52:53], v[52:53], v[116:117], v[236:237]
    v_pk_fma_f32 v[54:55], v[54:55], v[118:119], v[238:239]
    v_cvt_pk_bf16_f32 v140, v52, v53
    v_cvt_pk_bf16_f32 v141, v54, v55
    ds_write_b64 v4, v[140:141] offset:2368
    v_pk_fma_f32 v[60:61], v[60:61], v[124:125], v[244:245]
    v_pk_fma_f32 v[62:63], v[62:63], v[126:127], v[246:247]
    v_cvt_pk_bf16_f32 v142, v60, v61
    v_cvt_pk_bf16_f32 v143, v62, v63
    ds_write_b64 v4, v[142:143] offset:2400
    ds_read_b128 v[184:187], v5 offset:2304
    ds_read_b128 v[188:191], v5 offset:3456
    s_waitcnt lgkmcnt(7)
    buffer_store_dwordx4 v[176:179], v6, s[52:55], s40 offen sc0 sc1
    s_waitcnt lgkmcnt(6)
    buffer_store_dwordx4 v[180:183], v8, s[52:55], s40 offen sc0 sc1
    s_waitcnt lgkmcnt(1)
    buffer_store_dwordx4 v[184:187], v6, s[52:55], s41 offen sc0 sc1
    s_waitcnt lgkmcnt(0)
    buffer_store_dwordx4 v[188:191], v8, s[52:55], s41 offen sc0 sc1
recurrent_scan__sliding_local_dilated__swiglu_ffn__prompt_kernel_done:
    s_endpgm
recurrent_scan__sliding_local_dilated__swiglu_ffn__prompt_kernel_spin_spin:
    s_sleep 1
    buffer_load_dword v12, v23, s[80:83], s35 offen sc0 sc1
    s_waitcnt vmcnt(0)
    s_add_u32 s45, s45, 1
    s_cmp_lt_u32 s45, 524288
    s_cbranch_scc1 recurrent_scan__sliding_local_dilated__swiglu_ffn__prompt_kernel_spin_back
    s_branch recurrent_scan__sliding_local_dilated__swiglu_ffn__prompt_kernel_spin_out

recurrent_scan__sliding_local_dilated__swiglu_ffn__prompt_kernel_g_spin:
    s_sleep 1
    buffer_load_dwordx4 v[16:19], v24, s[80:83], s96 offen sc1
    s_waitcnt vmcnt(0)
    s_add_u32 s45, s45, 1
    s_cmp_lt_u32 s45, 524288
    s_cbranch_scc1 recurrent_scan__sliding_local_dilated__swiglu_ffn__prompt_kernel_g_back
    s_branch recurrent_scan__sliding_local_dilated__swiglu_ffn__prompt_kernel_g_out

recurrent_scan__sliding_local_dilated__swiglu_ffn__prompt_kernel_h_spin:
    buffer_load_dword v227, v226, s[80:83], s47 offen sc0 sc1
    s_waitcnt vmcnt(0)
    v_cmp_eq_u32 vcc, v227, v22
    s_cmp_eq_u64 vcc, exec
    s_cbranch_scc1 recurrent_scan__sliding_local_dilated__swiglu_ffn__prompt_kernel_h_go
    s_add_u32 s45, s45, 1
    s_cmp_lt_u32 s45, 524288
    s_cbranch_scc1 recurrent_scan__sliding_local_dilated__swiglu_ffn__prompt_kernel_h_spin
recurrent_scan__sliding_local_dilated__swiglu_ffn__prompt_kernel_h_go:

    buffer_load_dwordx4 a[32:35], v220, s[48:51], s42 offen sc1
    buffer_load_dwordx4 a[36:39], v221, s[48:51], s42 offen sc1
    s_add_u32 s42, s42, 196608
    buffer_load_dwordx4 a[40:43], v220, s[48:51], s42 offen sc1
    buffer_load_dwordx4 a[44:47], v221, s[48:51], s42 offen sc1
    s_add_u32 s42, s42, 196608
    buffer_load_dwordx4 a[48:51], v220, s[48:51], s42 offen sc1
    buffer_load_dwordx4 a[52:55], v221, s[48:51], s42 offen sc1
    s_add_u32 s42, s42, 196608
    buffer_load_dwordx2 a[56:57], v222, s[48:51], s42 offen offset:512 sc1
    buffer_load_dwordx2 a[58:59], v222, s[48:51], s42 offen offset:1536 sc1
    buffer_load_dwordx2 a[60:61], v222, s[48:51], s42 offen offset:2560 sc1
    buffer_load_dwordx2 a[62:63], v222, s[48:51], s42 offen offset:0 sc1
    s_add_u32 s42, s42, 196608
    s_branch recurrent_scan__sliding_local_dilated__swiglu_ffn__prompt_kernel_h_ret
recurrent_scan__sliding_local_dilated__swiglu_ffn__prompt_kernel_o_spin:
    s_sleep 1
    buffer_load_dword v27, v24, s[80:83], s30 offen sc1
    s_waitcnt vmcnt(0)
    s_add_u32 s45, s45, 1
    s_cmp_lt_u32 s45, 524288
    s_cbranch_scc1 recurrent_scan__sliding_local_dilated__swiglu_ffn__prompt_kernel_o_back
    s_branch recurrent_scan__sliding_local_dilated__swiglu_ffn__prompt_kernel_o_out

recurrent_scan__sliding_local_dilated__swiglu_ffn__prompt_kernel_e_spin:
    s_sleep 1
    buffer_load_dword v26, v20, s[80:83], s69 offen sc0 sc1
    s_waitcnt vmcnt(0)
    s_add_u32 s45, s45, 1
    s_cmp_lt_u32 s45, 524288
    s_cbranch_scc1 recurrent_scan__sliding_local_dilated__swiglu_ffn__prompt_kernel_e_back
    s_branch recurrent_scan__sliding_local_dilated__swiglu_ffn__prompt_kernel_e_out

code_end:
    s_endpgm
.section .rodata,"a"
.p2align 6
.amdhsa_kernel recurrent_scan__sliding_local_dilated__swiglu_ffn__prompt_kernel
  .amdhsa_next_free_vgpr 512
  .amdhsa_next_free_sgpr 102
  .amdhsa_accum_offset 256
  .amdhsa_group_segment_fixed_size 0
  .amdhsa_kernarg_size 80
  .amdhsa_user_sgpr_count 2
  .amdhsa_user_sgpr_kernarg_segment_ptr 1
  .amdhsa_system_sgpr_workgroup_id_x 1
  .amdhsa_float_denorm_mode_32 3
  .amdhsa_float_denorm_mode_16_64 3
.end_amdhsa_kernel
```
